```python
import torch

def _softmax(x, axis=-1):
    return torch.softmax(x, dim=axis)

def _gelu(x):
    return torch.nn.functional.gelu(x, approximate='tanh')

def _silu(x):
    return torch.nn.functional.silu(x)

def _sigmoid(x):
    return torch.sigmoid(x)

def _layernorm(x, axis=-1, eps=1e-05):
    m = x.mean(dim=axis, keepdim=True)
    v = x.var(dim=axis, keepdim=True, unbiased=False)
    return (x - m) / torch.sqrt(v + eps)

def _scatter_add(tgt, idx, src, axis=0):
    return tgt.clone().index_add_(axis, idx, src)

def _segment_sum(src, seg, n):
    out = torch.zeros((n,) + src.shape[1:], dtype=src.dtype)
    return out.index_add_(0, seg, src)

def _pad(x, pw):
    flat = tuple((v for pair in reversed(pw) for v in pair))
    return torch.nn.functional.pad(x, flat)
kernel_name = 'adaLN_cond__compressed_kv_cla__geglu_ffn__prompt'

def setup_inputs():

    _w = lambda a: (lambda t: t.to(torch.bfloat16) if t.is_floating_point() else t)(torch.as_tensor(a))

    def _A_setup():
        B, H, Sq, Sk, D, M = (1, 32, 2048, 2048, 128, 512)
        Dc = 4 * D
        return {'x': _w((lambda *s: torch.randn(*s, dtype=torch.bfloat16) * 0.05)(B, Sq, M)), 'c_kv': _w((lambda *s: torch.randn(*s, dtype=torch.bfloat16) * 1.6)(B, Sk, Dc)), 'w_q': _w((lambda *s: torch.randn(*s, dtype=torch.bfloat16) * 0.8)(M, H, D) * M ** (-0.5)), 'w_uk': _w((lambda *s: torch.randn(*s, dtype=torch.bfloat16) * 0.8)(Dc, H, D) * Dc ** (-0.5)), 'w_uv': _w((lambda *s: torch.randn(*s, dtype=torch.bfloat16) * 1.6)(Dc, H, D) * Dc ** (-0.5)), 'w_o': _w((lambda *s: torch.randn(*s, dtype=torch.bfloat16) * 1.6)(H, D, M) * (H * D) ** (-0.5))}
    _A_in = _A_setup()

    def _B_setup():
        B, S, D, F = (1, 2048, 512, 1792)
        return {'x': _w((lambda *s: torch.randn(*s, dtype=torch.bfloat16) * 0.05)(B, S, D)), 'w_gate': _w((lambda *s: torch.randn(*s, dtype=torch.bfloat16) * 0.05)(D, F)), 'w_up': _w((lambda *s: torch.randn(*s, dtype=torch.bfloat16) * 0.05)(D, F)), 'w_down': _w((lambda *s: torch.randn(*s, dtype=torch.bfloat16) * 0.05)(F, D))}
    _B_in = _B_setup()
    return {'A_x': _A_in['x'], 'A_c_kv': _A_in['c_kv'], 'A_w_q': _A_in['w_q'], 'A_w_uk': _A_in['w_uk'], 'A_w_uv': _A_in['w_uv'], 'A_w_o': _A_in['w_o'], 'B_x': _B_in['x'], 'B_w_gate': _B_in['w_gate'], 'B_w_up': _B_in['w_up'], 'B_w_down': _B_in['w_down'], 'c': _w((lambda *s: torch.randn(*s, dtype=torch.bfloat16) * 0.1)(1, 512) * 8.0), 'w_mod': _w((lambda *s: torch.randn(*s, dtype=torch.bfloat16) * 0.1)(512, 6 * 512) * 512 ** (-0.5) * 8.0)}

def reference(A_x, A_c_kv, A_w_q, A_w_uk, A_w_uv, A_w_o, B_x, B_w_gate, B_w_up, B_w_down, c, w_mod):

    def _A_ref(x, c_kv, w_q, w_uk, w_uv, w_o):
        B, Sq, M = (x.shape[0], x.shape[1], x.shape[2])
        Sk = c_kv.shape[1]
        H, D = (w_q.shape[1], w_q.shape[2])
        q = torch.einsum('bqm,mhd->bhqd', x, w_q)
        k = torch.einsum('bkc,chd->bhkd', c_kv, w_uk)
        v = torch.einsum('bkc,chd->bhkd', c_kv, w_uv)
        scores = torch.einsum('bhqd,bhkd->bhqk', q, k) * D ** (-0.5)
        off = Sk - Sq
        qi = torch.arange(Sq)[:, None]
        kj = torch.arange(Sk)[None, :]
        cmask = kj <= qi + off
        scores = torch.where(cmask[None, None], scores, -1000000000.0)
        p = _softmax(scores, axis=-1)
        ctx = torch.einsum('bhqk,bhkd->bhqd', p, v)
        return torch.einsum('bhqd,hdm->bqm', ctx, w_o)

    def _B_ref(x, w_gate, w_up, w_down):
        return _gelu(x @ w_gate) * (x @ w_up) @ w_down
    x = A_x
    mod = (_silu(c) @ w_mod).reshape(c.shape[0], 6, 1, -1)
    sa, ca, ga, sb, cb, gb = (mod[:, 0].clone(), mod[:, 1].clone(), mod[:, 2].clone(), mod[:, 3].clone(), mod[:, 4].clone(), mod[:, 5].clone())
    h = _layernorm(x, axis=-1) * (1 + ca) + sa
    x = x + ga * _A_ref(h, A_c_kv, A_w_q, A_w_uk, A_w_uv, A_w_o)
    h = _layernorm(x, axis=-1) * (1 + cb) + sb
    x = x + gb * _B_ref(h, B_w_gate, B_w_up, B_w_down)
    return x
```

```asm
; @launch kernel=kv_kernel grid=(256,1,1) block=(512,1,1) lds=163840
; @launch kernel=attn_kernel grid=(256,1,1) block=(512,1,1) lds=163840
; @launch kernel=oproj_kernel grid=(256,1,1) block=(512,1,1) lds=163840
; @launch kernel=rgu_kernel grid=(256,1,1) block=(512,1,1) lds=163840
; @launch kernel=down_kernel grid=(256,1,1) block=(512,1,1) lds=163840
.amdgcn_target "amdgcn-amd-amdhsa--gfx950"
.text
.globl kv_kernel
.p2align 8
.type kv_kernel,@function
kv_kernel:
    s_cmp_ge_u32 s2, 256
    s_cbranch_scc1 kv_kernel_end
    s_load_dwordx2 s[4:5], s[0:1], 8
    s_load_dwordx4 s[24:27], s[0:1], 24
    s_load_dwordx2 s[8:9], s[0:1], 112
    v_and_b32 v1, 63, v0
    v_lshrrev_b32 v5, 6, v0
    s_nop 0
    v_readfirstlane_b32 s30, v5
    s_and_b32 s31, s30, 3
    s_lshr_b32 s32, s30, 2
    s_and_b32 s33, s2, 7
    s_lshr_b32 s34, s2, 3
    s_and_b32 s35, s34, 7
    s_lshl_b32 s33, s33, 3
    s_add_u32 s33, s33, s35
    s_lshr_b32 s34, s34, 3
    s_and_b32 s35, s33, 31
    s_lshr_b32 s36, s33, 5
    s_waitcnt lgkmcnt(0)
    s_cmp_eq_u32 s36, 0
    s_cselect_b32 s6, s24, s26
    s_cselect_b32 s7, s25, s27
    s_mov_b32 s12, s4
    s_mov_b32 s13, s5
    s_mov_b32 s14, 2097152
    s_mov_b32 s15, 0x00020000
    s_mov_b32 s16, s6
    s_mov_b32 s17, s7
    s_mov_b32 s18, 4194304
    s_mov_b32 s19, 0x00020000
    s_add_u32 s20, s8, 51380224
    s_addc_u32 s21, s9, 0
    s_mov_b32 s22, 33554432
    s_mov_b32 s23, 0x00020000
    v_lshrrev_b32 v5, 4, v1
    v_and_b32 v6, 15, v1
    v_lshlrev_b32 v7, 2, v5
    v_xor_b32 v6, v6, v7
    v_lshlrev_b32 v6, 4, v6
    v_lshlrev_b32 v5, 13, v5
    v_add_u32 v3, v5, v6
    v_and_b32 v5, 15, v1
    v_lshrrev_b32 v6, 2, v5
    v_and_b32 v7, 3, v5
    v_lshrrev_b32 v5, 5, v1
    v_lshlrev_b32 v5, 3, v5
    v_add_u32 v5, v5, v6
    v_lshlrev_b32 v5, 8, v5
    v_xor_b32 v6, s31, v6
    v_lshlrev_b32 v6, 6, v6
    v_add_u32 v5, v5, v6
    v_lshrrev_b32 v6, 4, v1
    v_and_b32 v6, 1, v6
    v_lshlrev_b32 v6, 5, v6
    v_add_u32 v5, v5, v6
    v_lshlrev_b32 v7, 3, v7
    v_add_u32 v2, v5, v7
    v_and_b32 v5, 31, v1
    v_lshrrev_b32 v6, 5, v1
    v_and_b32 v7, 15, v1
    s_lshl_b32 s37, s32, 15
    v_lshlrev_b32 v5, 10, v5
    v_add_u32 v5, s37, v5
    v_add_u32 v8, 0, v6
    v_xor_b32 v8, v8, v7
    v_lshlrev_b32 v8, 4, v8
    v_add_u32 v8, v8, v5
    v_add_u32 v9, 2, v6
    v_xor_b32 v9, v9, v7
    v_lshlrev_b32 v9, 4, v9
    v_add_u32 v9, v9, v5
    v_add_u32 v10, 4, v6
    v_xor_b32 v10, v10, v7
    v_lshlrev_b32 v10, 4, v10
    v_add_u32 v10, v10, v5
    v_add_u32 v11, 6, v6
    v_xor_b32 v11, v11, v7
    v_lshlrev_b32 v11, 4, v11
    v_add_u32 v11, v11, v5
    v_add_u32 v12, 8, v6
    v_xor_b32 v12, v12, v7
    v_lshlrev_b32 v12, 4, v12
    v_add_u32 v12, v12, v5
    v_add_u32 v13, 10, v6
    v_xor_b32 v13, v13, v7
    v_lshlrev_b32 v13, 4, v13
    v_add_u32 v13, v13, v5
    v_add_u32 v14, 12, v6
    v_xor_b32 v14, v14, v7
    v_lshlrev_b32 v14, 4, v14
    v_add_u32 v14, v14, v5
    v_add_u32 v15, 14, v6
    v_xor_b32 v15, v15, v7
    v_lshlrev_b32 v15, 4, v15
    v_add_u32 v15, v15, v5
    s_and_b32 s37, s30, 1
    s_lshl_b32 s37, s37, 3
    s_add_u32 s38, s37, 0
    v_xor_b32 v16, s38, v1
    v_lshlrev_b32 v16, 4, v16
    s_add_u32 s38, s37, 1
    v_xor_b32 v17, s38, v1
    v_lshlrev_b32 v17, 4, v17
    s_add_u32 s38, s37, 2
    v_xor_b32 v18, s38, v1
    v_lshlrev_b32 v18, 4, v18
    s_add_u32 s38, s37, 3
    v_xor_b32 v19, s38, v1
    v_lshlrev_b32 v19, 4, v19
    s_add_u32 s38, s37, 4
    v_xor_b32 v20, s38, v1
    v_lshlrev_b32 v20, 4, v20
    s_add_u32 s38, s37, 5
    v_xor_b32 v21, s38, v1
    v_lshlrev_b32 v21, 4, v21
    s_add_u32 s38, s37, 6
    v_xor_b32 v22, s38, v1
    v_lshlrev_b32 v22, 4, v22
    s_add_u32 s38, s37, 7
    v_xor_b32 v23, s38, v1
    v_lshlrev_b32 v23, 4, v23
    v_lshlrev_b32 v4, 4, v1
    s_lshl_b32 s40, s35, 8
    s_lshl_b32 s41, s30, 17
    s_add_u32 s40, s40, s41
    s_lshl_b32 s42, s30, 12
    s_lshl_b32 s43, s34, 19
    s_lshl_b32 s41, s30, 13
    s_add_u32 s43, s43, s41
    s_lshl_b32 s44, s30, 13
    s_lshl_b32 s45, s35, 6
    s_lshl_b32 s41, s34, 4
    s_add_u32 s45, s45, s41
    s_add_u32 s45, s45, s32
    s_lshl_b32 s45, s45, 14
    s_lshl_b32 s41, s36, 13
    s_add_u32 s45, s45, s41
    s_lshl_b32 s41, s31, 11
    s_add_u32 s45, s45, s41
    s_cmp_eq_u32 s36, 0
    s_cbranch_scc0 kv_kernel_V
    v_add_u32 v5, 0x10000, v2
    v_add_u32 v6, 0x20000, v2
    s_cmp_ge_u32 s2, 48
    s_cbranch_scc1 kv_kernel_ml1
    s_load_dwordx4 s[56:59], s[0:1], 80
    v_and_b32 v56, 7, v0
    v_lshrrev_b32 v57, 3, v0
    v_lshlrev_b32 v58, 4, v57
    s_waitcnt lgkmcnt(0)
    global_load_dwordx4 v[60:63], v58, s[56:57]
    s_mov_b32 s53, 49152
    v_mul_lo_u32 v58, v57, s53
    v_lshlrev_b32 v56, 4, v56
    v_add_u32 v58, v58, v56
    s_lshl_b32 s53, s2, 7
    v_add_u32 v58, s53, v58
    global_load_dwordx4 v[24:27], v58, s[58:59]
    v_add_u32 v58, 6144, v58
    global_load_dwordx4 v[28:31], v58, s[58:59]
    v_add_u32 v58, 6144, v58
    global_load_dwordx4 v[32:35], v58, s[58:59]
    v_add_u32 v58, 6144, v58
    global_load_dwordx4 v[36:39], v58, s[58:59]
    v_add_u32 v58, 6144, v58
    global_load_dwordx4 v[40:43], v58, s[58:59]
    v_add_u32 v58, 6144, v58
    global_load_dwordx4 v[44:47], v58, s[58:59]
    v_add_u32 v58, 6144, v58
    global_load_dwordx4 v[48:51], v58, s[58:59]
    v_add_u32 v58, 6144, v58
    global_load_dwordx4 v[52:55], v58, s[58:59]
kv_kernel_ml1:
    s_add_u32 m0, s42, 131072
    s_add_u32 s46, s40, 0
    buffer_load_dwordx4 v3, s[16:19], s46 offen lds
    s_add_u32 m0, s42, 132096
    s_add_u32 s46, s40, 32768
    buffer_load_dwordx4 v3, s[16:19], s46 offen lds
    s_add_u32 m0, s42, 133120
    s_add_u32 s46, s40, 65536
    buffer_load_dwordx4 v3, s[16:19], s46 offen lds
    s_add_u32 m0, s42, 134144
    s_add_u32 s46, s40, 98304
    buffer_load_dwordx4 v3, s[16:19], s46 offen lds
    s_add_u32 m0, s44, 0
    s_add_u32 s46, s43, 0
    buffer_load_dwordx4 v16, s[12:15], s46 offen offset:0 lds
    buffer_load_dwordx4 v17, s[12:15], s46 offen offset:1024 lds
    buffer_load_dwordx4 v18, s[12:15], s46 offen offset:2048 lds
    buffer_load_dwordx4 v19, s[12:15], s46 offen offset:3072 lds
    s_add_u32 m0, s44, 4096
    s_add_u32 s46, s43, 4096
    buffer_load_dwordx4 v20, s[12:15], s46 offen offset:0 lds
    buffer_load_dwordx4 v21, s[12:15], s46 offen offset:1024 lds
    buffer_load_dwordx4 v22, s[12:15], s46 offen offset:2048 lds
    buffer_load_dwordx4 v23, s[12:15], s46 offen offset:3072 lds
    s_add_u32 m0, s42, 65536
    s_add_u32 s46, s40, 1048576
    buffer_load_dwordx4 v3, s[16:19], s46 offen lds
    s_add_u32 m0, s42, 66560
    s_add_u32 s46, s40, 1081344
    buffer_load_dwordx4 v3, s[16:19], s46 offen lds
    s_add_u32 m0, s42, 67584
    s_add_u32 s46, s40, 1114112
    buffer_load_dwordx4 v3, s[16:19], s46 offen lds
    s_add_u32 m0, s42, 68608
    s_add_u32 s46, s40, 1146880
    buffer_load_dwordx4 v3, s[16:19], s46 offen lds
    s_add_u32 m0, s42, 98304
    s_add_u32 s46, s40, 2097152
    buffer_load_dwordx4 v3, s[16:19], s46 offen lds
    s_add_u32 m0, s42, 99328
    s_add_u32 s46, s40, 2129920
    buffer_load_dwordx4 v3, s[16:19], s46 offen lds
    s_add_u32 m0, s42, 100352
    s_add_u32 s46, s40, 2162688
    buffer_load_dwordx4 v3, s[16:19], s46 offen lds
    s_add_u32 m0, s42, 101376
    s_add_u32 s46, s40, 2195456
    buffer_load_dwordx4 v3, s[16:19], s46 offen lds
    s_waitcnt vmcnt(8)
    s_barrier
    ds_read_b64_tr_b16 v[128:129], v6 offset:0
    ds_read_b64_tr_b16 v[130:131], v6 offset:1024
    ds_read_b64_tr_b16 v[132:133], v6 offset:4096
    ds_read_b64_tr_b16 v[134:135], v6 offset:5120
    ds_read_b64_tr_b16 v[136:137], v6 offset:8192
    ds_read_b64_tr_b16 v[138:139], v6 offset:9216
    ds_read_b64_tr_b16 v[140:141], v6 offset:12288
    ds_read_b64_tr_b16 v[142:143], v6 offset:13312
    ds_read_b64_tr_b16 v[144:145], v6 offset:16384
    ds_read_b64_tr_b16 v[146:147], v6 offset:17408
    ds_read_b64_tr_b16 v[148:149], v6 offset:20480
    ds_read_b64_tr_b16 v[150:151], v6 offset:21504
    ds_read_b64_tr_b16 v[152:153], v6 offset:24576
    ds_read_b64_tr_b16 v[154:155], v6 offset:25600
    ds_read_b64_tr_b16 v[156:157], v6 offset:28672
    ds_read_b64_tr_b16 v[158:159], v6 offset:29696
    s_waitcnt lgkmcnt(0)
    ds_read_b128 v[64:67], v8 offset:0
    ds_read_b128 v[68:71], v9 offset:0
    ds_read_b128 v[72:75], v10 offset:0
    ds_read_b128 v[76:79], v11 offset:0
    ds_read_b128 v[80:83], v12 offset:0
    ds_read_b128 v[84:87], v13 offset:0
    ds_read_b128 v[88:91], v14 offset:0
    s_waitcnt lgkmcnt(6)
    v_mfma_f32_32x32x16_bf16 v[96:111], v[128:131], v[64:67], 0
    ds_read_b128 v[92:95], v15 offset:0
    s_waitcnt lgkmcnt(6)
    v_mfma_f32_32x32x16_bf16 v[96:111], v[132:135], v[68:71], v[96:111]
    s_waitcnt lgkmcnt(5)
    v_mfma_f32_32x32x16_bf16 v[96:111], v[136:139], v[72:75], v[96:111]
    s_waitcnt lgkmcnt(4)
    v_mfma_f32_32x32x16_bf16 v[96:111], v[140:143], v[76:79], v[96:111]
    s_waitcnt lgkmcnt(3)
    v_mfma_f32_32x32x16_bf16 v[96:111], v[144:147], v[80:83], v[96:111]
    s_waitcnt lgkmcnt(2)
    v_mfma_f32_32x32x16_bf16 v[96:111], v[148:151], v[84:87], v[96:111]
    s_waitcnt lgkmcnt(1)
    v_mfma_f32_32x32x16_bf16 v[96:111], v[152:155], v[88:91], v[96:111]
    s_waitcnt lgkmcnt(0)
    v_mfma_f32_32x32x16_bf16 v[96:111], v[156:159], v[92:95], v[96:111]
    s_waitcnt vmcnt(0)
    s_barrier
    s_add_u32 m0, s42, 131072
    s_add_u32 s46, s40, 3145728
    buffer_load_dwordx4 v3, s[16:19], s46 offen lds
    s_add_u32 m0, s42, 132096
    s_add_u32 s46, s40, 3178496
    buffer_load_dwordx4 v3, s[16:19], s46 offen lds
    s_add_u32 m0, s42, 133120
    s_add_u32 s46, s40, 3211264
    buffer_load_dwordx4 v3, s[16:19], s46 offen lds
    s_add_u32 m0, s42, 134144
    s_add_u32 s46, s40, 3244032
    buffer_load_dwordx4 v3, s[16:19], s46 offen lds
    ds_read_b64_tr_b16 v[160:161], v5 offset:0
    ds_read_b64_tr_b16 v[162:163], v5 offset:1024
    ds_read_b64_tr_b16 v[164:165], v5 offset:4096
    ds_read_b64_tr_b16 v[166:167], v5 offset:5120
    ds_read_b64_tr_b16 v[168:169], v5 offset:8192
    ds_read_b64_tr_b16 v[170:171], v5 offset:9216
    ds_read_b64_tr_b16 v[172:173], v5 offset:12288
    ds_read_b64_tr_b16 v[174:175], v5 offset:13312
    ds_read_b64_tr_b16 v[176:177], v5 offset:16384
    ds_read_b64_tr_b16 v[178:179], v5 offset:17408
    ds_read_b64_tr_b16 v[180:181], v5 offset:20480
    ds_read_b64_tr_b16 v[182:183], v5 offset:21504
    ds_read_b64_tr_b16 v[184:185], v5 offset:24576
    ds_read_b64_tr_b16 v[186:187], v5 offset:25600
    ds_read_b64_tr_b16 v[188:189], v5 offset:28672
    ds_read_b64_tr_b16 v[190:191], v5 offset:29696
    ds_read_b64_tr_b16 v[192:193], v5 offset:32768
    ds_read_b64_tr_b16 v[194:195], v5 offset:33792
    ds_read_b64_tr_b16 v[196:197], v5 offset:36864
    ds_read_b64_tr_b16 v[198:199], v5 offset:37888
    ds_read_b64_tr_b16 v[200:201], v5 offset:40960
    ds_read_b64_tr_b16 v[202:203], v5 offset:41984
    ds_read_b64_tr_b16 v[204:205], v5 offset:45056
    ds_read_b64_tr_b16 v[206:207], v5 offset:46080
    ds_read_b64_tr_b16 v[208:209], v5 offset:49152
    ds_read_b64_tr_b16 v[210:211], v5 offset:50176
    ds_read_b64_tr_b16 v[212:213], v5 offset:53248
    ds_read_b64_tr_b16 v[214:215], v5 offset:54272
    ds_read_b64_tr_b16 v[216:217], v5 offset:57344
    ds_read_b64_tr_b16 v[218:219], v5 offset:58368
    ds_read_b64_tr_b16 v[220:221], v5 offset:61440
    ds_read_b64_tr_b16 v[222:223], v5 offset:62464
    s_waitcnt lgkmcnt(0)
    ds_read_b128 v[64:67], v8 offset:256
    ds_read_b128 v[68:71], v9 offset:256
    ds_read_b128 v[72:75], v10 offset:256
    ds_read_b128 v[76:79], v11 offset:256
    ds_read_b128 v[80:83], v12 offset:256
    ds_read_b128 v[84:87], v13 offset:256
    ds_read_b128 v[88:91], v14 offset:256
    s_waitcnt lgkmcnt(6)
    v_mfma_f32_32x32x16_bf16 v[96:111], v[160:163], v[64:67], v[96:111]
    ds_read_b128 v[92:95], v15 offset:256
    s_waitcnt lgkmcnt(6)
    v_mfma_f32_32x32x16_bf16 v[96:111], v[164:167], v[68:71], v[96:111]
    s_waitcnt lgkmcnt(5)
    v_mfma_f32_32x32x16_bf16 v[96:111], v[168:171], v[72:75], v[96:111]
    s_waitcnt lgkmcnt(4)
    v_mfma_f32_32x32x16_bf16 v[96:111], v[172:175], v[76:79], v[96:111]
    s_waitcnt lgkmcnt(3)
    v_mfma_f32_32x32x16_bf16 v[96:111], v[176:179], v[80:83], v[96:111]
    s_waitcnt lgkmcnt(2)
    v_mfma_f32_32x32x16_bf16 v[96:111], v[180:183], v[84:87], v[96:111]
    s_waitcnt lgkmcnt(1)
    v_mfma_f32_32x32x16_bf16 v[96:111], v[184:187], v[88:91], v[96:111]
    s_waitcnt lgkmcnt(0)
    v_mfma_f32_32x32x16_bf16 v[96:111], v[188:191], v[92:95], v[96:111]
    s_barrier
    s_add_u32 m0, s44, 65536
    s_add_u32 s46, s43, 65536
    buffer_load_dwordx4 v16, s[12:15], s46 offen offset:0 lds
    buffer_load_dwordx4 v17, s[12:15], s46 offen offset:1024 lds
    buffer_load_dwordx4 v18, s[12:15], s46 offen offset:2048 lds
    buffer_load_dwordx4 v19, s[12:15], s46 offen offset:3072 lds
    s_add_u32 m0, s44, 69632
    s_add_u32 s46, s43, 69632
    buffer_load_dwordx4 v20, s[12:15], s46 offen offset:0 lds
    buffer_load_dwordx4 v21, s[12:15], s46 offen offset:1024 lds
    buffer_load_dwordx4 v22, s[12:15], s46 offen offset:2048 lds
    buffer_load_dwordx4 v23, s[12:15], s46 offen offset:3072 lds
    ds_read_b128 v[64:67], v8 offset:512
    ds_read_b128 v[68:71], v9 offset:512
    ds_read_b128 v[72:75], v10 offset:512
    ds_read_b128 v[76:79], v11 offset:512
    ds_read_b128 v[80:83], v12 offset:512
    ds_read_b128 v[84:87], v13 offset:512
    ds_read_b128 v[88:91], v14 offset:512
    s_waitcnt lgkmcnt(6)
    v_mfma_f32_32x32x16_bf16 v[96:111], v[192:195], v[64:67], v[96:111]
    ds_read_b128 v[92:95], v15 offset:512
    s_waitcnt lgkmcnt(6)
    v_mfma_f32_32x32x16_bf16 v[96:111], v[196:199], v[68:71], v[96:111]
    s_waitcnt lgkmcnt(5)
    v_mfma_f32_32x32x16_bf16 v[96:111], v[200:203], v[72:75], v[96:111]
    s_waitcnt lgkmcnt(4)
    v_mfma_f32_32x32x16_bf16 v[96:111], v[204:207], v[76:79], v[96:111]
    s_waitcnt lgkmcnt(3)
    v_mfma_f32_32x32x16_bf16 v[96:111], v[208:211], v[80:83], v[96:111]
    s_waitcnt lgkmcnt(2)
    v_mfma_f32_32x32x16_bf16 v[96:111], v[212:215], v[84:87], v[96:111]
    s_waitcnt lgkmcnt(1)
    v_mfma_f32_32x32x16_bf16 v[96:111], v[216:219], v[88:91], v[96:111]
    s_waitcnt lgkmcnt(0)
    v_mfma_f32_32x32x16_bf16 v[96:111], v[220:223], v[92:95], v[96:111]
    s_waitcnt vmcnt(8)
    s_barrier
    ds_read_b64_tr_b16 v[224:225], v6 offset:0
    ds_read_b64_tr_b16 v[226:227], v6 offset:1024
    ds_read_b64_tr_b16 v[228:229], v6 offset:4096
    ds_read_b64_tr_b16 v[230:231], v6 offset:5120
    ds_read_b64_tr_b16 v[232:233], v6 offset:8192
    ds_read_b64_tr_b16 v[234:235], v6 offset:9216
    ds_read_b64_tr_b16 v[236:237], v6 offset:12288
    ds_read_b64_tr_b16 v[238:239], v6 offset:13312
    ds_read_b64_tr_b16 v[240:241], v6 offset:16384
    ds_read_b64_tr_b16 v[242:243], v6 offset:17408
    ds_read_b64_tr_b16 v[244:245], v6 offset:20480
    ds_read_b64_tr_b16 v[246:247], v6 offset:21504
    ds_read_b64_tr_b16 v[248:249], v6 offset:24576
    ds_read_b64_tr_b16 v[250:251], v6 offset:25600
    ds_read_b64_tr_b16 v[252:253], v6 offset:28672
    ds_read_b64_tr_b16 v[254:255], v6 offset:29696
    s_waitcnt lgkmcnt(0)
    ds_read_b128 v[64:67], v8 offset:768
    ds_read_b128 v[68:71], v9 offset:768
    ds_read_b128 v[72:75], v10 offset:768
    ds_read_b128 v[76:79], v11 offset:768
    ds_read_b128 v[80:83], v12 offset:768
    ds_read_b128 v[84:87], v13 offset:768
    ds_read_b128 v[88:91], v14 offset:768
    s_waitcnt lgkmcnt(6)
    v_mfma_f32_32x32x16_bf16 v[96:111], v[224:227], v[64:67], v[96:111]
    ds_read_b128 v[92:95], v15 offset:768
    s_waitcnt lgkmcnt(6)
    v_mfma_f32_32x32x16_bf16 v[96:111], v[228:231], v[68:71], v[96:111]
    s_waitcnt lgkmcnt(5)
    v_mfma_f32_32x32x16_bf16 v[96:111], v[232:235], v[72:75], v[96:111]
    s_waitcnt lgkmcnt(4)
    v_mfma_f32_32x32x16_bf16 v[96:111], v[236:239], v[76:79], v[96:111]
    s_waitcnt lgkmcnt(3)
    v_mfma_f32_32x32x16_bf16 v[96:111], v[240:243], v[80:83], v[96:111]
    s_waitcnt lgkmcnt(2)
    v_mfma_f32_32x32x16_bf16 v[96:111], v[244:247], v[84:87], v[96:111]
    s_waitcnt lgkmcnt(1)
    v_mfma_f32_32x32x16_bf16 v[96:111], v[248:251], v[88:91], v[96:111]
    s_waitcnt lgkmcnt(0)
    v_mfma_f32_32x32x16_bf16 v[96:111], v[252:255], v[92:95], v[96:111]
    s_cmp_ge_u32 s2, 48
    s_cbranch_scc1 kv_kernel_mc2
    s_load_dwordx2 s[50:51], s[0:1], 104
    s_barrier
    v_lshlrev_b32 v64, 16, v60
    v_and_b32 v65, 0xffff0000, v60
    v_lshlrev_b32 v66, 16, v61
    v_and_b32 v67, 0xffff0000, v61
    v_lshlrev_b32 v68, 16, v62
    v_and_b32 v69, 0xffff0000, v62
    v_lshlrev_b32 v70, 16, v63
    v_and_b32 v71, 0xffff0000, v63
    v_mul_f32 v72, 0xbfb8aa3b, v64
    v_mul_f32 v73, 0xbfb8aa3b, v65
    v_mul_f32 v74, 0xbfb8aa3b, v66
    v_mul_f32 v75, 0xbfb8aa3b, v67
    v_mul_f32 v76, 0xbfb8aa3b, v68
    v_mul_f32 v77, 0xbfb8aa3b, v69
    v_mul_f32 v78, 0xbfb8aa3b, v70
    v_mul_f32 v79, 0xbfb8aa3b, v71
    v_exp_f32 v72, v72
    v_exp_f32 v73, v73
    v_exp_f32 v74, v74
    v_exp_f32 v75, v75
    v_exp_f32 v76, v76
    v_exp_f32 v77, v77
    v_exp_f32 v78, v78
    v_exp_f32 v79, v79
    s_nop 0
    v_add_f32 v72, 1.0, v72
    v_add_f32 v73, 1.0, v73
    v_add_f32 v74, 1.0, v74
    v_add_f32 v75, 1.0, v75
    v_add_f32 v76, 1.0, v76
    v_add_f32 v77, 1.0, v77
    v_add_f32 v78, 1.0, v78
    v_add_f32 v79, 1.0, v79
    v_rcp_f32 v72, v72
    v_rcp_f32 v73, v73
    v_rcp_f32 v74, v74
    v_rcp_f32 v75, v75
    v_rcp_f32 v76, v76
    v_rcp_f32 v77, v77
    v_rcp_f32 v78, v78
    v_rcp_f32 v79, v79
    s_nop 0
    v_mul_f32 v64, v64, v72
    v_mul_f32 v65, v65, v73
    v_mul_f32 v66, v66, v74
    v_mul_f32 v67, v67, v75
    v_mul_f32 v68, v68, v76
    v_mul_f32 v69, v69, v77
    v_mul_f32 v70, v70, v78
    v_mul_f32 v71, v71, v79
    v_cvt_pk_bf16_f32 v72, v64, v65
    v_cvt_pk_bf16_f32 v73, v66, v67
    v_cvt_pk_bf16_f32 v74, v68, v69
    v_cvt_pk_bf16_f32 v75, v70, v71
    v_lshlrev_b32 v64, 16, v72
    v_and_b32 v65, 0xffff0000, v72
    v_lshlrev_b32 v66, 16, v73
    v_and_b32 v67, 0xffff0000, v73
    v_lshlrev_b32 v68, 16, v74
    v_and_b32 v69, 0xffff0000, v74
    v_lshlrev_b32 v70, 16, v75
    v_and_b32 v71, 0xffff0000, v75
    v_mov_b32 v80, 0
    v_mov_b32 v81, 0
    v_mov_b32 v82, 0
    v_mov_b32 v83, 0
    v_mov_b32 v84, 0
    v_mov_b32 v85, 0
    v_mov_b32 v86, 0
    v_mov_b32 v87, 0
    v_lshlrev_b32 v88, 16, v24
    v_and_b32 v89, 0xffff0000, v24
    v_fmac_f32 v80, v88, v64
    v_fmac_f32 v81, v89, v64
    v_lshlrev_b32 v88, 16, v25
    v_and_b32 v89, 0xffff0000, v25
    v_fmac_f32 v82, v88, v64
    v_fmac_f32 v83, v89, v64
    v_lshlrev_b32 v88, 16, v26
    v_and_b32 v89, 0xffff0000, v26
    v_fmac_f32 v84, v88, v64
    v_fmac_f32 v85, v89, v64
    v_lshlrev_b32 v88, 16, v27
    v_and_b32 v89, 0xffff0000, v27
    v_fmac_f32 v86, v88, v64
    v_fmac_f32 v87, v89, v64
    v_lshlrev_b32 v88, 16, v28
    v_and_b32 v89, 0xffff0000, v28
    v_fmac_f32 v80, v88, v65
    v_fmac_f32 v81, v89, v65
    v_lshlrev_b32 v88, 16, v29
    v_and_b32 v89, 0xffff0000, v29
    v_fmac_f32 v82, v88, v65
    v_fmac_f32 v83, v89, v65
    v_lshlrev_b32 v88, 16, v30
    v_and_b32 v89, 0xffff0000, v30
    v_fmac_f32 v84, v88, v65
    v_fmac_f32 v85, v89, v65
    v_lshlrev_b32 v88, 16, v31
    v_and_b32 v89, 0xffff0000, v31
    v_fmac_f32 v86, v88, v65
    v_fmac_f32 v87, v89, v65
    v_lshlrev_b32 v88, 16, v32
    v_and_b32 v89, 0xffff0000, v32
    v_fmac_f32 v80, v88, v66
    v_fmac_f32 v81, v89, v66
    v_lshlrev_b32 v88, 16, v33
    v_and_b32 v89, 0xffff0000, v33
    v_fmac_f32 v82, v88, v66
    v_fmac_f32 v83, v89, v66
    v_lshlrev_b32 v88, 16, v34
    v_and_b32 v89, 0xffff0000, v34
    v_fmac_f32 v84, v88, v66
    v_fmac_f32 v85, v89, v66
    v_lshlrev_b32 v88, 16, v35
    v_and_b32 v89, 0xffff0000, v35
    v_fmac_f32 v86, v88, v66
    v_fmac_f32 v87, v89, v66
    v_lshlrev_b32 v88, 16, v36
    v_and_b32 v89, 0xffff0000, v36
    v_fmac_f32 v80, v88, v67
    v_fmac_f32 v81, v89, v67
    v_lshlrev_b32 v88, 16, v37
    v_and_b32 v89, 0xffff0000, v37
    v_fmac_f32 v82, v88, v67
    v_fmac_f32 v83, v89, v67
    v_lshlrev_b32 v88, 16, v38
    v_and_b32 v89, 0xffff0000, v38
    v_fmac_f32 v84, v88, v67
    v_fmac_f32 v85, v89, v67
    v_lshlrev_b32 v88, 16, v39
    v_and_b32 v89, 0xffff0000, v39
    v_fmac_f32 v86, v88, v67
    v_fmac_f32 v87, v89, v67
    v_lshlrev_b32 v88, 16, v40
    v_and_b32 v89, 0xffff0000, v40
    v_fmac_f32 v80, v88, v68
    v_fmac_f32 v81, v89, v68
    v_lshlrev_b32 v88, 16, v41
    v_and_b32 v89, 0xffff0000, v41
    v_fmac_f32 v82, v88, v68
    v_fmac_f32 v83, v89, v68
    v_lshlrev_b32 v88, 16, v42
    v_and_b32 v89, 0xffff0000, v42
    v_fmac_f32 v84, v88, v68
    v_fmac_f32 v85, v89, v68
    v_lshlrev_b32 v88, 16, v43
    v_and_b32 v89, 0xffff0000, v43
    v_fmac_f32 v86, v88, v68
    v_fmac_f32 v87, v89, v68
    v_lshlrev_b32 v88, 16, v44
    v_and_b32 v89, 0xffff0000, v44
    v_fmac_f32 v80, v88, v69
    v_fmac_f32 v81, v89, v69
    v_lshlrev_b32 v88, 16, v45
    v_and_b32 v89, 0xffff0000, v45
    v_fmac_f32 v82, v88, v69
    v_fmac_f32 v83, v89, v69
    v_lshlrev_b32 v88, 16, v46
    v_and_b32 v89, 0xffff0000, v46
    v_fmac_f32 v84, v88, v69
    v_fmac_f32 v85, v89, v69
    v_lshlrev_b32 v88, 16, v47
    v_and_b32 v89, 0xffff0000, v47
    v_fmac_f32 v86, v88, v69
    v_fmac_f32 v87, v89, v69
    v_lshlrev_b32 v88, 16, v48
    v_and_b32 v89, 0xffff0000, v48
    v_fmac_f32 v80, v88, v70
    v_fmac_f32 v81, v89, v70
    v_lshlrev_b32 v88, 16, v49
    v_and_b32 v89, 0xffff0000, v49
    v_fmac_f32 v82, v88, v70
    v_fmac_f32 v83, v89, v70
    v_lshlrev_b32 v88, 16, v50
    v_and_b32 v89, 0xffff0000, v50
    v_fmac_f32 v84, v88, v70
    v_fmac_f32 v85, v89, v70
    v_lshlrev_b32 v88, 16, v51
    v_and_b32 v89, 0xffff0000, v51
    v_fmac_f32 v86, v88, v70
    v_fmac_f32 v87, v89, v70
    v_lshlrev_b32 v88, 16, v52
    v_and_b32 v89, 0xffff0000, v52
    v_fmac_f32 v80, v88, v71
    v_fmac_f32 v81, v89, v71
    v_lshlrev_b32 v88, 16, v53
    v_and_b32 v89, 0xffff0000, v53
    v_fmac_f32 v82, v88, v71
    v_fmac_f32 v83, v89, v71
    v_lshlrev_b32 v88, 16, v54
    v_and_b32 v89, 0xffff0000, v54
    v_fmac_f32 v84, v88, v71
    v_fmac_f32 v85, v89, v71
    v_lshlrev_b32 v88, 16, v55
    v_and_b32 v89, 0xffff0000, v55
    v_fmac_f32 v86, v88, v71
    v_fmac_f32 v87, v89, v71
    v_and_b32 v90, 7, v0
    v_lshrrev_b32 v91, 3, v0
    v_lshlrev_b32 v91, 8, v91
    v_lshlrev_b32 v90, 5, v90
    v_add_u32 v90, v90, v91
    v_add_u32 v90, 131072, v90
    ds_write_b128 v90, v[80:83]
    ds_write_b128 v90, v[84:87] offset:16
    s_waitcnt lgkmcnt(0)
    s_barrier
    s_lshl_b32 s53, s30, 11
    v_lshlrev_b32 v91, 2, v1
    v_add_u32 v90, s53, v91
    v_add_u32 v90, 131072, v90
    ds_read_b32 v64, v90 offset:0
    ds_read_b32 v65, v90 offset:256
    ds_read_b32 v66, v90 offset:512
    ds_read_b32 v67, v90 offset:768
    ds_read_b32 v68, v90 offset:1024
    ds_read_b32 v69, v90 offset:1280
    ds_read_b32 v70, v90 offset:1536
    ds_read_b32 v71, v90 offset:1792
    s_waitcnt lgkmcnt(0)
    v_add_f32 v64, v64, v65
    v_add_f32 v64, v64, v66
    v_add_f32 v64, v64, v67
    v_add_f32 v64, v64, v68
    v_add_f32 v64, v64, v69
    v_add_f32 v64, v64, v70
    v_add_f32 v64, v64, v71
    s_lshl_b32 s53, s30, 8
    v_add_u32 v90, s53, v91
    v_add_u32 v90, 147456, v90
    ds_write_b32 v90, v64
    s_waitcnt lgkmcnt(0)
    s_barrier
    s_cmp_eq_u32 s30, 0
    s_cbranch_scc0 kv_kernel_mc2
    v_add_u32 v90, 147456, v91
    ds_read_b32 v64, v90 offset:0
    ds_read_b32 v65, v90 offset:256
    ds_read_b32 v66, v90 offset:512
    ds_read_b32 v67, v90 offset:768
    ds_read_b32 v68, v90 offset:1024
    ds_read_b32 v69, v90 offset:1280
    ds_read_b32 v70, v90 offset:1536
    ds_read_b32 v71, v90 offset:1792
    s_waitcnt lgkmcnt(0)
    v_add_f32 v64, v64, v65
    v_add_f32 v64, v64, v66
    v_add_f32 v64, v64, v67
    v_add_f32 v64, v64, v68
    v_add_f32 v64, v64, v69
    v_add_f32 v64, v64, v70
    v_add_f32 v64, v64, v71
    s_lshl_b32 s53, s2, 8
    v_add_u32 v91, s53, v91
    global_store_dword v91, v64, s[8:9] sc0 sc1
    s_waitcnt vmcnt(0)
    s_mov_b64 exec, 1
    v_mov_b32 v88, 0
    v_mov_b32 v89, 1
    global_atomic_add v88, v89, s[50:51] offset:64
    s_mov_b64 exec, -1
kv_kernel_mc2:
    v_xor_b32 v8, 0x10000, v8
    v_xor_b32 v9, 0x10000, v9
    v_xor_b32 v10, 0x10000, v10
    v_xor_b32 v11, 0x10000, v11
    v_xor_b32 v12, 0x10000, v12
    v_xor_b32 v13, 0x10000, v13
    v_xor_b32 v14, 0x10000, v14
    v_xor_b32 v15, 0x10000, v15
    s_waitcnt vmcnt(0)
    s_barrier
    ds_read_b128 v[64:67], v8 offset:0
    ds_read_b128 v[68:71], v9 offset:0
    ds_read_b128 v[72:75], v10 offset:0
    ds_read_b128 v[76:79], v11 offset:0
    ds_read_b128 v[80:83], v12 offset:0
    ds_read_b128 v[84:87], v13 offset:0
    ds_read_b128 v[88:91], v14 offset:0
    s_waitcnt lgkmcnt(6)
    v_mfma_f32_32x32x16_bf16 v[112:127], v[128:131], v[64:67], 0
    ds_read_b128 v[92:95], v15 offset:0
    s_waitcnt lgkmcnt(6)
    v_mfma_f32_32x32x16_bf16 v[112:127], v[132:135], v[68:71], v[112:127]
    s_add_u32 m0, s44, 0
    s_add_u32 s46, s43, 131072
    buffer_load_dwordx4 v16, s[12:15], s46 offen offset:0 lds
    ds_read_b128 v[64:67], v8 offset:256
    s_waitcnt lgkmcnt(6)
    v_mfma_f32_32x32x16_bf16 v[112:127], v[136:139], v[72:75], v[112:127]
    ds_read_b128 v[68:71], v9 offset:256
    s_waitcnt lgkmcnt(6)
    v_mfma_f32_32x32x16_bf16 v[112:127], v[140:143], v[76:79], v[112:127]
    ds_read_b128 v[72:75], v10 offset:256
    s_waitcnt lgkmcnt(6)
    v_mfma_f32_32x32x16_bf16 v[112:127], v[144:147], v[80:83], v[112:127]
    buffer_load_dwordx4 v17, s[12:15], s46 offen offset:1024 lds
    ds_read_b128 v[76:79], v11 offset:256
    s_waitcnt lgkmcnt(6)
    v_mfma_f32_32x32x16_bf16 v[112:127], v[148:151], v[84:87], v[112:127]
    ds_read_b128 v[80:83], v12 offset:256
    s_waitcnt lgkmcnt(6)
    v_mfma_f32_32x32x16_bf16 v[112:127], v[152:155], v[88:91], v[112:127]
    ds_read_b128 v[84:87], v13 offset:256
    s_waitcnt lgkmcnt(6)
    v_mfma_f32_32x32x16_bf16 v[112:127], v[156:159], v[92:95], v[112:127]
    buffer_load_dwordx4 v18, s[12:15], s46 offen offset:2048 lds
    ds_read_b128 v[88:91], v14 offset:256
    s_waitcnt lgkmcnt(6)
    v_mfma_f32_32x32x16_bf16 v[112:127], v[160:163], v[64:67], v[112:127]
    ds_read_b128 v[92:95], v15 offset:256
    s_waitcnt lgkmcnt(6)
    v_mfma_f32_32x32x16_bf16 v[112:127], v[164:167], v[68:71], v[112:127]
    ds_read_b128 v[64:67], v8 offset:512
    s_waitcnt lgkmcnt(6)
    v_mfma_f32_32x32x16_bf16 v[112:127], v[168:171], v[72:75], v[112:127]
    buffer_load_dwordx4 v19, s[12:15], s46 offen offset:3072 lds
    ds_read_b128 v[68:71], v9 offset:512
    s_waitcnt lgkmcnt(6)
    v_mfma_f32_32x32x16_bf16 v[112:127], v[172:175], v[76:79], v[112:127]
    ds_read_b128 v[72:75], v10 offset:512
    s_waitcnt lgkmcnt(6)
    v_mfma_f32_32x32x16_bf16 v[112:127], v[176:179], v[80:83], v[112:127]
    ds_read_b128 v[76:79], v11 offset:512
    s_waitcnt lgkmcnt(6)
    v_mfma_f32_32x32x16_bf16 v[112:127], v[180:183], v[84:87], v[112:127]
    s_add_u32 m0, s44, 4096
    s_add_u32 s46, s43, 135168
    buffer_load_dwordx4 v20, s[12:15], s46 offen offset:0 lds
    ds_read_b128 v[80:83], v12 offset:512
    s_waitcnt lgkmcnt(6)
    v_mfma_f32_32x32x16_bf16 v[112:127], v[184:187], v[88:91], v[112:127]
    ds_read_b128 v[84:87], v13 offset:512
    s_waitcnt lgkmcnt(6)
    v_mfma_f32_32x32x16_bf16 v[112:127], v[188:191], v[92:95], v[112:127]
    ds_read_b128 v[88:91], v14 offset:512
    s_waitcnt lgkmcnt(6)
    v_mfma_f32_32x32x16_bf16 v[112:127], v[192:195], v[64:67], v[112:127]
    buffer_load_dwordx4 v21, s[12:15], s46 offen offset:1024 lds
    ds_read_b128 v[92:95], v15 offset:512
    s_waitcnt lgkmcnt(6)
    v_mfma_f32_32x32x16_bf16 v[112:127], v[196:199], v[68:71], v[112:127]
    ds_read_b128 v[64:67], v8 offset:768
    s_waitcnt lgkmcnt(6)
    v_mfma_f32_32x32x16_bf16 v[112:127], v[200:203], v[72:75], v[112:127]
    ds_read_b128 v[68:71], v9 offset:768
    s_waitcnt lgkmcnt(6)
    v_mfma_f32_32x32x16_bf16 v[112:127], v[204:207], v[76:79], v[112:127]
    buffer_load_dwordx4 v22, s[12:15], s46 offen offset:2048 lds
    ds_read_b128 v[72:75], v10 offset:768
    s_waitcnt lgkmcnt(6)
    v_mfma_f32_32x32x16_bf16 v[112:127], v[208:211], v[80:83], v[112:127]
    ds_read_b128 v[76:79], v11 offset:768
    s_waitcnt lgkmcnt(6)
    v_mfma_f32_32x32x16_bf16 v[112:127], v[212:215], v[84:87], v[112:127]
    ds_read_b128 v[80:83], v12 offset:768
    s_waitcnt lgkmcnt(6)
    v_mfma_f32_32x32x16_bf16 v[112:127], v[216:219], v[88:91], v[112:127]
    buffer_load_dwordx4 v23, s[12:15], s46 offen offset:3072 lds
    ds_read_b128 v[84:87], v13 offset:768
    s_waitcnt lgkmcnt(6)
    v_mfma_f32_32x32x16_bf16 v[112:127], v[220:223], v[92:95], v[112:127]
    ds_read_b128 v[88:91], v14 offset:768
    s_waitcnt lgkmcnt(6)
    v_mfma_f32_32x32x16_bf16 v[112:127], v[224:227], v[64:67], v[112:127]
    ds_read_b128 v[92:95], v15 offset:768
    s_waitcnt lgkmcnt(6)
    v_mfma_f32_32x32x16_bf16 v[112:127], v[228:231], v[68:71], v[112:127]
    s_waitcnt lgkmcnt(5)
    v_mfma_f32_32x32x16_bf16 v[112:127], v[232:235], v[72:75], v[112:127]
    s_waitcnt lgkmcnt(4)
    v_mfma_f32_32x32x16_bf16 v[112:127], v[236:239], v[76:79], v[112:127]
    s_waitcnt lgkmcnt(3)
    v_mfma_f32_32x32x16_bf16 v[112:127], v[240:243], v[80:83], v[112:127]
    v_cvt_pk_bf16_f32 v56, v96, v97
    v_cvt_pk_bf16_f32 v57, v98, v99
    v_cvt_pk_bf16_f32 v58, v100, v101
    v_cvt_pk_bf16_f32 v59, v102, v103
    v_cvt_pk_bf16_f32 v60, v104, v105
    v_cvt_pk_bf16_f32 v61, v106, v107
    v_cvt_pk_bf16_f32 v62, v108, v109
    v_cvt_pk_bf16_f32 v63, v110, v111
    s_add_u32 s47, s45, 0
    buffer_store_dwordx4 v[56:59], v4, s[20:23], s47 offen sc1
    buffer_store_dwordx4 v[60:63], v4, s[20:23], s47 offen offset:1024 sc1
    s_waitcnt lgkmcnt(2)
    v_mfma_f32_32x32x16_bf16 v[112:127], v[244:247], v[84:87], v[112:127]
    s_waitcnt lgkmcnt(1)
    v_mfma_f32_32x32x16_bf16 v[112:127], v[248:251], v[88:91], v[112:127]
    s_waitcnt lgkmcnt(0)
    v_mfma_f32_32x32x16_bf16 v[112:127], v[252:255], v[92:95], v[112:127]
    v_xor_b32 v8, 0x10000, v8
    v_xor_b32 v9, 0x10000, v9
    v_xor_b32 v10, 0x10000, v10
    v_xor_b32 v11, 0x10000, v11
    v_xor_b32 v12, 0x10000, v12
    v_xor_b32 v13, 0x10000, v13
    v_xor_b32 v14, 0x10000, v14
    v_xor_b32 v15, 0x10000, v15
    s_waitcnt vmcnt(2)
    s_barrier
    ds_read_b128 v[64:67], v8 offset:0
    ds_read_b128 v[68:71], v9 offset:0
    ds_read_b128 v[72:75], v10 offset:0
    ds_read_b128 v[76:79], v11 offset:0
    ds_read_b128 v[80:83], v12 offset:0
    ds_read_b128 v[84:87], v13 offset:0
    ds_read_b128 v[88:91], v14 offset:0
    s_waitcnt lgkmcnt(6)
    v_mfma_f32_32x32x16_bf16 v[96:111], v[128:131], v[64:67], 0
    ds_read_b128 v[92:95], v15 offset:0
    s_waitcnt lgkmcnt(6)
    v_mfma_f32_32x32x16_bf16 v[96:111], v[132:135], v[68:71], v[96:111]
    s_add_u32 m0, s44, 65536
    s_add_u32 s46, s43, 196608
    buffer_load_dwordx4 v16, s[12:15], s46 offen offset:0 lds
    ds_read_b128 v[64:67], v8 offset:256
    s_waitcnt lgkmcnt(6)
    v_mfma_f32_32x32x16_bf16 v[96:111], v[136:139], v[72:75], v[96:111]
    ds_read_b128 v[68:71], v9 offset:256
    s_waitcnt lgkmcnt(6)
    v_mfma_f32_32x32x16_bf16 v[96:111], v[140:143], v[76:79], v[96:111]
    ds_read_b128 v[72:75], v10 offset:256
    s_waitcnt lgkmcnt(6)
    v_mfma_f32_32x32x16_bf16 v[96:111], v[144:147], v[80:83], v[96:111]
    buffer_load_dwordx4 v17, s[12:15], s46 offen offset:1024 lds
    ds_read_b128 v[76:79], v11 offset:256
    s_waitcnt lgkmcnt(6)
    v_mfma_f32_32x32x16_bf16 v[96:111], v[148:151], v[84:87], v[96:111]
    ds_read_b128 v[80:83], v12 offset:256
    s_waitcnt lgkmcnt(6)
    v_mfma_f32_32x32x16_bf16 v[96:111], v[152:155], v[88:91], v[96:111]
    ds_read_b128 v[84:87], v13 offset:256
    s_waitcnt lgkmcnt(6)
    v_mfma_f32_32x32x16_bf16 v[96:111], v[156:159], v[92:95], v[96:111]
    buffer_load_dwordx4 v18, s[12:15], s46 offen offset:2048 lds
    ds_read_b128 v[88:91], v14 offset:256
    s_waitcnt lgkmcnt(6)
    v_mfma_f32_32x32x16_bf16 v[96:111], v[160:163], v[64:67], v[96:111]
    ds_read_b128 v[92:95], v15 offset:256
    s_waitcnt lgkmcnt(6)
    v_mfma_f32_32x32x16_bf16 v[96:111], v[164:167], v[68:71], v[96:111]
    ds_read_b128 v[64:67], v8 offset:512
    s_waitcnt lgkmcnt(6)
    v_mfma_f32_32x32x16_bf16 v[96:111], v[168:171], v[72:75], v[96:111]
    buffer_load_dwordx4 v19, s[12:15], s46 offen offset:3072 lds
    ds_read_b128 v[68:71], v9 offset:512
    s_waitcnt lgkmcnt(6)
    v_mfma_f32_32x32x16_bf16 v[96:111], v[172:175], v[76:79], v[96:111]
    ds_read_b128 v[72:75], v10 offset:512
    s_waitcnt lgkmcnt(6)
    v_mfma_f32_32x32x16_bf16 v[96:111], v[176:179], v[80:83], v[96:111]
    ds_read_b128 v[76:79], v11 offset:512
    s_waitcnt lgkmcnt(6)
    v_mfma_f32_32x32x16_bf16 v[96:111], v[180:183], v[84:87], v[96:111]
    s_add_u32 m0, s44, 69632
    s_add_u32 s46, s43, 200704
    buffer_load_dwordx4 v20, s[12:15], s46 offen offset:0 lds
    ds_read_b128 v[80:83], v12 offset:512
    s_waitcnt lgkmcnt(6)
    v_mfma_f32_32x32x16_bf16 v[96:111], v[184:187], v[88:91], v[96:111]
    ds_read_b128 v[84:87], v13 offset:512
    s_waitcnt lgkmcnt(6)
    v_mfma_f32_32x32x16_bf16 v[96:111], v[188:191], v[92:95], v[96:111]
    ds_read_b128 v[88:91], v14 offset:512
    s_waitcnt lgkmcnt(6)
    v_mfma_f32_32x32x16_bf16 v[96:111], v[192:195], v[64:67], v[96:111]
    buffer_load_dwordx4 v21, s[12:15], s46 offen offset:1024 lds
    ds_read_b128 v[92:95], v15 offset:512
    s_waitcnt lgkmcnt(6)
    v_mfma_f32_32x32x16_bf16 v[96:111], v[196:199], v[68:71], v[96:111]
    ds_read_b128 v[64:67], v8 offset:768
    s_waitcnt lgkmcnt(6)
    v_mfma_f32_32x32x16_bf16 v[96:111], v[200:203], v[72:75], v[96:111]
    ds_read_b128 v[68:71], v9 offset:768
    s_waitcnt lgkmcnt(6)
    v_mfma_f32_32x32x16_bf16 v[96:111], v[204:207], v[76:79], v[96:111]
    buffer_load_dwordx4 v22, s[12:15], s46 offen offset:2048 lds
    ds_read_b128 v[72:75], v10 offset:768
    s_waitcnt lgkmcnt(6)
    v_mfma_f32_32x32x16_bf16 v[96:111], v[208:211], v[80:83], v[96:111]
    ds_read_b128 v[76:79], v11 offset:768
    s_waitcnt lgkmcnt(6)
    v_mfma_f32_32x32x16_bf16 v[96:111], v[212:215], v[84:87], v[96:111]
    ds_read_b128 v[80:83], v12 offset:768
    s_waitcnt lgkmcnt(6)
    v_mfma_f32_32x32x16_bf16 v[96:111], v[216:219], v[88:91], v[96:111]
    buffer_load_dwordx4 v23, s[12:15], s46 offen offset:3072 lds
    ds_read_b128 v[84:87], v13 offset:768
    s_waitcnt lgkmcnt(6)
    v_mfma_f32_32x32x16_bf16 v[96:111], v[220:223], v[92:95], v[96:111]
    ds_read_b128 v[88:91], v14 offset:768
    s_waitcnt lgkmcnt(6)
    v_mfma_f32_32x32x16_bf16 v[96:111], v[224:227], v[64:67], v[96:111]
    ds_read_b128 v[92:95], v15 offset:768
    s_waitcnt lgkmcnt(6)
    v_mfma_f32_32x32x16_bf16 v[96:111], v[228:231], v[68:71], v[96:111]
    s_waitcnt lgkmcnt(5)
    v_mfma_f32_32x32x16_bf16 v[96:111], v[232:235], v[72:75], v[96:111]
    s_waitcnt lgkmcnt(4)
    v_mfma_f32_32x32x16_bf16 v[96:111], v[236:239], v[76:79], v[96:111]
    s_waitcnt lgkmcnt(3)
    v_mfma_f32_32x32x16_bf16 v[96:111], v[240:243], v[80:83], v[96:111]
    v_cvt_pk_bf16_f32 v56, v112, v113
    v_cvt_pk_bf16_f32 v57, v114, v115
    v_cvt_pk_bf16_f32 v58, v116, v117
    v_cvt_pk_bf16_f32 v59, v118, v119
    v_cvt_pk_bf16_f32 v60, v120, v121
    v_cvt_pk_bf16_f32 v61, v122, v123
    v_cvt_pk_bf16_f32 v62, v124, v125
    v_cvt_pk_bf16_f32 v63, v126, v127
    s_add_u32 s47, s45, 32768
    buffer_store_dwordx4 v[56:59], v4, s[20:23], s47 offen sc1
    buffer_store_dwordx4 v[60:63], v4, s[20:23], s47 offen offset:1024 sc1
    s_waitcnt lgkmcnt(2)
    v_mfma_f32_32x32x16_bf16 v[96:111], v[244:247], v[84:87], v[96:111]
    s_waitcnt lgkmcnt(1)
    v_mfma_f32_32x32x16_bf16 v[96:111], v[248:251], v[88:91], v[96:111]
    s_waitcnt lgkmcnt(0)
    v_mfma_f32_32x32x16_bf16 v[96:111], v[252:255], v[92:95], v[96:111]
    v_xor_b32 v8, 0x10000, v8
    v_xor_b32 v9, 0x10000, v9
    v_xor_b32 v10, 0x10000, v10
    v_xor_b32 v11, 0x10000, v11
    v_xor_b32 v12, 0x10000, v12
    v_xor_b32 v13, 0x10000, v13
    v_xor_b32 v14, 0x10000, v14
    v_xor_b32 v15, 0x10000, v15
    s_waitcnt vmcnt(2)
    s_barrier
    s_load_dwordx2 s[50:51], s[0:1], 16
    v_lshlrev_b32 v24, 4, v0
    s_lshl_b32 s49, s2, 13
    v_add_u32 v24, s49, v24
    v_add_u32 v25, 0x200000, v24
    s_waitcnt lgkmcnt(0)
    global_load_dwordx4 v[28:31], v24, s[50:51]
    global_load_dwordx4 v[32:35], v25, s[50:51]
    ds_read_b128 v[64:67], v8 offset:0
    ds_read_b128 v[68:71], v9 offset:0
    ds_read_b128 v[72:75], v10 offset:0
    ds_read_b128 v[76:79], v11 offset:0
    ds_read_b128 v[80:83], v12 offset:0
    ds_read_b128 v[84:87], v13 offset:0
    ds_read_b128 v[88:91], v14 offset:0
    s_waitcnt lgkmcnt(6)
    v_mfma_f32_32x32x16_bf16 v[112:127], v[128:131], v[64:67], 0
    ds_read_b128 v[92:95], v15 offset:0
    s_waitcnt lgkmcnt(6)
    v_mfma_f32_32x32x16_bf16 v[112:127], v[132:135], v[68:71], v[112:127]
    s_add_u32 m0, s44, 0
    s_add_u32 s46, s43, 262144
    buffer_load_dwordx4 v16, s[12:15], s46 offen offset:0 lds
    ds_read_b128 v[64:67], v8 offset:256
    s_waitcnt lgkmcnt(6)
    v_mfma_f32_32x32x16_bf16 v[112:127], v[136:139], v[72:75], v[112:127]
    ds_read_b128 v[68:71], v9 offset:256
    s_waitcnt lgkmcnt(6)
    v_mfma_f32_32x32x16_bf16 v[112:127], v[140:143], v[76:79], v[112:127]
    ds_read_b128 v[72:75], v10 offset:256
    s_waitcnt lgkmcnt(6)
    v_mfma_f32_32x32x16_bf16 v[112:127], v[144:147], v[80:83], v[112:127]
    buffer_load_dwordx4 v17, s[12:15], s46 offen offset:1024 lds
    ds_read_b128 v[76:79], v11 offset:256
    s_waitcnt lgkmcnt(6)
    v_mfma_f32_32x32x16_bf16 v[112:127], v[148:151], v[84:87], v[112:127]
    ds_read_b128 v[80:83], v12 offset:256
    s_waitcnt lgkmcnt(6)
    v_mfma_f32_32x32x16_bf16 v[112:127], v[152:155], v[88:91], v[112:127]
    ds_read_b128 v[84:87], v13 offset:256
    s_waitcnt lgkmcnt(6)
    v_mfma_f32_32x32x16_bf16 v[112:127], v[156:159], v[92:95], v[112:127]
    buffer_load_dwordx4 v18, s[12:15], s46 offen offset:2048 lds
    ds_read_b128 v[88:91], v14 offset:256
    s_waitcnt lgkmcnt(6)
    v_mfma_f32_32x32x16_bf16 v[112:127], v[160:163], v[64:67], v[112:127]
    ds_read_b128 v[92:95], v15 offset:256
    s_waitcnt lgkmcnt(6)
    v_mfma_f32_32x32x16_bf16 v[112:127], v[164:167], v[68:71], v[112:127]
    ds_read_b128 v[64:67], v8 offset:512
    s_waitcnt lgkmcnt(6)
    v_mfma_f32_32x32x16_bf16 v[112:127], v[168:171], v[72:75], v[112:127]
    buffer_load_dwordx4 v19, s[12:15], s46 offen offset:3072 lds
    ds_read_b128 v[68:71], v9 offset:512
    s_waitcnt lgkmcnt(6)
    v_mfma_f32_32x32x16_bf16 v[112:127], v[172:175], v[76:79], v[112:127]
    ds_read_b128 v[72:75], v10 offset:512
    s_waitcnt lgkmcnt(6)
    v_mfma_f32_32x32x16_bf16 v[112:127], v[176:179], v[80:83], v[112:127]
    ds_read_b128 v[76:79], v11 offset:512
    s_waitcnt lgkmcnt(6)
    v_mfma_f32_32x32x16_bf16 v[112:127], v[180:183], v[84:87], v[112:127]
    s_add_u32 m0, s44, 4096
    s_add_u32 s46, s43, 266240
    buffer_load_dwordx4 v20, s[12:15], s46 offen offset:0 lds
    ds_read_b128 v[80:83], v12 offset:512
    s_waitcnt lgkmcnt(6)
    v_mfma_f32_32x32x16_bf16 v[112:127], v[184:187], v[88:91], v[112:127]
    ds_read_b128 v[84:87], v13 offset:512
    s_waitcnt lgkmcnt(6)
    v_mfma_f32_32x32x16_bf16 v[112:127], v[188:191], v[92:95], v[112:127]
    ds_read_b128 v[88:91], v14 offset:512
    s_waitcnt lgkmcnt(6)
    v_mfma_f32_32x32x16_bf16 v[112:127], v[192:195], v[64:67], v[112:127]
    buffer_load_dwordx4 v21, s[12:15], s46 offen offset:1024 lds
    ds_read_b128 v[92:95], v15 offset:512
    s_waitcnt lgkmcnt(6)
    v_mfma_f32_32x32x16_bf16 v[112:127], v[196:199], v[68:71], v[112:127]
    ds_read_b128 v[64:67], v8 offset:768
    s_waitcnt lgkmcnt(6)
    v_mfma_f32_32x32x16_bf16 v[112:127], v[200:203], v[72:75], v[112:127]
    ds_read_b128 v[68:71], v9 offset:768
    s_waitcnt lgkmcnt(6)
    v_mfma_f32_32x32x16_bf16 v[112:127], v[204:207], v[76:79], v[112:127]
    buffer_load_dwordx4 v22, s[12:15], s46 offen offset:2048 lds
    ds_read_b128 v[72:75], v10 offset:768
    s_waitcnt lgkmcnt(6)
    v_mfma_f32_32x32x16_bf16 v[112:127], v[208:211], v[80:83], v[112:127]
    ds_read_b128 v[76:79], v11 offset:768
    s_waitcnt lgkmcnt(6)
    v_mfma_f32_32x32x16_bf16 v[112:127], v[212:215], v[84:87], v[112:127]
    ds_read_b128 v[80:83], v12 offset:768
    s_waitcnt lgkmcnt(6)
    v_mfma_f32_32x32x16_bf16 v[112:127], v[216:219], v[88:91], v[112:127]
    buffer_load_dwordx4 v23, s[12:15], s46 offen offset:3072 lds
    ds_read_b128 v[84:87], v13 offset:768
    s_waitcnt lgkmcnt(6)
    v_mfma_f32_32x32x16_bf16 v[112:127], v[220:223], v[92:95], v[112:127]
    ds_read_b128 v[88:91], v14 offset:768
    s_waitcnt lgkmcnt(6)
    v_mfma_f32_32x32x16_bf16 v[112:127], v[224:227], v[64:67], v[112:127]
    ds_read_b128 v[92:95], v15 offset:768
    s_waitcnt lgkmcnt(6)
    v_mfma_f32_32x32x16_bf16 v[112:127], v[228:231], v[68:71], v[112:127]
    s_waitcnt lgkmcnt(5)
    v_mfma_f32_32x32x16_bf16 v[112:127], v[232:235], v[72:75], v[112:127]
    s_waitcnt lgkmcnt(4)
    v_mfma_f32_32x32x16_bf16 v[112:127], v[236:239], v[76:79], v[112:127]
    s_waitcnt lgkmcnt(3)
    v_mfma_f32_32x32x16_bf16 v[112:127], v[240:243], v[80:83], v[112:127]
    v_cvt_pk_bf16_f32 v56, v96, v97
    v_cvt_pk_bf16_f32 v57, v98, v99
    v_cvt_pk_bf16_f32 v58, v100, v101
    v_cvt_pk_bf16_f32 v59, v102, v103
    v_cvt_pk_bf16_f32 v60, v104, v105
    v_cvt_pk_bf16_f32 v61, v106, v107
    v_cvt_pk_bf16_f32 v62, v108, v109
    v_cvt_pk_bf16_f32 v63, v110, v111
    s_add_u32 s47, s45, 65536
    buffer_store_dwordx4 v[56:59], v4, s[20:23], s47 offen sc1
    buffer_store_dwordx4 v[60:63], v4, s[20:23], s47 offen offset:1024 sc1
    s_waitcnt lgkmcnt(2)
    v_mfma_f32_32x32x16_bf16 v[112:127], v[244:247], v[84:87], v[112:127]
    s_waitcnt lgkmcnt(1)
    v_mfma_f32_32x32x16_bf16 v[112:127], v[248:251], v[88:91], v[112:127]
    s_waitcnt lgkmcnt(0)
    v_mfma_f32_32x32x16_bf16 v[112:127], v[252:255], v[92:95], v[112:127]
    v_xor_b32 v8, 0x10000, v8
    v_xor_b32 v9, 0x10000, v9
    v_xor_b32 v10, 0x10000, v10
    v_xor_b32 v11, 0x10000, v11
    v_xor_b32 v12, 0x10000, v12
    v_xor_b32 v13, 0x10000, v13
    v_xor_b32 v14, 0x10000, v14
    v_xor_b32 v15, 0x10000, v15
    s_waitcnt vmcnt(2)
    s_barrier
    ds_read_b128 v[64:67], v8 offset:0
    ds_read_b128 v[68:71], v9 offset:0
    ds_read_b128 v[72:75], v10 offset:0
    ds_read_b128 v[76:79], v11 offset:0
    ds_read_b128 v[80:83], v12 offset:0
    ds_read_b128 v[84:87], v13 offset:0
    ds_read_b128 v[88:91], v14 offset:0
    s_waitcnt lgkmcnt(6)
    v_mfma_f32_32x32x16_bf16 v[96:111], v[128:131], v[64:67], 0
    ds_read_b128 v[92:95], v15 offset:0
    s_waitcnt lgkmcnt(6)
    v_mfma_f32_32x32x16_bf16 v[96:111], v[132:135], v[68:71], v[96:111]
    s_add_u32 m0, s44, 65536
    s_add_u32 s46, s43, 327680
    buffer_load_dwordx4 v16, s[12:15], s46 offen offset:0 lds
    ds_read_b128 v[64:67], v8 offset:256
    s_waitcnt lgkmcnt(6)
    v_mfma_f32_32x32x16_bf16 v[96:111], v[136:139], v[72:75], v[96:111]
    ds_read_b128 v[68:71], v9 offset:256
    s_waitcnt lgkmcnt(6)
    v_mfma_f32_32x32x16_bf16 v[96:111], v[140:143], v[76:79], v[96:111]
    ds_read_b128 v[72:75], v10 offset:256
    s_waitcnt lgkmcnt(6)
    v_mfma_f32_32x32x16_bf16 v[96:111], v[144:147], v[80:83], v[96:111]
    buffer_load_dwordx4 v17, s[12:15], s46 offen offset:1024 lds
    ds_read_b128 v[76:79], v11 offset:256
    s_waitcnt lgkmcnt(6)
    v_mfma_f32_32x32x16_bf16 v[96:111], v[148:151], v[84:87], v[96:111]
    ds_read_b128 v[80:83], v12 offset:256
    s_waitcnt lgkmcnt(6)
    v_mfma_f32_32x32x16_bf16 v[96:111], v[152:155], v[88:91], v[96:111]
    ds_read_b128 v[84:87], v13 offset:256
    s_waitcnt lgkmcnt(6)
    v_mfma_f32_32x32x16_bf16 v[96:111], v[156:159], v[92:95], v[96:111]
    buffer_load_dwordx4 v18, s[12:15], s46 offen offset:2048 lds
    ds_read_b128 v[88:91], v14 offset:256
    s_waitcnt lgkmcnt(6)
    v_mfma_f32_32x32x16_bf16 v[96:111], v[160:163], v[64:67], v[96:111]
    ds_read_b128 v[92:95], v15 offset:256
    s_waitcnt lgkmcnt(6)
    v_mfma_f32_32x32x16_bf16 v[96:111], v[164:167], v[68:71], v[96:111]
    ds_read_b128 v[64:67], v8 offset:512
    s_waitcnt lgkmcnt(6)
    v_mfma_f32_32x32x16_bf16 v[96:111], v[168:171], v[72:75], v[96:111]
    buffer_load_dwordx4 v19, s[12:15], s46 offen offset:3072 lds
    ds_read_b128 v[68:71], v9 offset:512
    s_waitcnt lgkmcnt(6)
    v_mfma_f32_32x32x16_bf16 v[96:111], v[172:175], v[76:79], v[96:111]
    ds_read_b128 v[72:75], v10 offset:512
    s_waitcnt lgkmcnt(6)
    v_mfma_f32_32x32x16_bf16 v[96:111], v[176:179], v[80:83], v[96:111]
    ds_read_b128 v[76:79], v11 offset:512
    s_waitcnt lgkmcnt(6)
    v_mfma_f32_32x32x16_bf16 v[96:111], v[180:183], v[84:87], v[96:111]
    s_add_u32 m0, s44, 69632
    s_add_u32 s46, s43, 331776
    buffer_load_dwordx4 v20, s[12:15], s46 offen offset:0 lds
    ds_read_b128 v[80:83], v12 offset:512
    s_waitcnt lgkmcnt(6)
    v_mfma_f32_32x32x16_bf16 v[96:111], v[184:187], v[88:91], v[96:111]
    ds_read_b128 v[84:87], v13 offset:512
    s_waitcnt lgkmcnt(6)
    v_mfma_f32_32x32x16_bf16 v[96:111], v[188:191], v[92:95], v[96:111]
    ds_read_b128 v[88:91], v14 offset:512
    s_waitcnt lgkmcnt(6)
    v_mfma_f32_32x32x16_bf16 v[96:111], v[192:195], v[64:67], v[96:111]
    buffer_load_dwordx4 v21, s[12:15], s46 offen offset:1024 lds
    ds_read_b128 v[92:95], v15 offset:512
    s_waitcnt lgkmcnt(6)
    v_mfma_f32_32x32x16_bf16 v[96:111], v[196:199], v[68:71], v[96:111]
    ds_read_b128 v[64:67], v8 offset:768
    s_waitcnt lgkmcnt(6)
    v_mfma_f32_32x32x16_bf16 v[96:111], v[200:203], v[72:75], v[96:111]
    ds_read_b128 v[68:71], v9 offset:768
    s_waitcnt lgkmcnt(6)
    v_mfma_f32_32x32x16_bf16 v[96:111], v[204:207], v[76:79], v[96:111]
    buffer_load_dwordx4 v22, s[12:15], s46 offen offset:2048 lds
    ds_read_b128 v[72:75], v10 offset:768
    s_waitcnt lgkmcnt(6)
    v_mfma_f32_32x32x16_bf16 v[96:111], v[208:211], v[80:83], v[96:111]
    ds_read_b128 v[76:79], v11 offset:768
    s_waitcnt lgkmcnt(6)
    v_mfma_f32_32x32x16_bf16 v[96:111], v[212:215], v[84:87], v[96:111]
    ds_read_b128 v[80:83], v12 offset:768
    s_waitcnt lgkmcnt(6)
    v_mfma_f32_32x32x16_bf16 v[96:111], v[216:219], v[88:91], v[96:111]
    buffer_load_dwordx4 v23, s[12:15], s46 offen offset:3072 lds
    ds_read_b128 v[84:87], v13 offset:768
    s_waitcnt lgkmcnt(6)
    v_mfma_f32_32x32x16_bf16 v[96:111], v[220:223], v[92:95], v[96:111]
    ds_read_b128 v[88:91], v14 offset:768
    s_waitcnt lgkmcnt(6)
    v_mfma_f32_32x32x16_bf16 v[96:111], v[224:227], v[64:67], v[96:111]
    ds_read_b128 v[92:95], v15 offset:768
    s_waitcnt lgkmcnt(6)
    v_mfma_f32_32x32x16_bf16 v[96:111], v[228:231], v[68:71], v[96:111]
    s_waitcnt lgkmcnt(5)
    v_mfma_f32_32x32x16_bf16 v[96:111], v[232:235], v[72:75], v[96:111]
    s_waitcnt lgkmcnt(4)
    v_mfma_f32_32x32x16_bf16 v[96:111], v[236:239], v[76:79], v[96:111]
    s_waitcnt lgkmcnt(3)
    v_mfma_f32_32x32x16_bf16 v[96:111], v[240:243], v[80:83], v[96:111]
    v_cvt_pk_bf16_f32 v56, v112, v113
    v_cvt_pk_bf16_f32 v57, v114, v115
    v_cvt_pk_bf16_f32 v58, v116, v117
    v_cvt_pk_bf16_f32 v59, v118, v119
    v_cvt_pk_bf16_f32 v60, v120, v121
    v_cvt_pk_bf16_f32 v61, v122, v123
    v_cvt_pk_bf16_f32 v62, v124, v125
    v_cvt_pk_bf16_f32 v63, v126, v127
    s_add_u32 s47, s45, 98304
    buffer_store_dwordx4 v[56:59], v4, s[20:23], s47 offen sc1
    buffer_store_dwordx4 v[60:63], v4, s[20:23], s47 offen offset:1024 sc1
    s_waitcnt lgkmcnt(2)
    v_mfma_f32_32x32x16_bf16 v[96:111], v[244:247], v[84:87], v[96:111]
    s_waitcnt lgkmcnt(1)
    v_mfma_f32_32x32x16_bf16 v[96:111], v[248:251], v[88:91], v[96:111]
    s_waitcnt lgkmcnt(0)
    v_mfma_f32_32x32x16_bf16 v[96:111], v[252:255], v[92:95], v[96:111]
    v_xor_b32 v8, 0x10000, v8
    v_xor_b32 v9, 0x10000, v9
    v_xor_b32 v10, 0x10000, v10
    v_xor_b32 v11, 0x10000, v11
    v_xor_b32 v12, 0x10000, v12
    v_xor_b32 v13, 0x10000, v13
    v_xor_b32 v14, 0x10000, v14
    v_xor_b32 v15, 0x10000, v15
    s_waitcnt vmcnt(2)
    s_barrier
    ds_read_b128 v[64:67], v8 offset:0
    ds_read_b128 v[68:71], v9 offset:0
    ds_read_b128 v[72:75], v10 offset:0
    ds_read_b128 v[76:79], v11 offset:0
    ds_read_b128 v[80:83], v12 offset:0
    ds_read_b128 v[84:87], v13 offset:0
    ds_read_b128 v[88:91], v14 offset:0
    s_waitcnt lgkmcnt(6)
    v_mfma_f32_32x32x16_bf16 v[112:127], v[128:131], v[64:67], 0
    ds_read_b128 v[92:95], v15 offset:0
    s_waitcnt lgkmcnt(6)
    v_mfma_f32_32x32x16_bf16 v[112:127], v[132:135], v[68:71], v[112:127]
    s_add_u32 m0, s44, 0
    s_add_u32 s46, s43, 393216
    buffer_load_dwordx4 v16, s[12:15], s46 offen offset:0 lds
    ds_read_b128 v[64:67], v8 offset:256
    s_waitcnt lgkmcnt(6)
    v_mfma_f32_32x32x16_bf16 v[112:127], v[136:139], v[72:75], v[112:127]
    ds_read_b128 v[68:71], v9 offset:256
    s_waitcnt lgkmcnt(6)
    v_mfma_f32_32x32x16_bf16 v[112:127], v[140:143], v[76:79], v[112:127]
    ds_read_b128 v[72:75], v10 offset:256
    s_waitcnt lgkmcnt(6)
    v_mfma_f32_32x32x16_bf16 v[112:127], v[144:147], v[80:83], v[112:127]
    buffer_load_dwordx4 v17, s[12:15], s46 offen offset:1024 lds
    ds_read_b128 v[76:79], v11 offset:256
    s_waitcnt lgkmcnt(6)
    v_mfma_f32_32x32x16_bf16 v[112:127], v[148:151], v[84:87], v[112:127]
    ds_read_b128 v[80:83], v12 offset:256
    s_waitcnt lgkmcnt(6)
    v_mfma_f32_32x32x16_bf16 v[112:127], v[152:155], v[88:91], v[112:127]
    ds_read_b128 v[84:87], v13 offset:256
    s_waitcnt lgkmcnt(6)
    v_mfma_f32_32x32x16_bf16 v[112:127], v[156:159], v[92:95], v[112:127]
    buffer_load_dwordx4 v18, s[12:15], s46 offen offset:2048 lds
    ds_read_b128 v[88:91], v14 offset:256
    s_waitcnt lgkmcnt(6)
    v_mfma_f32_32x32x16_bf16 v[112:127], v[160:163], v[64:67], v[112:127]
    ds_read_b128 v[92:95], v15 offset:256
    s_waitcnt lgkmcnt(6)
    v_mfma_f32_32x32x16_bf16 v[112:127], v[164:167], v[68:71], v[112:127]
    ds_read_b128 v[64:67], v8 offset:512
    s_waitcnt lgkmcnt(6)
    v_mfma_f32_32x32x16_bf16 v[112:127], v[168:171], v[72:75], v[112:127]
    buffer_load_dwordx4 v19, s[12:15], s46 offen offset:3072 lds
    ds_read_b128 v[68:71], v9 offset:512
    s_waitcnt lgkmcnt(6)
    v_mfma_f32_32x32x16_bf16 v[112:127], v[172:175], v[76:79], v[112:127]
    ds_read_b128 v[72:75], v10 offset:512
    s_waitcnt lgkmcnt(6)
    v_mfma_f32_32x32x16_bf16 v[112:127], v[176:179], v[80:83], v[112:127]
    ds_read_b128 v[76:79], v11 offset:512
    s_waitcnt lgkmcnt(6)
    v_mfma_f32_32x32x16_bf16 v[112:127], v[180:183], v[84:87], v[112:127]
    s_add_u32 m0, s44, 4096
    s_add_u32 s46, s43, 397312
    buffer_load_dwordx4 v20, s[12:15], s46 offen offset:0 lds
    ds_read_b128 v[80:83], v12 offset:512
    s_waitcnt lgkmcnt(6)
    v_mfma_f32_32x32x16_bf16 v[112:127], v[184:187], v[88:91], v[112:127]
    ds_read_b128 v[84:87], v13 offset:512
    s_waitcnt lgkmcnt(6)
    v_mfma_f32_32x32x16_bf16 v[112:127], v[188:191], v[92:95], v[112:127]
    ds_read_b128 v[88:91], v14 offset:512
    s_waitcnt lgkmcnt(6)
    v_mfma_f32_32x32x16_bf16 v[112:127], v[192:195], v[64:67], v[112:127]
    buffer_load_dwordx4 v21, s[12:15], s46 offen offset:1024 lds
    ds_read_b128 v[92:95], v15 offset:512
    s_waitcnt lgkmcnt(6)
    v_mfma_f32_32x32x16_bf16 v[112:127], v[196:199], v[68:71], v[112:127]
    ds_read_b128 v[64:67], v8 offset:768
    s_waitcnt lgkmcnt(6)
    v_mfma_f32_32x32x16_bf16 v[112:127], v[200:203], v[72:75], v[112:127]
    ds_read_b128 v[68:71], v9 offset:768
    s_waitcnt lgkmcnt(6)
    v_mfma_f32_32x32x16_bf16 v[112:127], v[204:207], v[76:79], v[112:127]
    buffer_load_dwordx4 v22, s[12:15], s46 offen offset:2048 lds
    ds_read_b128 v[72:75], v10 offset:768
    s_waitcnt lgkmcnt(6)
    v_mfma_f32_32x32x16_bf16 v[112:127], v[208:211], v[80:83], v[112:127]
    ds_read_b128 v[76:79], v11 offset:768
    s_waitcnt lgkmcnt(6)
    v_mfma_f32_32x32x16_bf16 v[112:127], v[212:215], v[84:87], v[112:127]
    ds_read_b128 v[80:83], v12 offset:768
    s_waitcnt lgkmcnt(6)
    v_mfma_f32_32x32x16_bf16 v[112:127], v[216:219], v[88:91], v[112:127]
    buffer_load_dwordx4 v23, s[12:15], s46 offen offset:3072 lds
    ds_read_b128 v[84:87], v13 offset:768
    s_waitcnt lgkmcnt(6)
    v_mfma_f32_32x32x16_bf16 v[112:127], v[220:223], v[92:95], v[112:127]
    ds_read_b128 v[88:91], v14 offset:768
    s_waitcnt lgkmcnt(6)
    v_mfma_f32_32x32x16_bf16 v[112:127], v[224:227], v[64:67], v[112:127]
    ds_read_b128 v[92:95], v15 offset:768
    s_waitcnt lgkmcnt(6)
    v_mfma_f32_32x32x16_bf16 v[112:127], v[228:231], v[68:71], v[112:127]
    s_waitcnt lgkmcnt(5)
    v_mfma_f32_32x32x16_bf16 v[112:127], v[232:235], v[72:75], v[112:127]
    s_waitcnt lgkmcnt(4)
    v_mfma_f32_32x32x16_bf16 v[112:127], v[236:239], v[76:79], v[112:127]
    s_waitcnt lgkmcnt(3)
    v_mfma_f32_32x32x16_bf16 v[112:127], v[240:243], v[80:83], v[112:127]
    v_cvt_pk_bf16_f32 v56, v96, v97
    v_cvt_pk_bf16_f32 v57, v98, v99
    v_cvt_pk_bf16_f32 v58, v100, v101
    v_cvt_pk_bf16_f32 v59, v102, v103
    v_cvt_pk_bf16_f32 v60, v104, v105
    v_cvt_pk_bf16_f32 v61, v106, v107
    v_cvt_pk_bf16_f32 v62, v108, v109
    v_cvt_pk_bf16_f32 v63, v110, v111
    s_add_u32 s47, s45, 131072
    buffer_store_dwordx4 v[56:59], v4, s[20:23], s47 offen sc1
    buffer_store_dwordx4 v[60:63], v4, s[20:23], s47 offen offset:1024 sc1
    s_waitcnt lgkmcnt(2)
    v_mfma_f32_32x32x16_bf16 v[112:127], v[244:247], v[84:87], v[112:127]
    s_waitcnt lgkmcnt(1)
    v_mfma_f32_32x32x16_bf16 v[112:127], v[248:251], v[88:91], v[112:127]
    s_waitcnt lgkmcnt(0)
    v_mfma_f32_32x32x16_bf16 v[112:127], v[252:255], v[92:95], v[112:127]
    v_xor_b32 v8, 0x10000, v8
    v_xor_b32 v9, 0x10000, v9
    v_xor_b32 v10, 0x10000, v10
    v_xor_b32 v11, 0x10000, v11
    v_xor_b32 v12, 0x10000, v12
    v_xor_b32 v13, 0x10000, v13
    v_xor_b32 v14, 0x10000, v14
    v_xor_b32 v15, 0x10000, v15
    s_waitcnt vmcnt(2)
    s_barrier
    ds_read_b128 v[64:67], v8 offset:0
    ds_read_b128 v[68:71], v9 offset:0
    ds_read_b128 v[72:75], v10 offset:0
    ds_read_b128 v[76:79], v11 offset:0
    ds_read_b128 v[80:83], v12 offset:0
    ds_read_b128 v[84:87], v13 offset:0
    ds_read_b128 v[88:91], v14 offset:0
    s_waitcnt lgkmcnt(6)
    v_mfma_f32_32x32x16_bf16 v[96:111], v[128:131], v[64:67], 0
    ds_read_b128 v[92:95], v15 offset:0
    s_waitcnt lgkmcnt(6)
    v_mfma_f32_32x32x16_bf16 v[96:111], v[132:135], v[68:71], v[96:111]
    s_add_u32 m0, s44, 65536
    s_add_u32 s46, s43, 458752
    buffer_load_dwordx4 v16, s[12:15], s46 offen offset:0 lds
    ds_read_b128 v[64:67], v8 offset:256
    s_waitcnt lgkmcnt(6)
    v_mfma_f32_32x32x16_bf16 v[96:111], v[136:139], v[72:75], v[96:111]
    ds_read_b128 v[68:71], v9 offset:256
    s_waitcnt lgkmcnt(6)
    v_mfma_f32_32x32x16_bf16 v[96:111], v[140:143], v[76:79], v[96:111]
    ds_read_b128 v[72:75], v10 offset:256
    s_waitcnt lgkmcnt(6)
    v_mfma_f32_32x32x16_bf16 v[96:111], v[144:147], v[80:83], v[96:111]
    buffer_load_dwordx4 v17, s[12:15], s46 offen offset:1024 lds
    ds_read_b128 v[76:79], v11 offset:256
    s_waitcnt lgkmcnt(6)
    v_mfma_f32_32x32x16_bf16 v[96:111], v[148:151], v[84:87], v[96:111]
    ds_read_b128 v[80:83], v12 offset:256
    s_waitcnt lgkmcnt(6)
    v_mfma_f32_32x32x16_bf16 v[96:111], v[152:155], v[88:91], v[96:111]
    ds_read_b128 v[84:87], v13 offset:256
    s_waitcnt lgkmcnt(6)
    v_mfma_f32_32x32x16_bf16 v[96:111], v[156:159], v[92:95], v[96:111]
    buffer_load_dwordx4 v18, s[12:15], s46 offen offset:2048 lds
    ds_read_b128 v[88:91], v14 offset:256
    s_waitcnt lgkmcnt(6)
    v_mfma_f32_32x32x16_bf16 v[96:111], v[160:163], v[64:67], v[96:111]
    ds_read_b128 v[92:95], v15 offset:256
    s_waitcnt lgkmcnt(6)
    v_mfma_f32_32x32x16_bf16 v[96:111], v[164:167], v[68:71], v[96:111]
    ds_read_b128 v[64:67], v8 offset:512
    s_waitcnt lgkmcnt(6)
    v_mfma_f32_32x32x16_bf16 v[96:111], v[168:171], v[72:75], v[96:111]
    buffer_load_dwordx4 v19, s[12:15], s46 offen offset:3072 lds
    ds_read_b128 v[68:71], v9 offset:512
    s_waitcnt lgkmcnt(6)
    v_mfma_f32_32x32x16_bf16 v[96:111], v[172:175], v[76:79], v[96:111]
    ds_read_b128 v[72:75], v10 offset:512
    s_waitcnt lgkmcnt(6)
    v_mfma_f32_32x32x16_bf16 v[96:111], v[176:179], v[80:83], v[96:111]
    ds_read_b128 v[76:79], v11 offset:512
    s_waitcnt lgkmcnt(6)
    v_mfma_f32_32x32x16_bf16 v[96:111], v[180:183], v[84:87], v[96:111]
    s_add_u32 m0, s44, 69632
    s_add_u32 s46, s43, 462848
    buffer_load_dwordx4 v20, s[12:15], s46 offen offset:0 lds
    ds_read_b128 v[80:83], v12 offset:512
    s_waitcnt lgkmcnt(6)
    v_mfma_f32_32x32x16_bf16 v[96:111], v[184:187], v[88:91], v[96:111]
    ds_read_b128 v[84:87], v13 offset:512
    s_waitcnt lgkmcnt(6)
    v_mfma_f32_32x32x16_bf16 v[96:111], v[188:191], v[92:95], v[96:111]
    ds_read_b128 v[88:91], v14 offset:512
    s_waitcnt lgkmcnt(6)
    v_mfma_f32_32x32x16_bf16 v[96:111], v[192:195], v[64:67], v[96:111]
    buffer_load_dwordx4 v21, s[12:15], s46 offen offset:1024 lds
    ds_read_b128 v[92:95], v15 offset:512
    s_waitcnt lgkmcnt(6)
    v_mfma_f32_32x32x16_bf16 v[96:111], v[196:199], v[68:71], v[96:111]
    ds_read_b128 v[64:67], v8 offset:768
    s_waitcnt lgkmcnt(6)
    v_mfma_f32_32x32x16_bf16 v[96:111], v[200:203], v[72:75], v[96:111]
    ds_read_b128 v[68:71], v9 offset:768
    s_waitcnt lgkmcnt(6)
    v_mfma_f32_32x32x16_bf16 v[96:111], v[204:207], v[76:79], v[96:111]
    buffer_load_dwordx4 v22, s[12:15], s46 offen offset:2048 lds
    ds_read_b128 v[72:75], v10 offset:768
    s_waitcnt lgkmcnt(6)
    v_mfma_f32_32x32x16_bf16 v[96:111], v[208:211], v[80:83], v[96:111]
    ds_read_b128 v[76:79], v11 offset:768
    s_waitcnt lgkmcnt(6)
    v_mfma_f32_32x32x16_bf16 v[96:111], v[212:215], v[84:87], v[96:111]
    ds_read_b128 v[80:83], v12 offset:768
    s_waitcnt lgkmcnt(6)
    v_mfma_f32_32x32x16_bf16 v[96:111], v[216:219], v[88:91], v[96:111]
    buffer_load_dwordx4 v23, s[12:15], s46 offen offset:3072 lds
    ds_read_b128 v[84:87], v13 offset:768
    s_waitcnt lgkmcnt(6)
    v_mfma_f32_32x32x16_bf16 v[96:111], v[220:223], v[92:95], v[96:111]
    ds_read_b128 v[88:91], v14 offset:768
    s_waitcnt lgkmcnt(6)
    v_mfma_f32_32x32x16_bf16 v[96:111], v[224:227], v[64:67], v[96:111]
    ds_read_b128 v[92:95], v15 offset:768
    s_waitcnt lgkmcnt(6)
    v_mfma_f32_32x32x16_bf16 v[96:111], v[228:231], v[68:71], v[96:111]
    s_waitcnt lgkmcnt(5)
    v_mfma_f32_32x32x16_bf16 v[96:111], v[232:235], v[72:75], v[96:111]
    s_waitcnt lgkmcnt(4)
    v_mfma_f32_32x32x16_bf16 v[96:111], v[236:239], v[76:79], v[96:111]
    s_waitcnt lgkmcnt(3)
    v_mfma_f32_32x32x16_bf16 v[96:111], v[240:243], v[80:83], v[96:111]
    v_cvt_pk_bf16_f32 v56, v112, v113
    v_cvt_pk_bf16_f32 v57, v114, v115
    v_cvt_pk_bf16_f32 v58, v116, v117
    v_cvt_pk_bf16_f32 v59, v118, v119
    v_cvt_pk_bf16_f32 v60, v120, v121
    v_cvt_pk_bf16_f32 v61, v122, v123
    v_cvt_pk_bf16_f32 v62, v124, v125
    v_cvt_pk_bf16_f32 v63, v126, v127
    s_add_u32 s47, s45, 163840
    buffer_store_dwordx4 v[56:59], v4, s[20:23], s47 offen sc1
    buffer_store_dwordx4 v[60:63], v4, s[20:23], s47 offen offset:1024 sc1
    s_waitcnt lgkmcnt(2)
    v_mfma_f32_32x32x16_bf16 v[96:111], v[244:247], v[84:87], v[96:111]
    s_waitcnt lgkmcnt(1)
    v_mfma_f32_32x32x16_bf16 v[96:111], v[248:251], v[88:91], v[96:111]
    s_waitcnt lgkmcnt(0)
    v_mfma_f32_32x32x16_bf16 v[96:111], v[252:255], v[92:95], v[96:111]
    v_xor_b32 v8, 0x10000, v8
    v_xor_b32 v9, 0x10000, v9
    v_xor_b32 v10, 0x10000, v10
    v_xor_b32 v11, 0x10000, v11
    v_xor_b32 v12, 0x10000, v12
    v_xor_b32 v13, 0x10000, v13
    v_xor_b32 v14, 0x10000, v14
    v_xor_b32 v15, 0x10000, v15
    s_waitcnt vmcnt(2)
    s_barrier
    ds_read_b128 v[64:67], v8 offset:0
    ds_read_b128 v[68:71], v9 offset:0
    ds_read_b128 v[72:75], v10 offset:0
    ds_read_b128 v[76:79], v11 offset:0
    ds_read_b128 v[80:83], v12 offset:0
    ds_read_b128 v[84:87], v13 offset:0
    ds_read_b128 v[88:91], v14 offset:0
    s_waitcnt lgkmcnt(6)
    v_mfma_f32_32x32x16_bf16 v[112:127], v[128:131], v[64:67], 0
    ds_read_b128 v[92:95], v15 offset:0
    s_waitcnt lgkmcnt(6)
    v_mfma_f32_32x32x16_bf16 v[112:127], v[132:135], v[68:71], v[112:127]
    ds_read_b128 v[64:67], v8 offset:256
    s_waitcnt lgkmcnt(6)
    v_mfma_f32_32x32x16_bf16 v[112:127], v[136:139], v[72:75], v[112:127]
    ds_read_b128 v[68:71], v9 offset:256
    s_waitcnt lgkmcnt(6)
    v_mfma_f32_32x32x16_bf16 v[112:127], v[140:143], v[76:79], v[112:127]
    ds_read_b128 v[72:75], v10 offset:256
    s_waitcnt lgkmcnt(6)
    v_mfma_f32_32x32x16_bf16 v[112:127], v[144:147], v[80:83], v[112:127]
    ds_read_b128 v[76:79], v11 offset:256
    s_waitcnt lgkmcnt(6)
    v_mfma_f32_32x32x16_bf16 v[112:127], v[148:151], v[84:87], v[112:127]
    ds_read_b128 v[80:83], v12 offset:256
    s_waitcnt lgkmcnt(6)
    v_mfma_f32_32x32x16_bf16 v[112:127], v[152:155], v[88:91], v[112:127]
    ds_read_b128 v[84:87], v13 offset:256
    s_waitcnt lgkmcnt(6)
    v_mfma_f32_32x32x16_bf16 v[112:127], v[156:159], v[92:95], v[112:127]
    ds_read_b128 v[88:91], v14 offset:256
    s_waitcnt lgkmcnt(6)
    v_mfma_f32_32x32x16_bf16 v[112:127], v[160:163], v[64:67], v[112:127]
    ds_read_b128 v[92:95], v15 offset:256
    s_waitcnt lgkmcnt(6)
    v_mfma_f32_32x32x16_bf16 v[112:127], v[164:167], v[68:71], v[112:127]
    ds_read_b128 v[64:67], v8 offset:512
    s_waitcnt lgkmcnt(6)
    v_mfma_f32_32x32x16_bf16 v[112:127], v[168:171], v[72:75], v[112:127]
    ds_read_b128 v[68:71], v9 offset:512
    s_waitcnt lgkmcnt(6)
    v_mfma_f32_32x32x16_bf16 v[112:127], v[172:175], v[76:79], v[112:127]
    ds_read_b128 v[72:75], v10 offset:512
    s_waitcnt lgkmcnt(6)
    v_mfma_f32_32x32x16_bf16 v[112:127], v[176:179], v[80:83], v[112:127]
    ds_read_b128 v[76:79], v11 offset:512
    s_waitcnt lgkmcnt(6)
    v_mfma_f32_32x32x16_bf16 v[112:127], v[180:183], v[84:87], v[112:127]
    ds_read_b128 v[80:83], v12 offset:512
    s_waitcnt lgkmcnt(6)
    v_mfma_f32_32x32x16_bf16 v[112:127], v[184:187], v[88:91], v[112:127]
    ds_read_b128 v[84:87], v13 offset:512
    s_waitcnt lgkmcnt(6)
    v_mfma_f32_32x32x16_bf16 v[112:127], v[188:191], v[92:95], v[112:127]
    ds_read_b128 v[88:91], v14 offset:512
    s_waitcnt lgkmcnt(6)
    v_mfma_f32_32x32x16_bf16 v[112:127], v[192:195], v[64:67], v[112:127]
    ds_read_b128 v[92:95], v15 offset:512
    s_waitcnt lgkmcnt(6)
    v_mfma_f32_32x32x16_bf16 v[112:127], v[196:199], v[68:71], v[112:127]
    ds_read_b128 v[64:67], v8 offset:768
    s_waitcnt lgkmcnt(6)
    v_mfma_f32_32x32x16_bf16 v[112:127], v[200:203], v[72:75], v[112:127]
    ds_read_b128 v[68:71], v9 offset:768
    s_waitcnt lgkmcnt(6)
    v_mfma_f32_32x32x16_bf16 v[112:127], v[204:207], v[76:79], v[112:127]
    ds_read_b128 v[72:75], v10 offset:768
    s_waitcnt lgkmcnt(6)
    v_mfma_f32_32x32x16_bf16 v[112:127], v[208:211], v[80:83], v[112:127]
    ds_read_b128 v[76:79], v11 offset:768
    s_waitcnt lgkmcnt(6)
    v_mfma_f32_32x32x16_bf16 v[112:127], v[212:215], v[84:87], v[112:127]
    ds_read_b128 v[80:83], v12 offset:768
    s_waitcnt lgkmcnt(6)
    v_mfma_f32_32x32x16_bf16 v[112:127], v[216:219], v[88:91], v[112:127]
    ds_read_b128 v[84:87], v13 offset:768
    s_waitcnt lgkmcnt(6)
    v_mfma_f32_32x32x16_bf16 v[112:127], v[220:223], v[92:95], v[112:127]
    ds_read_b128 v[88:91], v14 offset:768
    s_waitcnt lgkmcnt(6)
    v_mfma_f32_32x32x16_bf16 v[112:127], v[224:227], v[64:67], v[112:127]
    ds_read_b128 v[92:95], v15 offset:768
    s_waitcnt lgkmcnt(6)
    v_mfma_f32_32x32x16_bf16 v[112:127], v[228:231], v[68:71], v[112:127]
    s_waitcnt lgkmcnt(5)
    v_mfma_f32_32x32x16_bf16 v[112:127], v[232:235], v[72:75], v[112:127]
    s_waitcnt lgkmcnt(4)
    v_mfma_f32_32x32x16_bf16 v[112:127], v[236:239], v[76:79], v[112:127]
    s_waitcnt lgkmcnt(3)
    v_mfma_f32_32x32x16_bf16 v[112:127], v[240:243], v[80:83], v[112:127]
    v_cvt_pk_bf16_f32 v56, v96, v97
    v_cvt_pk_bf16_f32 v57, v98, v99
    v_cvt_pk_bf16_f32 v58, v100, v101
    v_cvt_pk_bf16_f32 v59, v102, v103
    v_cvt_pk_bf16_f32 v60, v104, v105
    v_cvt_pk_bf16_f32 v61, v106, v107
    v_cvt_pk_bf16_f32 v62, v108, v109
    v_cvt_pk_bf16_f32 v63, v110, v111
    s_add_u32 s47, s45, 196608
    buffer_store_dwordx4 v[56:59], v4, s[20:23], s47 offen sc1
    buffer_store_dwordx4 v[60:63], v4, s[20:23], s47 offen offset:1024 sc1
    s_waitcnt lgkmcnt(2)
    v_mfma_f32_32x32x16_bf16 v[112:127], v[244:247], v[84:87], v[112:127]
    s_waitcnt lgkmcnt(1)
    v_mfma_f32_32x32x16_bf16 v[112:127], v[248:251], v[88:91], v[112:127]
    s_waitcnt lgkmcnt(0)
    v_mfma_f32_32x32x16_bf16 v[112:127], v[252:255], v[92:95], v[112:127]
    s_nop 15
    v_cvt_pk_bf16_f32 v56, v112, v113
    v_cvt_pk_bf16_f32 v57, v114, v115
    v_cvt_pk_bf16_f32 v58, v116, v117
    v_cvt_pk_bf16_f32 v59, v118, v119
    v_cvt_pk_bf16_f32 v60, v120, v121
    v_cvt_pk_bf16_f32 v61, v122, v123
    v_cvt_pk_bf16_f32 v62, v124, v125
    v_cvt_pk_bf16_f32 v63, v126, v127
    s_add_u32 s47, s45, 229376
    buffer_store_dwordx4 v[56:59], v4, s[20:23], s47 offen sc1
    buffer_store_dwordx4 v[60:63], v4, s[20:23], s47 offen offset:1024 sc1
    s_load_dwordx2 s[50:51], s[0:1], 104
    s_load_dwordx2 s[56:57], s[0:1], 0
    s_lshl_b32 s52, s2, 3
    s_add_u32 s52, s52, s30
    s_lshl_b32 s53, s52, 10
    v_lshlrev_b32 v24, 4, v1
    v_add_u32 v24, s53, v24
    v_lshlrev_b32 v25, 5, v1
    v_mov_b32 v26, 0
    s_waitcnt lgkmcnt(0)
    global_load_dwordx4 v[28:31], v24, s[56:57]
kv_kernel_hw4:
    global_load_dword v27, v26, s[50:51] offset:64 sc0 sc1
    s_waitcnt vmcnt(0)
    v_readfirstlane_b32 s54, v27
    s_nop 3
    s_cmp_ge_u32 s54, 48
    s_cbranch_scc1 kv_kernel_hw4_ok
    s_sleep 8
    s_branch kv_kernel_hw4
kv_kernel_hw4_ok:
    global_load_dwordx4 v[40:43], v25, s[8:9] sc0 sc1
    global_load_dwordx4 v[44:47], v25, s[8:9] offset:16 sc0 sc1
    global_load_dwordx4 v[48:51], v25, s[8:9] offset:2048 sc0 sc1
    global_load_dwordx4 v[52:55], v25, s[8:9] offset:2064 sc0 sc1
    v_lshlrev_b32 v32, 16, v28
    v_and_b32 v33, 0xffff0000, v28
    v_lshlrev_b32 v34, 16, v29
    v_and_b32 v35, 0xffff0000, v29
    v_lshlrev_b32 v36, 16, v30
    v_and_b32 v37, 0xffff0000, v30
    v_lshlrev_b32 v38, 16, v31
    v_and_b32 v39, 0xffff0000, v31
    v_add_f32 v26, v32, v33
    v_add_f32 v26, v26, v34
    v_add_f32 v26, v26, v35
    v_add_f32 v26, v26, v36
    v_add_f32 v26, v26, v37
    v_add_f32 v26, v26, v38
    v_add_f32 v26, v26, v39
    s_nop 1
    v_add_f32_dpp v26, v26, v26 quad_perm:[1,0,3,2] row_mask:0xf bank_mask:0xf
    s_nop 1
    v_add_f32_dpp v26, v26, v26 quad_perm:[2,3,0,1] row_mask:0xf bank_mask:0xf
    s_nop 1
    v_add_f32_dpp v26, v26, v26 row_half_mirror row_mask:0xf bank_mask:0xf
    s_nop 1
    v_add_f32_dpp v26, v26, v26 row_mirror row_mask:0xf bank_mask:0xf
    s_nop 1
    v_readlane_b32 s54, v26, 0
    v_readlane_b32 s55, v26, 16
    v_readlane_b32 s56, v26, 32
    v_readlane_b32 s57, v26, 48
    s_nop 1
    v_mov_b32 v26, s54
    v_add_f32 v26, s55, v26
    v_add_f32 v26, s56, v26
    v_add_f32 v26, s57, v26
    v_mul_f32 v26, 0x3b000000, v26
    v_sub_f32 v32, v32, v26
    v_sub_f32 v33, v33, v26
    v_sub_f32 v34, v34, v26
    v_sub_f32 v35, v35, v26
    v_sub_f32 v36, v36, v26
    v_sub_f32 v37, v37, v26
    v_sub_f32 v38, v38, v26
    v_sub_f32 v39, v39, v26
    v_mul_f32 v26, v32, v32
    v_fmac_f32 v26, v33, v33
    v_fmac_f32 v26, v34, v34
    v_fmac_f32 v26, v35, v35
    v_fmac_f32 v26, v36, v36
    v_fmac_f32 v26, v37, v37
    v_fmac_f32 v26, v38, v38
    v_fmac_f32 v26, v39, v39
    s_nop 1
    v_add_f32_dpp v26, v26, v26 quad_perm:[1,0,3,2] row_mask:0xf bank_mask:0xf
    s_nop 1
    v_add_f32_dpp v26, v26, v26 quad_perm:[2,3,0,1] row_mask:0xf bank_mask:0xf
    s_nop 1
    v_add_f32_dpp v26, v26, v26 row_half_mirror row_mask:0xf bank_mask:0xf
    s_nop 1
    v_add_f32_dpp v26, v26, v26 row_mirror row_mask:0xf bank_mask:0xf
    s_nop 1
    v_readlane_b32 s54, v26, 0
    v_readlane_b32 s55, v26, 16
    v_readlane_b32 s56, v26, 32
    v_readlane_b32 s57, v26, 48
    s_nop 1
    v_mov_b32 v26, s54
    v_add_f32 v26, s55, v26
    v_add_f32 v26, s56, v26
    v_add_f32 v26, s57, v26
    v_mov_b32 v27, 0x3727c5ac
    v_fmac_f32 v27, 0x3b000000, v26
    v_rsq_f32 v27, v27
    s_nop 0
    v_mul_f32 v32, v32, v27
    v_mul_f32 v33, v33, v27
    v_mul_f32 v34, v34, v27
    v_mul_f32 v35, v35, v27
    v_mul_f32 v36, v36, v27
    v_mul_f32 v37, v37, v27
    v_mul_f32 v38, v38, v27
    v_mul_f32 v39, v39, v27
    s_waitcnt vmcnt(0)
    v_add_f32 v48, 1.0, v48
    v_fma_f32 v32, v32, v48, v40
    v_add_f32 v49, 1.0, v49
    v_fma_f32 v33, v33, v49, v41
    v_add_f32 v50, 1.0, v50
    v_fma_f32 v34, v34, v50, v42
    v_add_f32 v51, 1.0, v51
    v_fma_f32 v35, v35, v51, v43
    v_add_f32 v52, 1.0, v52
    v_fma_f32 v36, v36, v52, v44
    v_add_f32 v53, 1.0, v53
    v_fma_f32 v37, v37, v53, v45
    v_add_f32 v54, 1.0, v54
    v_fma_f32 v38, v38, v54, v46
    v_add_f32 v55, 1.0, v55
    v_fma_f32 v39, v39, v55, v47
    v_cvt_pk_bf16_f32 v28, v32, v33
    v_cvt_pk_bf16_f32 v29, v34, v35
    v_cvt_pk_bf16_f32 v30, v36, v37
    v_cvt_pk_bf16_f32 v31, v38, v39
    s_lshr_b32 s53, s52, 5
    s_lshl_b32 s53, s53, 15
    s_and_b32 s54, s52, 31
    s_lshl_b32 s54, s54, 4
    s_add_u32 s53, s53, s54
    s_add_u32 s53, s53, 1048576
    v_lshrrev_b32 v24, 1, v1
    v_lshlrev_b32 v24, 10, v24
    v_and_b32 v25, 1, v1
    v_lshlrev_b32 v25, 9, v25
    v_add_u32 v24, v24, v25
    v_add_u32 v24, s53, v24
    global_store_dwordx4 v24, v[28:31], s[8:9]
    s_branch kv_kernel_end
kv_kernel_V:
    v_add_u32 v5, 0x10000, v2
    v_add_u32 v6, 0x20000, v2
    s_cmp_ge_u32 s2, 48
    s_cbranch_scc1 kv_kernel_ml5
    s_load_dwordx4 s[56:59], s[0:1], 80
    v_and_b32 v56, 7, v0
    v_lshrrev_b32 v57, 3, v0
    v_lshlrev_b32 v58, 4, v57
    s_waitcnt lgkmcnt(0)
    global_load_dwordx4 v[60:63], v58, s[56:57]
    s_mov_b32 s53, 49152
    v_mul_lo_u32 v58, v57, s53
    v_lshlrev_b32 v56, 4, v56
    v_add_u32 v58, v58, v56
    s_lshl_b32 s53, s2, 7
    v_add_u32 v58, s53, v58
    global_load_dwordx4 v[24:27], v58, s[58:59]
    v_add_u32 v58, 6144, v58
    global_load_dwordx4 v[28:31], v58, s[58:59]
    v_add_u32 v58, 6144, v58
    global_load_dwordx4 v[32:35], v58, s[58:59]
    v_add_u32 v58, 6144, v58
    global_load_dwordx4 v[36:39], v58, s[58:59]
    v_add_u32 v58, 6144, v58
    global_load_dwordx4 v[40:43], v58, s[58:59]
    v_add_u32 v58, 6144, v58
    global_load_dwordx4 v[44:47], v58, s[58:59]
    v_add_u32 v58, 6144, v58
    global_load_dwordx4 v[48:51], v58, s[58:59]
    v_add_u32 v58, 6144, v58
    global_load_dwordx4 v[52:55], v58, s[58:59]
kv_kernel_ml5:
    s_add_u32 m0, s42, 131072
    s_add_u32 s46, s40, 0
    buffer_load_dwordx4 v3, s[16:19], s46 offen lds
    s_add_u32 m0, s42, 132096
    s_add_u32 s46, s40, 32768
    buffer_load_dwordx4 v3, s[16:19], s46 offen lds
    s_add_u32 m0, s42, 133120
    s_add_u32 s46, s40, 65536
    buffer_load_dwordx4 v3, s[16:19], s46 offen lds
    s_add_u32 m0, s42, 134144
    s_add_u32 s46, s40, 98304
    buffer_load_dwordx4 v3, s[16:19], s46 offen lds
    s_add_u32 m0, s44, 0
    s_add_u32 s46, s43, 0
    buffer_load_dwordx4 v16, s[12:15], s46 offen offset:0 lds
    buffer_load_dwordx4 v17, s[12:15], s46 offen offset:1024 lds
    buffer_load_dwordx4 v18, s[12:15], s46 offen offset:2048 lds
    buffer_load_dwordx4 v19, s[12:15], s46 offen offset:3072 lds
    s_add_u32 m0, s44, 4096
    s_add_u32 s46, s43, 4096
    buffer_load_dwordx4 v20, s[12:15], s46 offen offset:0 lds
    buffer_load_dwordx4 v21, s[12:15], s46 offen offset:1024 lds
    buffer_load_dwordx4 v22, s[12:15], s46 offen offset:2048 lds
    buffer_load_dwordx4 v23, s[12:15], s46 offen offset:3072 lds
    s_add_u32 m0, s42, 65536
    s_add_u32 s46, s40, 1048576
    buffer_load_dwordx4 v3, s[16:19], s46 offen lds
    s_add_u32 m0, s42, 66560
    s_add_u32 s46, s40, 1081344
    buffer_load_dwordx4 v3, s[16:19], s46 offen lds
    s_add_u32 m0, s42, 67584
    s_add_u32 s46, s40, 1114112
    buffer_load_dwordx4 v3, s[16:19], s46 offen lds
    s_add_u32 m0, s42, 68608
    s_add_u32 s46, s40, 1146880
    buffer_load_dwordx4 v3, s[16:19], s46 offen lds
    s_add_u32 m0, s42, 98304
    s_add_u32 s46, s40, 2097152
    buffer_load_dwordx4 v3, s[16:19], s46 offen lds
    s_add_u32 m0, s42, 99328
    s_add_u32 s46, s40, 2129920
    buffer_load_dwordx4 v3, s[16:19], s46 offen lds
    s_add_u32 m0, s42, 100352
    s_add_u32 s46, s40, 2162688
    buffer_load_dwordx4 v3, s[16:19], s46 offen lds
    s_add_u32 m0, s42, 101376
    s_add_u32 s46, s40, 2195456
    buffer_load_dwordx4 v3, s[16:19], s46 offen lds
    s_waitcnt vmcnt(8)
    s_barrier
    ds_read_b64_tr_b16 v[128:129], v6 offset:0
    ds_read_b64_tr_b16 v[130:131], v6 offset:1024
    ds_read_b64_tr_b16 v[132:133], v6 offset:4096
    ds_read_b64_tr_b16 v[134:135], v6 offset:5120
    ds_read_b64_tr_b16 v[136:137], v6 offset:8192
    ds_read_b64_tr_b16 v[138:139], v6 offset:9216
    ds_read_b64_tr_b16 v[140:141], v6 offset:12288
    ds_read_b64_tr_b16 v[142:143], v6 offset:13312
    ds_read_b64_tr_b16 v[144:145], v6 offset:16384
    ds_read_b64_tr_b16 v[146:147], v6 offset:17408
    ds_read_b64_tr_b16 v[148:149], v6 offset:20480
    ds_read_b64_tr_b16 v[150:151], v6 offset:21504
    ds_read_b64_tr_b16 v[152:153], v6 offset:24576
    ds_read_b64_tr_b16 v[154:155], v6 offset:25600
    ds_read_b64_tr_b16 v[156:157], v6 offset:28672
    ds_read_b64_tr_b16 v[158:159], v6 offset:29696
    s_waitcnt lgkmcnt(0)
    ds_read_b128 v[64:67], v8 offset:0
    ds_read_b128 v[68:71], v9 offset:0
    ds_read_b128 v[72:75], v10 offset:0
    ds_read_b128 v[76:79], v11 offset:0
    ds_read_b128 v[80:83], v12 offset:0
    ds_read_b128 v[84:87], v13 offset:0
    ds_read_b128 v[88:91], v14 offset:0
    s_waitcnt lgkmcnt(6)
    v_mfma_f32_32x32x16_bf16 v[96:111], v[64:67], v[128:131], 0
    ds_read_b128 v[92:95], v15 offset:0
    s_waitcnt lgkmcnt(6)
    v_mfma_f32_32x32x16_bf16 v[96:111], v[68:71], v[132:135], v[96:111]
    s_waitcnt lgkmcnt(5)
    v_mfma_f32_32x32x16_bf16 v[96:111], v[72:75], v[136:139], v[96:111]
    s_waitcnt lgkmcnt(4)
    v_mfma_f32_32x32x16_bf16 v[96:111], v[76:79], v[140:143], v[96:111]
    s_waitcnt lgkmcnt(3)
    v_mfma_f32_32x32x16_bf16 v[96:111], v[80:83], v[144:147], v[96:111]
    s_waitcnt lgkmcnt(2)
    v_mfma_f32_32x32x16_bf16 v[96:111], v[84:87], v[148:151], v[96:111]
    s_waitcnt lgkmcnt(1)
    v_mfma_f32_32x32x16_bf16 v[96:111], v[88:91], v[152:155], v[96:111]
    s_waitcnt lgkmcnt(0)
    v_mfma_f32_32x32x16_bf16 v[96:111], v[92:95], v[156:159], v[96:111]
    s_waitcnt vmcnt(0)
    s_barrier
    s_add_u32 m0, s42, 131072
    s_add_u32 s46, s40, 3145728
    buffer_load_dwordx4 v3, s[16:19], s46 offen lds
    s_add_u32 m0, s42, 132096
    s_add_u32 s46, s40, 3178496
    buffer_load_dwordx4 v3, s[16:19], s46 offen lds
    s_add_u32 m0, s42, 133120
    s_add_u32 s46, s40, 3211264
    buffer_load_dwordx4 v3, s[16:19], s46 offen lds
    s_add_u32 m0, s42, 134144
    s_add_u32 s46, s40, 3244032
    buffer_load_dwordx4 v3, s[16:19], s46 offen lds
    ds_read_b64_tr_b16 v[160:161], v5 offset:0
    ds_read_b64_tr_b16 v[162:163], v5 offset:1024
    ds_read_b64_tr_b16 v[164:165], v5 offset:4096
    ds_read_b64_tr_b16 v[166:167], v5 offset:5120
    ds_read_b64_tr_b16 v[168:169], v5 offset:8192
    ds_read_b64_tr_b16 v[170:171], v5 offset:9216
    ds_read_b64_tr_b16 v[172:173], v5 offset:12288
    ds_read_b64_tr_b16 v[174:175], v5 offset:13312
    ds_read_b64_tr_b16 v[176:177], v5 offset:16384
    ds_read_b64_tr_b16 v[178:179], v5 offset:17408
    ds_read_b64_tr_b16 v[180:181], v5 offset:20480
    ds_read_b64_tr_b16 v[182:183], v5 offset:21504
    ds_read_b64_tr_b16 v[184:185], v5 offset:24576
    ds_read_b64_tr_b16 v[186:187], v5 offset:25600
    ds_read_b64_tr_b16 v[188:189], v5 offset:28672
    ds_read_b64_tr_b16 v[190:191], v5 offset:29696
    ds_read_b64_tr_b16 v[192:193], v5 offset:32768
    ds_read_b64_tr_b16 v[194:195], v5 offset:33792
    ds_read_b64_tr_b16 v[196:197], v5 offset:36864
    ds_read_b64_tr_b16 v[198:199], v5 offset:37888
    ds_read_b64_tr_b16 v[200:201], v5 offset:40960
    ds_read_b64_tr_b16 v[202:203], v5 offset:41984
    ds_read_b64_tr_b16 v[204:205], v5 offset:45056
    ds_read_b64_tr_b16 v[206:207], v5 offset:46080
    ds_read_b64_tr_b16 v[208:209], v5 offset:49152
    ds_read_b64_tr_b16 v[210:211], v5 offset:50176
    ds_read_b64_tr_b16 v[212:213], v5 offset:53248
    ds_read_b64_tr_b16 v[214:215], v5 offset:54272
    ds_read_b64_tr_b16 v[216:217], v5 offset:57344
    ds_read_b64_tr_b16 v[218:219], v5 offset:58368
    ds_read_b64_tr_b16 v[220:221], v5 offset:61440
    ds_read_b64_tr_b16 v[222:223], v5 offset:62464
    s_waitcnt lgkmcnt(0)
    ds_read_b128 v[64:67], v8 offset:256
    ds_read_b128 v[68:71], v9 offset:256
    ds_read_b128 v[72:75], v10 offset:256
    ds_read_b128 v[76:79], v11 offset:256
    ds_read_b128 v[80:83], v12 offset:256
    ds_read_b128 v[84:87], v13 offset:256
    ds_read_b128 v[88:91], v14 offset:256
    s_waitcnt lgkmcnt(6)
    v_mfma_f32_32x32x16_bf16 v[96:111], v[64:67], v[160:163], v[96:111]
    ds_read_b128 v[92:95], v15 offset:256
    s_waitcnt lgkmcnt(6)
    v_mfma_f32_32x32x16_bf16 v[96:111], v[68:71], v[164:167], v[96:111]
    s_waitcnt lgkmcnt(5)
    v_mfma_f32_32x32x16_bf16 v[96:111], v[72:75], v[168:171], v[96:111]
    s_waitcnt lgkmcnt(4)
    v_mfma_f32_32x32x16_bf16 v[96:111], v[76:79], v[172:175], v[96:111]
    s_waitcnt lgkmcnt(3)
    v_mfma_f32_32x32x16_bf16 v[96:111], v[80:83], v[176:179], v[96:111]
    s_waitcnt lgkmcnt(2)
    v_mfma_f32_32x32x16_bf16 v[96:111], v[84:87], v[180:183], v[96:111]
    s_waitcnt lgkmcnt(1)
    v_mfma_f32_32x32x16_bf16 v[96:111], v[88:91], v[184:187], v[96:111]
    s_waitcnt lgkmcnt(0)
    v_mfma_f32_32x32x16_bf16 v[96:111], v[92:95], v[188:191], v[96:111]
    s_barrier
    s_add_u32 m0, s44, 65536
    s_add_u32 s46, s43, 65536
    buffer_load_dwordx4 v16, s[12:15], s46 offen offset:0 lds
    buffer_load_dwordx4 v17, s[12:15], s46 offen offset:1024 lds
    buffer_load_dwordx4 v18, s[12:15], s46 offen offset:2048 lds
    buffer_load_dwordx4 v19, s[12:15], s46 offen offset:3072 lds
    s_add_u32 m0, s44, 69632
    s_add_u32 s46, s43, 69632
    buffer_load_dwordx4 v20, s[12:15], s46 offen offset:0 lds
    buffer_load_dwordx4 v21, s[12:15], s46 offen offset:1024 lds
    buffer_load_dwordx4 v22, s[12:15], s46 offen offset:2048 lds
    buffer_load_dwordx4 v23, s[12:15], s46 offen offset:3072 lds
    ds_read_b128 v[64:67], v8 offset:512
    ds_read_b128 v[68:71], v9 offset:512
    ds_read_b128 v[72:75], v10 offset:512
    ds_read_b128 v[76:79], v11 offset:512
    ds_read_b128 v[80:83], v12 offset:512
    ds_read_b128 v[84:87], v13 offset:512
    ds_read_b128 v[88:91], v14 offset:512
    s_waitcnt lgkmcnt(6)
    v_mfma_f32_32x32x16_bf16 v[96:111], v[64:67], v[192:195], v[96:111]
    ds_read_b128 v[92:95], v15 offset:512
    s_waitcnt lgkmcnt(6)
    v_mfma_f32_32x32x16_bf16 v[96:111], v[68:71], v[196:199], v[96:111]
    s_waitcnt lgkmcnt(5)
    v_mfma_f32_32x32x16_bf16 v[96:111], v[72:75], v[200:203], v[96:111]
    s_waitcnt lgkmcnt(4)
    v_mfma_f32_32x32x16_bf16 v[96:111], v[76:79], v[204:207], v[96:111]
    s_waitcnt lgkmcnt(3)
    v_mfma_f32_32x32x16_bf16 v[96:111], v[80:83], v[208:211], v[96:111]
    s_waitcnt lgkmcnt(2)
    v_mfma_f32_32x32x16_bf16 v[96:111], v[84:87], v[212:215], v[96:111]
    s_waitcnt lgkmcnt(1)
    v_mfma_f32_32x32x16_bf16 v[96:111], v[88:91], v[216:219], v[96:111]
    s_waitcnt lgkmcnt(0)
    v_mfma_f32_32x32x16_bf16 v[96:111], v[92:95], v[220:223], v[96:111]
    s_waitcnt vmcnt(8)
    s_barrier
    ds_read_b64_tr_b16 v[224:225], v6 offset:0
    ds_read_b64_tr_b16 v[226:227], v6 offset:1024
    ds_read_b64_tr_b16 v[228:229], v6 offset:4096
    ds_read_b64_tr_b16 v[230:231], v6 offset:5120
    ds_read_b64_tr_b16 v[232:233], v6 offset:8192
    ds_read_b64_tr_b16 v[234:235], v6 offset:9216
    ds_read_b64_tr_b16 v[236:237], v6 offset:12288
    ds_read_b64_tr_b16 v[238:239], v6 offset:13312
    ds_read_b64_tr_b16 v[240:241], v6 offset:16384
    ds_read_b64_tr_b16 v[242:243], v6 offset:17408
    ds_read_b64_tr_b16 v[244:245], v6 offset:20480
    ds_read_b64_tr_b16 v[246:247], v6 offset:21504
    ds_read_b64_tr_b16 v[248:249], v6 offset:24576
    ds_read_b64_tr_b16 v[250:251], v6 offset:25600
    ds_read_b64_tr_b16 v[252:253], v6 offset:28672
    ds_read_b64_tr_b16 v[254:255], v6 offset:29696
    s_waitcnt lgkmcnt(0)
    ds_read_b128 v[64:67], v8 offset:768
    ds_read_b128 v[68:71], v9 offset:768
    ds_read_b128 v[72:75], v10 offset:768
    ds_read_b128 v[76:79], v11 offset:768
    ds_read_b128 v[80:83], v12 offset:768
    ds_read_b128 v[84:87], v13 offset:768
    ds_read_b128 v[88:91], v14 offset:768
    s_waitcnt lgkmcnt(6)
    v_mfma_f32_32x32x16_bf16 v[96:111], v[64:67], v[224:227], v[96:111]
    ds_read_b128 v[92:95], v15 offset:768
    s_waitcnt lgkmcnt(6)
    v_mfma_f32_32x32x16_bf16 v[96:111], v[68:71], v[228:231], v[96:111]
    s_waitcnt lgkmcnt(5)
    v_mfma_f32_32x32x16_bf16 v[96:111], v[72:75], v[232:235], v[96:111]
    s_waitcnt lgkmcnt(4)
    v_mfma_f32_32x32x16_bf16 v[96:111], v[76:79], v[236:239], v[96:111]
    s_waitcnt lgkmcnt(3)
    v_mfma_f32_32x32x16_bf16 v[96:111], v[80:83], v[240:243], v[96:111]
    s_waitcnt lgkmcnt(2)
    v_mfma_f32_32x32x16_bf16 v[96:111], v[84:87], v[244:247], v[96:111]
    s_waitcnt lgkmcnt(1)
    v_mfma_f32_32x32x16_bf16 v[96:111], v[88:91], v[248:251], v[96:111]
    s_waitcnt lgkmcnt(0)
    v_mfma_f32_32x32x16_bf16 v[96:111], v[92:95], v[252:255], v[96:111]
    s_cmp_ge_u32 s2, 48
    s_cbranch_scc1 kv_kernel_mc6
    s_load_dwordx2 s[50:51], s[0:1], 104
    s_barrier
    v_lshlrev_b32 v64, 16, v60
    v_and_b32 v65, 0xffff0000, v60
    v_lshlrev_b32 v66, 16, v61
    v_and_b32 v67, 0xffff0000, v61
    v_lshlrev_b32 v68, 16, v62
    v_and_b32 v69, 0xffff0000, v62
    v_lshlrev_b32 v70, 16, v63
    v_and_b32 v71, 0xffff0000, v63
    v_mul_f32 v72, 0xbfb8aa3b, v64
    v_mul_f32 v73, 0xbfb8aa3b, v65
    v_mul_f32 v74, 0xbfb8aa3b, v66
    v_mul_f32 v75, 0xbfb8aa3b, v67
    v_mul_f32 v76, 0xbfb8aa3b, v68
    v_mul_f32 v77, 0xbfb8aa3b, v69
    v_mul_f32 v78, 0xbfb8aa3b, v70
    v_mul_f32 v79, 0xbfb8aa3b, v71
    v_exp_f32 v72, v72
    v_exp_f32 v73, v73
    v_exp_f32 v74, v74
    v_exp_f32 v75, v75
    v_exp_f32 v76, v76
    v_exp_f32 v77, v77
    v_exp_f32 v78, v78
    v_exp_f32 v79, v79
    s_nop 0
    v_add_f32 v72, 1.0, v72
    v_add_f32 v73, 1.0, v73
    v_add_f32 v74, 1.0, v74
    v_add_f32 v75, 1.0, v75
    v_add_f32 v76, 1.0, v76
    v_add_f32 v77, 1.0, v77
    v_add_f32 v78, 1.0, v78
    v_add_f32 v79, 1.0, v79
    v_rcp_f32 v72, v72
    v_rcp_f32 v73, v73
    v_rcp_f32 v74, v74
    v_rcp_f32 v75, v75
    v_rcp_f32 v76, v76
    v_rcp_f32 v77, v77
    v_rcp_f32 v78, v78
    v_rcp_f32 v79, v79
    s_nop 0
    v_mul_f32 v64, v64, v72
    v_mul_f32 v65, v65, v73
    v_mul_f32 v66, v66, v74
    v_mul_f32 v67, v67, v75
    v_mul_f32 v68, v68, v76
    v_mul_f32 v69, v69, v77
    v_mul_f32 v70, v70, v78
    v_mul_f32 v71, v71, v79
    v_cvt_pk_bf16_f32 v72, v64, v65
    v_cvt_pk_bf16_f32 v73, v66, v67
    v_cvt_pk_bf16_f32 v74, v68, v69
    v_cvt_pk_bf16_f32 v75, v70, v71
    v_lshlrev_b32 v64, 16, v72
    v_and_b32 v65, 0xffff0000, v72
    v_lshlrev_b32 v66, 16, v73
    v_and_b32 v67, 0xffff0000, v73
    v_lshlrev_b32 v68, 16, v74
    v_and_b32 v69, 0xffff0000, v74
    v_lshlrev_b32 v70, 16, v75
    v_and_b32 v71, 0xffff0000, v75
    v_mov_b32 v80, 0
    v_mov_b32 v81, 0
    v_mov_b32 v82, 0
    v_mov_b32 v83, 0
    v_mov_b32 v84, 0
    v_mov_b32 v85, 0
    v_mov_b32 v86, 0
    v_mov_b32 v87, 0
    v_lshlrev_b32 v88, 16, v24
    v_and_b32 v89, 0xffff0000, v24
    v_fmac_f32 v80, v88, v64
    v_fmac_f32 v81, v89, v64
    v_lshlrev_b32 v88, 16, v25
    v_and_b32 v89, 0xffff0000, v25
    v_fmac_f32 v82, v88, v64
    v_fmac_f32 v83, v89, v64
    v_lshlrev_b32 v88, 16, v26
    v_and_b32 v89, 0xffff0000, v26
    v_fmac_f32 v84, v88, v64
    v_fmac_f32 v85, v89, v64
    v_lshlrev_b32 v88, 16, v27
    v_and_b32 v89, 0xffff0000, v27
    v_fmac_f32 v86, v88, v64
    v_fmac_f32 v87, v89, v64
    v_lshlrev_b32 v88, 16, v28
    v_and_b32 v89, 0xffff0000, v28
    v_fmac_f32 v80, v88, v65
    v_fmac_f32 v81, v89, v65
    v_lshlrev_b32 v88, 16, v29
    v_and_b32 v89, 0xffff0000, v29
    v_fmac_f32 v82, v88, v65
    v_fmac_f32 v83, v89, v65
    v_lshlrev_b32 v88, 16, v30
    v_and_b32 v89, 0xffff0000, v30
    v_fmac_f32 v84, v88, v65
    v_fmac_f32 v85, v89, v65
    v_lshlrev_b32 v88, 16, v31
    v_and_b32 v89, 0xffff0000, v31
    v_fmac_f32 v86, v88, v65
    v_fmac_f32 v87, v89, v65
    v_lshlrev_b32 v88, 16, v32
    v_and_b32 v89, 0xffff0000, v32
    v_fmac_f32 v80, v88, v66
    v_fmac_f32 v81, v89, v66
    v_lshlrev_b32 v88, 16, v33
    v_and_b32 v89, 0xffff0000, v33
    v_fmac_f32 v82, v88, v66
    v_fmac_f32 v83, v89, v66
    v_lshlrev_b32 v88, 16, v34
    v_and_b32 v89, 0xffff0000, v34
    v_fmac_f32 v84, v88, v66
    v_fmac_f32 v85, v89, v66
    v_lshlrev_b32 v88, 16, v35
    v_and_b32 v89, 0xffff0000, v35
    v_fmac_f32 v86, v88, v66
    v_fmac_f32 v87, v89, v66
    v_lshlrev_b32 v88, 16, v36
    v_and_b32 v89, 0xffff0000, v36
    v_fmac_f32 v80, v88, v67
    v_fmac_f32 v81, v89, v67
    v_lshlrev_b32 v88, 16, v37
    v_and_b32 v89, 0xffff0000, v37
    v_fmac_f32 v82, v88, v67
    v_fmac_f32 v83, v89, v67
    v_lshlrev_b32 v88, 16, v38
    v_and_b32 v89, 0xffff0000, v38
    v_fmac_f32 v84, v88, v67
    v_fmac_f32 v85, v89, v67
    v_lshlrev_b32 v88, 16, v39
    v_and_b32 v89, 0xffff0000, v39
    v_fmac_f32 v86, v88, v67
    v_fmac_f32 v87, v89, v67
    v_lshlrev_b32 v88, 16, v40
    v_and_b32 v89, 0xffff0000, v40
    v_fmac_f32 v80, v88, v68
    v_fmac_f32 v81, v89, v68
    v_lshlrev_b32 v88, 16, v41
    v_and_b32 v89, 0xffff0000, v41
    v_fmac_f32 v82, v88, v68
    v_fmac_f32 v83, v89, v68
    v_lshlrev_b32 v88, 16, v42
    v_and_b32 v89, 0xffff0000, v42
    v_fmac_f32 v84, v88, v68
    v_fmac_f32 v85, v89, v68
    v_lshlrev_b32 v88, 16, v43
    v_and_b32 v89, 0xffff0000, v43
    v_fmac_f32 v86, v88, v68
    v_fmac_f32 v87, v89, v68
    v_lshlrev_b32 v88, 16, v44
    v_and_b32 v89, 0xffff0000, v44
    v_fmac_f32 v80, v88, v69
    v_fmac_f32 v81, v89, v69
    v_lshlrev_b32 v88, 16, v45
    v_and_b32 v89, 0xffff0000, v45
    v_fmac_f32 v82, v88, v69
    v_fmac_f32 v83, v89, v69
    v_lshlrev_b32 v88, 16, v46
    v_and_b32 v89, 0xffff0000, v46
    v_fmac_f32 v84, v88, v69
    v_fmac_f32 v85, v89, v69
    v_lshlrev_b32 v88, 16, v47
    v_and_b32 v89, 0xffff0000, v47
    v_fmac_f32 v86, v88, v69
    v_fmac_f32 v87, v89, v69
    v_lshlrev_b32 v88, 16, v48
    v_and_b32 v89, 0xffff0000, v48
    v_fmac_f32 v80, v88, v70
    v_fmac_f32 v81, v89, v70
    v_lshlrev_b32 v88, 16, v49
    v_and_b32 v89, 0xffff0000, v49
    v_fmac_f32 v82, v88, v70
    v_fmac_f32 v83, v89, v70
    v_lshlrev_b32 v88, 16, v50
    v_and_b32 v89, 0xffff0000, v50
    v_fmac_f32 v84, v88, v70
    v_fmac_f32 v85, v89, v70
    v_lshlrev_b32 v88, 16, v51
    v_and_b32 v89, 0xffff0000, v51
    v_fmac_f32 v86, v88, v70
    v_fmac_f32 v87, v89, v70
    v_lshlrev_b32 v88, 16, v52
    v_and_b32 v89, 0xffff0000, v52
    v_fmac_f32 v80, v88, v71
    v_fmac_f32 v81, v89, v71
    v_lshlrev_b32 v88, 16, v53
    v_and_b32 v89, 0xffff0000, v53
    v_fmac_f32 v82, v88, v71
    v_fmac_f32 v83, v89, v71
    v_lshlrev_b32 v88, 16, v54
    v_and_b32 v89, 0xffff0000, v54
    v_fmac_f32 v84, v88, v71
    v_fmac_f32 v85, v89, v71
    v_lshlrev_b32 v88, 16, v55
    v_and_b32 v89, 0xffff0000, v55
    v_fmac_f32 v86, v88, v71
    v_fmac_f32 v87, v89, v71
    v_and_b32 v90, 7, v0
    v_lshrrev_b32 v91, 3, v0
    v_lshlrev_b32 v91, 8, v91
    v_lshlrev_b32 v90, 5, v90
    v_add_u32 v90, v90, v91
    v_add_u32 v90, 131072, v90
    ds_write_b128 v90, v[80:83]
    ds_write_b128 v90, v[84:87] offset:16
    s_waitcnt lgkmcnt(0)
    s_barrier
    s_lshl_b32 s53, s30, 11
    v_lshlrev_b32 v91, 2, v1
    v_add_u32 v90, s53, v91
    v_add_u32 v90, 131072, v90
    ds_read_b32 v64, v90 offset:0
    ds_read_b32 v65, v90 offset:256
    ds_read_b32 v66, v90 offset:512
    ds_read_b32 v67, v90 offset:768
    ds_read_b32 v68, v90 offset:1024
    ds_read_b32 v69, v90 offset:1280
    ds_read_b32 v70, v90 offset:1536
    ds_read_b32 v71, v90 offset:1792
    s_waitcnt lgkmcnt(0)
    v_add_f32 v64, v64, v65
    v_add_f32 v64, v64, v66
    v_add_f32 v64, v64, v67
    v_add_f32 v64, v64, v68
    v_add_f32 v64, v64, v69
    v_add_f32 v64, v64, v70
    v_add_f32 v64, v64, v71
    s_lshl_b32 s53, s30, 8
    v_add_u32 v90, s53, v91
    v_add_u32 v90, 147456, v90
    ds_write_b32 v90, v64
    s_waitcnt lgkmcnt(0)
    s_barrier
    s_cmp_eq_u32 s30, 0
    s_cbranch_scc0 kv_kernel_mc6
    v_add_u32 v90, 147456, v91
    ds_read_b32 v64, v90 offset:0
    ds_read_b32 v65, v90 offset:256
    ds_read_b32 v66, v90 offset:512
    ds_read_b32 v67, v90 offset:768
    ds_read_b32 v68, v90 offset:1024
    ds_read_b32 v69, v90 offset:1280
    ds_read_b32 v70, v90 offset:1536
    ds_read_b32 v71, v90 offset:1792
    s_waitcnt lgkmcnt(0)
    v_add_f32 v64, v64, v65
    v_add_f32 v64, v64, v66
    v_add_f32 v64, v64, v67
    v_add_f32 v64, v64, v68
    v_add_f32 v64, v64, v69
    v_add_f32 v64, v64, v70
    v_add_f32 v64, v64, v71
    s_lshl_b32 s53, s2, 8
    v_add_u32 v91, s53, v91
    global_store_dword v91, v64, s[8:9] sc0 sc1
    s_waitcnt vmcnt(0)
    s_mov_b64 exec, 1
    v_mov_b32 v88, 0
    v_mov_b32 v89, 1
    global_atomic_add v88, v89, s[50:51] offset:64
    s_mov_b64 exec, -1
kv_kernel_mc6:
    v_xor_b32 v8, 0x10000, v8
    v_xor_b32 v9, 0x10000, v9
    v_xor_b32 v10, 0x10000, v10
    v_xor_b32 v11, 0x10000, v11
    v_xor_b32 v12, 0x10000, v12
    v_xor_b32 v13, 0x10000, v13
    v_xor_b32 v14, 0x10000, v14
    v_xor_b32 v15, 0x10000, v15
    s_waitcnt vmcnt(0)
    s_barrier
    ds_read_b128 v[64:67], v8 offset:0
    ds_read_b128 v[68:71], v9 offset:0
    ds_read_b128 v[72:75], v10 offset:0
    ds_read_b128 v[76:79], v11 offset:0
    ds_read_b128 v[80:83], v12 offset:0
    ds_read_b128 v[84:87], v13 offset:0
    ds_read_b128 v[88:91], v14 offset:0
    s_waitcnt lgkmcnt(6)
    v_mfma_f32_32x32x16_bf16 v[112:127], v[64:67], v[128:131], 0
    ds_read_b128 v[92:95], v15 offset:0
    s_waitcnt lgkmcnt(6)
    v_mfma_f32_32x32x16_bf16 v[112:127], v[68:71], v[132:135], v[112:127]
    s_add_u32 m0, s44, 0
    s_add_u32 s46, s43, 131072
    buffer_load_dwordx4 v16, s[12:15], s46 offen offset:0 lds
    ds_read_b128 v[64:67], v8 offset:256
    s_waitcnt lgkmcnt(6)
    v_mfma_f32_32x32x16_bf16 v[112:127], v[72:75], v[136:139], v[112:127]
    ds_read_b128 v[68:71], v9 offset:256
    s_waitcnt lgkmcnt(6)
    v_mfma_f32_32x32x16_bf16 v[112:127], v[76:79], v[140:143], v[112:127]
    ds_read_b128 v[72:75], v10 offset:256
    s_waitcnt lgkmcnt(6)
    v_mfma_f32_32x32x16_bf16 v[112:127], v[80:83], v[144:147], v[112:127]
    buffer_load_dwordx4 v17, s[12:15], s46 offen offset:1024 lds
    ds_read_b128 v[76:79], v11 offset:256
    s_waitcnt lgkmcnt(6)
    v_mfma_f32_32x32x16_bf16 v[112:127], v[84:87], v[148:151], v[112:127]
    ds_read_b128 v[80:83], v12 offset:256
    s_waitcnt lgkmcnt(6)
    v_mfma_f32_32x32x16_bf16 v[112:127], v[88:91], v[152:155], v[112:127]
    ds_read_b128 v[84:87], v13 offset:256
    s_waitcnt lgkmcnt(6)
    v_mfma_f32_32x32x16_bf16 v[112:127], v[92:95], v[156:159], v[112:127]
    buffer_load_dwordx4 v18, s[12:15], s46 offen offset:2048 lds
    ds_read_b128 v[88:91], v14 offset:256
    s_waitcnt lgkmcnt(6)
    v_mfma_f32_32x32x16_bf16 v[112:127], v[64:67], v[160:163], v[112:127]
    ds_read_b128 v[92:95], v15 offset:256
    s_waitcnt lgkmcnt(6)
    v_mfma_f32_32x32x16_bf16 v[112:127], v[68:71], v[164:167], v[112:127]
    ds_read_b128 v[64:67], v8 offset:512
    s_waitcnt lgkmcnt(6)
    v_mfma_f32_32x32x16_bf16 v[112:127], v[72:75], v[168:171], v[112:127]
    buffer_load_dwordx4 v19, s[12:15], s46 offen offset:3072 lds
    ds_read_b128 v[68:71], v9 offset:512
    s_waitcnt lgkmcnt(6)
    v_mfma_f32_32x32x16_bf16 v[112:127], v[76:79], v[172:175], v[112:127]
    ds_read_b128 v[72:75], v10 offset:512
    s_waitcnt lgkmcnt(6)
    v_mfma_f32_32x32x16_bf16 v[112:127], v[80:83], v[176:179], v[112:127]
    ds_read_b128 v[76:79], v11 offset:512
    s_waitcnt lgkmcnt(6)
    v_mfma_f32_32x32x16_bf16 v[112:127], v[84:87], v[180:183], v[112:127]
    s_add_u32 m0, s44, 4096
    s_add_u32 s46, s43, 135168
    buffer_load_dwordx4 v20, s[12:15], s46 offen offset:0 lds
    ds_read_b128 v[80:83], v12 offset:512
    s_waitcnt lgkmcnt(6)
    v_mfma_f32_32x32x16_bf16 v[112:127], v[88:91], v[184:187], v[112:127]
    ds_read_b128 v[84:87], v13 offset:512
    s_waitcnt lgkmcnt(6)
    v_mfma_f32_32x32x16_bf16 v[112:127], v[92:95], v[188:191], v[112:127]
    ds_read_b128 v[88:91], v14 offset:512
    s_waitcnt lgkmcnt(6)
    v_mfma_f32_32x32x16_bf16 v[112:127], v[64:67], v[192:195], v[112:127]
    buffer_load_dwordx4 v21, s[12:15], s46 offen offset:1024 lds
    ds_read_b128 v[92:95], v15 offset:512
    s_waitcnt lgkmcnt(6)
    v_mfma_f32_32x32x16_bf16 v[112:127], v[68:71], v[196:199], v[112:127]
    ds_read_b128 v[64:67], v8 offset:768
    s_waitcnt lgkmcnt(6)
    v_mfma_f32_32x32x16_bf16 v[112:127], v[72:75], v[200:203], v[112:127]
    ds_read_b128 v[68:71], v9 offset:768
    s_waitcnt lgkmcnt(6)
    v_mfma_f32_32x32x16_bf16 v[112:127], v[76:79], v[204:207], v[112:127]
    buffer_load_dwordx4 v22, s[12:15], s46 offen offset:2048 lds
    ds_read_b128 v[72:75], v10 offset:768
    s_waitcnt lgkmcnt(6)
    v_mfma_f32_32x32x16_bf16 v[112:127], v[80:83], v[208:211], v[112:127]
    ds_read_b128 v[76:79], v11 offset:768
    s_waitcnt lgkmcnt(6)
    v_mfma_f32_32x32x16_bf16 v[112:127], v[84:87], v[212:215], v[112:127]
    ds_read_b128 v[80:83], v12 offset:768
    s_waitcnt lgkmcnt(6)
    v_mfma_f32_32x32x16_bf16 v[112:127], v[88:91], v[216:219], v[112:127]
    buffer_load_dwordx4 v23, s[12:15], s46 offen offset:3072 lds
    ds_read_b128 v[84:87], v13 offset:768
    s_waitcnt lgkmcnt(6)
    v_mfma_f32_32x32x16_bf16 v[112:127], v[92:95], v[220:223], v[112:127]
    ds_read_b128 v[88:91], v14 offset:768
    s_waitcnt lgkmcnt(6)
    v_mfma_f32_32x32x16_bf16 v[112:127], v[64:67], v[224:227], v[112:127]
    ds_read_b128 v[92:95], v15 offset:768
    s_waitcnt lgkmcnt(6)
    v_mfma_f32_32x32x16_bf16 v[112:127], v[68:71], v[228:231], v[112:127]
    s_waitcnt lgkmcnt(5)
    v_mfma_f32_32x32x16_bf16 v[112:127], v[72:75], v[232:235], v[112:127]
    s_waitcnt lgkmcnt(4)
    v_mfma_f32_32x32x16_bf16 v[112:127], v[76:79], v[236:239], v[112:127]
    s_waitcnt lgkmcnt(3)
    v_mfma_f32_32x32x16_bf16 v[112:127], v[80:83], v[240:243], v[112:127]
    v_cvt_pk_bf16_f32 v56, v96, v97
    v_cvt_pk_bf16_f32 v57, v98, v99
    v_cvt_pk_bf16_f32 v58, v100, v101
    v_cvt_pk_bf16_f32 v59, v102, v103
    v_cvt_pk_bf16_f32 v60, v104, v105
    v_cvt_pk_bf16_f32 v61, v106, v107
    v_cvt_pk_bf16_f32 v62, v108, v109
    v_cvt_pk_bf16_f32 v63, v110, v111
    s_add_u32 s47, s45, 0
    buffer_store_dwordx4 v[56:59], v4, s[20:23], s47 offen sc1
    buffer_store_dwordx4 v[60:63], v4, s[20:23], s47 offen offset:1024 sc1
    s_waitcnt lgkmcnt(2)
    v_mfma_f32_32x32x16_bf16 v[112:127], v[84:87], v[244:247], v[112:127]
    s_waitcnt lgkmcnt(1)
    v_mfma_f32_32x32x16_bf16 v[112:127], v[88:91], v[248:251], v[112:127]
    s_waitcnt lgkmcnt(0)
    v_mfma_f32_32x32x16_bf16 v[112:127], v[92:95], v[252:255], v[112:127]
    v_xor_b32 v8, 0x10000, v8
    v_xor_b32 v9, 0x10000, v9
    v_xor_b32 v10, 0x10000, v10
    v_xor_b32 v11, 0x10000, v11
    v_xor_b32 v12, 0x10000, v12
    v_xor_b32 v13, 0x10000, v13
    v_xor_b32 v14, 0x10000, v14
    v_xor_b32 v15, 0x10000, v15
    s_waitcnt vmcnt(2)
    s_barrier
    ds_read_b128 v[64:67], v8 offset:0
    ds_read_b128 v[68:71], v9 offset:0
    ds_read_b128 v[72:75], v10 offset:0
    ds_read_b128 v[76:79], v11 offset:0
    ds_read_b128 v[80:83], v12 offset:0
    ds_read_b128 v[84:87], v13 offset:0
    ds_read_b128 v[88:91], v14 offset:0
    s_waitcnt lgkmcnt(6)
    v_mfma_f32_32x32x16_bf16 v[96:111], v[64:67], v[128:131], 0
    ds_read_b128 v[92:95], v15 offset:0
    s_waitcnt lgkmcnt(6)
    v_mfma_f32_32x32x16_bf16 v[96:111], v[68:71], v[132:135], v[96:111]
    s_add_u32 m0, s44, 65536
    s_add_u32 s46, s43, 196608
    buffer_load_dwordx4 v16, s[12:15], s46 offen offset:0 lds
    ds_read_b128 v[64:67], v8 offset:256
    s_waitcnt lgkmcnt(6)
    v_mfma_f32_32x32x16_bf16 v[96:111], v[72:75], v[136:139], v[96:111]
    ds_read_b128 v[68:71], v9 offset:256
    s_waitcnt lgkmcnt(6)
    v_mfma_f32_32x32x16_bf16 v[96:111], v[76:79], v[140:143], v[96:111]
    ds_read_b128 v[72:75], v10 offset:256
    s_waitcnt lgkmcnt(6)
    v_mfma_f32_32x32x16_bf16 v[96:111], v[80:83], v[144:147], v[96:111]
    buffer_load_dwordx4 v17, s[12:15], s46 offen offset:1024 lds
    ds_read_b128 v[76:79], v11 offset:256
    s_waitcnt lgkmcnt(6)
    v_mfma_f32_32x32x16_bf16 v[96:111], v[84:87], v[148:151], v[96:111]
    ds_read_b128 v[80:83], v12 offset:256
    s_waitcnt lgkmcnt(6)
    v_mfma_f32_32x32x16_bf16 v[96:111], v[88:91], v[152:155], v[96:111]
    ds_read_b128 v[84:87], v13 offset:256
    s_waitcnt lgkmcnt(6)
    v_mfma_f32_32x32x16_bf16 v[96:111], v[92:95], v[156:159], v[96:111]
    buffer_load_dwordx4 v18, s[12:15], s46 offen offset:2048 lds
    ds_read_b128 v[88:91], v14 offset:256
    s_waitcnt lgkmcnt(6)
    v_mfma_f32_32x32x16_bf16 v[96:111], v[64:67], v[160:163], v[96:111]
    ds_read_b128 v[92:95], v15 offset:256
    s_waitcnt lgkmcnt(6)
    v_mfma_f32_32x32x16_bf16 v[96:111], v[68:71], v[164:167], v[96:111]
    ds_read_b128 v[64:67], v8 offset:512
    s_waitcnt lgkmcnt(6)
    v_mfma_f32_32x32x16_bf16 v[96:111], v[72:75], v[168:171], v[96:111]
    buffer_load_dwordx4 v19, s[12:15], s46 offen offset:3072 lds
    ds_read_b128 v[68:71], v9 offset:512
    s_waitcnt lgkmcnt(6)
    v_mfma_f32_32x32x16_bf16 v[96:111], v[76:79], v[172:175], v[96:111]
    ds_read_b128 v[72:75], v10 offset:512
    s_waitcnt lgkmcnt(6)
    v_mfma_f32_32x32x16_bf16 v[96:111], v[80:83], v[176:179], v[96:111]
    ds_read_b128 v[76:79], v11 offset:512
    s_waitcnt lgkmcnt(6)
    v_mfma_f32_32x32x16_bf16 v[96:111], v[84:87], v[180:183], v[96:111]
    s_add_u32 m0, s44, 69632
    s_add_u32 s46, s43, 200704
    buffer_load_dwordx4 v20, s[12:15], s46 offen offset:0 lds
    ds_read_b128 v[80:83], v12 offset:512
    s_waitcnt lgkmcnt(6)
    v_mfma_f32_32x32x16_bf16 v[96:111], v[88:91], v[184:187], v[96:111]
    ds_read_b128 v[84:87], v13 offset:512
    s_waitcnt lgkmcnt(6)
    v_mfma_f32_32x32x16_bf16 v[96:111], v[92:95], v[188:191], v[96:111]
    ds_read_b128 v[88:91], v14 offset:512
    s_waitcnt lgkmcnt(6)
    v_mfma_f32_32x32x16_bf16 v[96:111], v[64:67], v[192:195], v[96:111]
    buffer_load_dwordx4 v21, s[12:15], s46 offen offset:1024 lds
    ds_read_b128 v[92:95], v15 offset:512
    s_waitcnt lgkmcnt(6)
    v_mfma_f32_32x32x16_bf16 v[96:111], v[68:71], v[196:199], v[96:111]
    ds_read_b128 v[64:67], v8 offset:768
    s_waitcnt lgkmcnt(6)
    v_mfma_f32_32x32x16_bf16 v[96:111], v[72:75], v[200:203], v[96:111]
    ds_read_b128 v[68:71], v9 offset:768
    s_waitcnt lgkmcnt(6)
    v_mfma_f32_32x32x16_bf16 v[96:111], v[76:79], v[204:207], v[96:111]
    buffer_load_dwordx4 v22, s[12:15], s46 offen offset:2048 lds
    ds_read_b128 v[72:75], v10 offset:768
    s_waitcnt lgkmcnt(6)
    v_mfma_f32_32x32x16_bf16 v[96:111], v[80:83], v[208:211], v[96:111]
    ds_read_b128 v[76:79], v11 offset:768
    s_waitcnt lgkmcnt(6)
    v_mfma_f32_32x32x16_bf16 v[96:111], v[84:87], v[212:215], v[96:111]
    ds_read_b128 v[80:83], v12 offset:768
    s_waitcnt lgkmcnt(6)
    v_mfma_f32_32x32x16_bf16 v[96:111], v[88:91], v[216:219], v[96:111]
    buffer_load_dwordx4 v23, s[12:15], s46 offen offset:3072 lds
    ds_read_b128 v[84:87], v13 offset:768
    s_waitcnt lgkmcnt(6)
    v_mfma_f32_32x32x16_bf16 v[96:111], v[92:95], v[220:223], v[96:111]
    ds_read_b128 v[88:91], v14 offset:768
    s_waitcnt lgkmcnt(6)
    v_mfma_f32_32x32x16_bf16 v[96:111], v[64:67], v[224:227], v[96:111]
    ds_read_b128 v[92:95], v15 offset:768
    s_waitcnt lgkmcnt(6)
    v_mfma_f32_32x32x16_bf16 v[96:111], v[68:71], v[228:231], v[96:111]
    s_waitcnt lgkmcnt(5)
    v_mfma_f32_32x32x16_bf16 v[96:111], v[72:75], v[232:235], v[96:111]
    s_waitcnt lgkmcnt(4)
    v_mfma_f32_32x32x16_bf16 v[96:111], v[76:79], v[236:239], v[96:111]
    s_waitcnt lgkmcnt(3)
    v_mfma_f32_32x32x16_bf16 v[96:111], v[80:83], v[240:243], v[96:111]
    v_cvt_pk_bf16_f32 v56, v112, v113
    v_cvt_pk_bf16_f32 v57, v114, v115
    v_cvt_pk_bf16_f32 v58, v116, v117
    v_cvt_pk_bf16_f32 v59, v118, v119
    v_cvt_pk_bf16_f32 v60, v120, v121
    v_cvt_pk_bf16_f32 v61, v122, v123
    v_cvt_pk_bf16_f32 v62, v124, v125
    v_cvt_pk_bf16_f32 v63, v126, v127
    s_add_u32 s47, s45, 32768
    buffer_store_dwordx4 v[56:59], v4, s[20:23], s47 offen sc1
    buffer_store_dwordx4 v[60:63], v4, s[20:23], s47 offen offset:1024 sc1
    s_waitcnt lgkmcnt(2)
    v_mfma_f32_32x32x16_bf16 v[96:111], v[84:87], v[244:247], v[96:111]
    s_waitcnt lgkmcnt(1)
    v_mfma_f32_32x32x16_bf16 v[96:111], v[88:91], v[248:251], v[96:111]
    s_waitcnt lgkmcnt(0)
    v_mfma_f32_32x32x16_bf16 v[96:111], v[92:95], v[252:255], v[96:111]
    v_xor_b32 v8, 0x10000, v8
    v_xor_b32 v9, 0x10000, v9
    v_xor_b32 v10, 0x10000, v10
    v_xor_b32 v11, 0x10000, v11
    v_xor_b32 v12, 0x10000, v12
    v_xor_b32 v13, 0x10000, v13
    v_xor_b32 v14, 0x10000, v14
    v_xor_b32 v15, 0x10000, v15
    s_waitcnt vmcnt(2)
    s_barrier
    s_load_dwordx2 s[50:51], s[0:1], 16
    v_lshlrev_b32 v24, 4, v0
    s_lshl_b32 s49, s2, 13
    v_add_u32 v24, s49, v24
    v_add_u32 v25, 0x200000, v24
    s_waitcnt lgkmcnt(0)
    global_load_dwordx4 v[28:31], v24, s[50:51]
    global_load_dwordx4 v[32:35], v25, s[50:51]
    ds_read_b128 v[64:67], v8 offset:0
    ds_read_b128 v[68:71], v9 offset:0
    ds_read_b128 v[72:75], v10 offset:0
    ds_read_b128 v[76:79], v11 offset:0
    ds_read_b128 v[80:83], v12 offset:0
    ds_read_b128 v[84:87], v13 offset:0
    ds_read_b128 v[88:91], v14 offset:0
    s_waitcnt lgkmcnt(6)
    v_mfma_f32_32x32x16_bf16 v[112:127], v[64:67], v[128:131], 0
    ds_read_b128 v[92:95], v15 offset:0
    s_waitcnt lgkmcnt(6)
    v_mfma_f32_32x32x16_bf16 v[112:127], v[68:71], v[132:135], v[112:127]
    s_add_u32 m0, s44, 0
    s_add_u32 s46, s43, 262144
    buffer_load_dwordx4 v16, s[12:15], s46 offen offset:0 lds
    ds_read_b128 v[64:67], v8 offset:256
    s_waitcnt lgkmcnt(6)
    v_mfma_f32_32x32x16_bf16 v[112:127], v[72:75], v[136:139], v[112:127]
    ds_read_b128 v[68:71], v9 offset:256
    s_waitcnt lgkmcnt(6)
    v_mfma_f32_32x32x16_bf16 v[112:127], v[76:79], v[140:143], v[112:127]
    ds_read_b128 v[72:75], v10 offset:256
    s_waitcnt lgkmcnt(6)
    v_mfma_f32_32x32x16_bf16 v[112:127], v[80:83], v[144:147], v[112:127]
    buffer_load_dwordx4 v17, s[12:15], s46 offen offset:1024 lds
    ds_read_b128 v[76:79], v11 offset:256
    s_waitcnt lgkmcnt(6)
    v_mfma_f32_32x32x16_bf16 v[112:127], v[84:87], v[148:151], v[112:127]
    ds_read_b128 v[80:83], v12 offset:256
    s_waitcnt lgkmcnt(6)
    v_mfma_f32_32x32x16_bf16 v[112:127], v[88:91], v[152:155], v[112:127]
    ds_read_b128 v[84:87], v13 offset:256
    s_waitcnt lgkmcnt(6)
    v_mfma_f32_32x32x16_bf16 v[112:127], v[92:95], v[156:159], v[112:127]
    buffer_load_dwordx4 v18, s[12:15], s46 offen offset:2048 lds
    ds_read_b128 v[88:91], v14 offset:256
    s_waitcnt lgkmcnt(6)
    v_mfma_f32_32x32x16_bf16 v[112:127], v[64:67], v[160:163], v[112:127]
    ds_read_b128 v[92:95], v15 offset:256
    s_waitcnt lgkmcnt(6)
    v_mfma_f32_32x32x16_bf16 v[112:127], v[68:71], v[164:167], v[112:127]
    ds_read_b128 v[64:67], v8 offset:512
    s_waitcnt lgkmcnt(6)
    v_mfma_f32_32x32x16_bf16 v[112:127], v[72:75], v[168:171], v[112:127]
    buffer_load_dwordx4 v19, s[12:15], s46 offen offset:3072 lds
    ds_read_b128 v[68:71], v9 offset:512
    s_waitcnt lgkmcnt(6)
    v_mfma_f32_32x32x16_bf16 v[112:127], v[76:79], v[172:175], v[112:127]
    ds_read_b128 v[72:75], v10 offset:512
    s_waitcnt lgkmcnt(6)
    v_mfma_f32_32x32x16_bf16 v[112:127], v[80:83], v[176:179], v[112:127]
    ds_read_b128 v[76:79], v11 offset:512
    s_waitcnt lgkmcnt(6)
    v_mfma_f32_32x32x16_bf16 v[112:127], v[84:87], v[180:183], v[112:127]
    s_add_u32 m0, s44, 4096
    s_add_u32 s46, s43, 266240
    buffer_load_dwordx4 v20, s[12:15], s46 offen offset:0 lds
    ds_read_b128 v[80:83], v12 offset:512
    s_waitcnt lgkmcnt(6)
    v_mfma_f32_32x32x16_bf16 v[112:127], v[88:91], v[184:187], v[112:127]
    ds_read_b128 v[84:87], v13 offset:512
    s_waitcnt lgkmcnt(6)
    v_mfma_f32_32x32x16_bf16 v[112:127], v[92:95], v[188:191], v[112:127]
    ds_read_b128 v[88:91], v14 offset:512
    s_waitcnt lgkmcnt(6)
    v_mfma_f32_32x32x16_bf16 v[112:127], v[64:67], v[192:195], v[112:127]
    buffer_load_dwordx4 v21, s[12:15], s46 offen offset:1024 lds
    ds_read_b128 v[92:95], v15 offset:512
    s_waitcnt lgkmcnt(6)
    v_mfma_f32_32x32x16_bf16 v[112:127], v[68:71], v[196:199], v[112:127]
    ds_read_b128 v[64:67], v8 offset:768
    s_waitcnt lgkmcnt(6)
    v_mfma_f32_32x32x16_bf16 v[112:127], v[72:75], v[200:203], v[112:127]
    ds_read_b128 v[68:71], v9 offset:768
    s_waitcnt lgkmcnt(6)
    v_mfma_f32_32x32x16_bf16 v[112:127], v[76:79], v[204:207], v[112:127]
    buffer_load_dwordx4 v22, s[12:15], s46 offen offset:2048 lds
    ds_read_b128 v[72:75], v10 offset:768
    s_waitcnt lgkmcnt(6)
    v_mfma_f32_32x32x16_bf16 v[112:127], v[80:83], v[208:211], v[112:127]
    ds_read_b128 v[76:79], v11 offset:768
    s_waitcnt lgkmcnt(6)
    v_mfma_f32_32x32x16_bf16 v[112:127], v[84:87], v[212:215], v[112:127]
    ds_read_b128 v[80:83], v12 offset:768
    s_waitcnt lgkmcnt(6)
    v_mfma_f32_32x32x16_bf16 v[112:127], v[88:91], v[216:219], v[112:127]
    buffer_load_dwordx4 v23, s[12:15], s46 offen offset:3072 lds
    ds_read_b128 v[84:87], v13 offset:768
    s_waitcnt lgkmcnt(6)
    v_mfma_f32_32x32x16_bf16 v[112:127], v[92:95], v[220:223], v[112:127]
    ds_read_b128 v[88:91], v14 offset:768
    s_waitcnt lgkmcnt(6)
    v_mfma_f32_32x32x16_bf16 v[112:127], v[64:67], v[224:227], v[112:127]
    ds_read_b128 v[92:95], v15 offset:768
    s_waitcnt lgkmcnt(6)
    v_mfma_f32_32x32x16_bf16 v[112:127], v[68:71], v[228:231], v[112:127]
    s_waitcnt lgkmcnt(5)
    v_mfma_f32_32x32x16_bf16 v[112:127], v[72:75], v[232:235], v[112:127]
    s_waitcnt lgkmcnt(4)
    v_mfma_f32_32x32x16_bf16 v[112:127], v[76:79], v[236:239], v[112:127]
    s_waitcnt lgkmcnt(3)
    v_mfma_f32_32x32x16_bf16 v[112:127], v[80:83], v[240:243], v[112:127]
    v_cvt_pk_bf16_f32 v56, v96, v97
    v_cvt_pk_bf16_f32 v57, v98, v99
    v_cvt_pk_bf16_f32 v58, v100, v101
    v_cvt_pk_bf16_f32 v59, v102, v103
    v_cvt_pk_bf16_f32 v60, v104, v105
    v_cvt_pk_bf16_f32 v61, v106, v107
    v_cvt_pk_bf16_f32 v62, v108, v109
    v_cvt_pk_bf16_f32 v63, v110, v111
    s_add_u32 s47, s45, 65536
    buffer_store_dwordx4 v[56:59], v4, s[20:23], s47 offen sc1
    buffer_store_dwordx4 v[60:63], v4, s[20:23], s47 offen offset:1024 sc1
    s_waitcnt lgkmcnt(2)
    v_mfma_f32_32x32x16_bf16 v[112:127], v[84:87], v[244:247], v[112:127]
    s_waitcnt lgkmcnt(1)
    v_mfma_f32_32x32x16_bf16 v[112:127], v[88:91], v[248:251], v[112:127]
    s_waitcnt lgkmcnt(0)
    v_mfma_f32_32x32x16_bf16 v[112:127], v[92:95], v[252:255], v[112:127]
    v_xor_b32 v8, 0x10000, v8
    v_xor_b32 v9, 0x10000, v9
    v_xor_b32 v10, 0x10000, v10
    v_xor_b32 v11, 0x10000, v11
    v_xor_b32 v12, 0x10000, v12
    v_xor_b32 v13, 0x10000, v13
    v_xor_b32 v14, 0x10000, v14
    v_xor_b32 v15, 0x10000, v15
    s_waitcnt vmcnt(2)
    s_barrier
    ds_read_b128 v[64:67], v8 offset:0
    ds_read_b128 v[68:71], v9 offset:0
    ds_read_b128 v[72:75], v10 offset:0
    ds_read_b128 v[76:79], v11 offset:0
    ds_read_b128 v[80:83], v12 offset:0
    ds_read_b128 v[84:87], v13 offset:0
    ds_read_b128 v[88:91], v14 offset:0
    s_waitcnt lgkmcnt(6)
    v_mfma_f32_32x32x16_bf16 v[96:111], v[64:67], v[128:131], 0
    ds_read_b128 v[92:95], v15 offset:0
    s_waitcnt lgkmcnt(6)
    v_mfma_f32_32x32x16_bf16 v[96:111], v[68:71], v[132:135], v[96:111]
    s_add_u32 m0, s44, 65536
    s_add_u32 s46, s43, 327680
    buffer_load_dwordx4 v16, s[12:15], s46 offen offset:0 lds
    ds_read_b128 v[64:67], v8 offset:256
    s_waitcnt lgkmcnt(6)
    v_mfma_f32_32x32x16_bf16 v[96:111], v[72:75], v[136:139], v[96:111]
    ds_read_b128 v[68:71], v9 offset:256
    s_waitcnt lgkmcnt(6)
    v_mfma_f32_32x32x16_bf16 v[96:111], v[76:79], v[140:143], v[96:111]
    ds_read_b128 v[72:75], v10 offset:256
    s_waitcnt lgkmcnt(6)
    v_mfma_f32_32x32x16_bf16 v[96:111], v[80:83], v[144:147], v[96:111]
    buffer_load_dwordx4 v17, s[12:15], s46 offen offset:1024 lds
    ds_read_b128 v[76:79], v11 offset:256
    s_waitcnt lgkmcnt(6)
    v_mfma_f32_32x32x16_bf16 v[96:111], v[84:87], v[148:151], v[96:111]
    ds_read_b128 v[80:83], v12 offset:256
    s_waitcnt lgkmcnt(6)
    v_mfma_f32_32x32x16_bf16 v[96:111], v[88:91], v[152:155], v[96:111]
    ds_read_b128 v[84:87], v13 offset:256
    s_waitcnt lgkmcnt(6)
    v_mfma_f32_32x32x16_bf16 v[96:111], v[92:95], v[156:159], v[96:111]
    buffer_load_dwordx4 v18, s[12:15], s46 offen offset:2048 lds
    ds_read_b128 v[88:91], v14 offset:256
    s_waitcnt lgkmcnt(6)
    v_mfma_f32_32x32x16_bf16 v[96:111], v[64:67], v[160:163], v[96:111]
    ds_read_b128 v[92:95], v15 offset:256
    s_waitcnt lgkmcnt(6)
    v_mfma_f32_32x32x16_bf16 v[96:111], v[68:71], v[164:167], v[96:111]
    ds_read_b128 v[64:67], v8 offset:512
    s_waitcnt lgkmcnt(6)
    v_mfma_f32_32x32x16_bf16 v[96:111], v[72:75], v[168:171], v[96:111]
    buffer_load_dwordx4 v19, s[12:15], s46 offen offset:3072 lds
    ds_read_b128 v[68:71], v9 offset:512
    s_waitcnt lgkmcnt(6)
    v_mfma_f32_32x32x16_bf16 v[96:111], v[76:79], v[172:175], v[96:111]
    ds_read_b128 v[72:75], v10 offset:512
    s_waitcnt lgkmcnt(6)
    v_mfma_f32_32x32x16_bf16 v[96:111], v[80:83], v[176:179], v[96:111]
    ds_read_b128 v[76:79], v11 offset:512
    s_waitcnt lgkmcnt(6)
    v_mfma_f32_32x32x16_bf16 v[96:111], v[84:87], v[180:183], v[96:111]
    s_add_u32 m0, s44, 69632
    s_add_u32 s46, s43, 331776
    buffer_load_dwordx4 v20, s[12:15], s46 offen offset:0 lds
    ds_read_b128 v[80:83], v12 offset:512
    s_waitcnt lgkmcnt(6)
    v_mfma_f32_32x32x16_bf16 v[96:111], v[88:91], v[184:187], v[96:111]
    ds_read_b128 v[84:87], v13 offset:512
    s_waitcnt lgkmcnt(6)
    v_mfma_f32_32x32x16_bf16 v[96:111], v[92:95], v[188:191], v[96:111]
    ds_read_b128 v[88:91], v14 offset:512
    s_waitcnt lgkmcnt(6)
    v_mfma_f32_32x32x16_bf16 v[96:111], v[64:67], v[192:195], v[96:111]
    buffer_load_dwordx4 v21, s[12:15], s46 offen offset:1024 lds
    ds_read_b128 v[92:95], v15 offset:512
    s_waitcnt lgkmcnt(6)
    v_mfma_f32_32x32x16_bf16 v[96:111], v[68:71], v[196:199], v[96:111]
    ds_read_b128 v[64:67], v8 offset:768
    s_waitcnt lgkmcnt(6)
    v_mfma_f32_32x32x16_bf16 v[96:111], v[72:75], v[200:203], v[96:111]
    ds_read_b128 v[68:71], v9 offset:768
    s_waitcnt lgkmcnt(6)
    v_mfma_f32_32x32x16_bf16 v[96:111], v[76:79], v[204:207], v[96:111]
    buffer_load_dwordx4 v22, s[12:15], s46 offen offset:2048 lds
    ds_read_b128 v[72:75], v10 offset:768
    s_waitcnt lgkmcnt(6)
    v_mfma_f32_32x32x16_bf16 v[96:111], v[80:83], v[208:211], v[96:111]
    ds_read_b128 v[76:79], v11 offset:768
    s_waitcnt lgkmcnt(6)
    v_mfma_f32_32x32x16_bf16 v[96:111], v[84:87], v[212:215], v[96:111]
    ds_read_b128 v[80:83], v12 offset:768
    s_waitcnt lgkmcnt(6)
    v_mfma_f32_32x32x16_bf16 v[96:111], v[88:91], v[216:219], v[96:111]
    buffer_load_dwordx4 v23, s[12:15], s46 offen offset:3072 lds
    ds_read_b128 v[84:87], v13 offset:768
    s_waitcnt lgkmcnt(6)
    v_mfma_f32_32x32x16_bf16 v[96:111], v[92:95], v[220:223], v[96:111]
    ds_read_b128 v[88:91], v14 offset:768
    s_waitcnt lgkmcnt(6)
    v_mfma_f32_32x32x16_bf16 v[96:111], v[64:67], v[224:227], v[96:111]
    ds_read_b128 v[92:95], v15 offset:768
    s_waitcnt lgkmcnt(6)
    v_mfma_f32_32x32x16_bf16 v[96:111], v[68:71], v[228:231], v[96:111]
    s_waitcnt lgkmcnt(5)
    v_mfma_f32_32x32x16_bf16 v[96:111], v[72:75], v[232:235], v[96:111]
    s_waitcnt lgkmcnt(4)
    v_mfma_f32_32x32x16_bf16 v[96:111], v[76:79], v[236:239], v[96:111]
    s_waitcnt lgkmcnt(3)
    v_mfma_f32_32x32x16_bf16 v[96:111], v[80:83], v[240:243], v[96:111]
    v_cvt_pk_bf16_f32 v56, v112, v113
    v_cvt_pk_bf16_f32 v57, v114, v115
    v_cvt_pk_bf16_f32 v58, v116, v117
    v_cvt_pk_bf16_f32 v59, v118, v119
    v_cvt_pk_bf16_f32 v60, v120, v121
    v_cvt_pk_bf16_f32 v61, v122, v123
    v_cvt_pk_bf16_f32 v62, v124, v125
    v_cvt_pk_bf16_f32 v63, v126, v127
    s_add_u32 s47, s45, 98304
    buffer_store_dwordx4 v[56:59], v4, s[20:23], s47 offen sc1
    buffer_store_dwordx4 v[60:63], v4, s[20:23], s47 offen offset:1024 sc1
    s_waitcnt lgkmcnt(2)
    v_mfma_f32_32x32x16_bf16 v[96:111], v[84:87], v[244:247], v[96:111]
    s_waitcnt lgkmcnt(1)
    v_mfma_f32_32x32x16_bf16 v[96:111], v[88:91], v[248:251], v[96:111]
    s_waitcnt lgkmcnt(0)
    v_mfma_f32_32x32x16_bf16 v[96:111], v[92:95], v[252:255], v[96:111]
    v_xor_b32 v8, 0x10000, v8
    v_xor_b32 v9, 0x10000, v9
    v_xor_b32 v10, 0x10000, v10
    v_xor_b32 v11, 0x10000, v11
    v_xor_b32 v12, 0x10000, v12
    v_xor_b32 v13, 0x10000, v13
    v_xor_b32 v14, 0x10000, v14
    v_xor_b32 v15, 0x10000, v15
    s_waitcnt vmcnt(2)
    s_barrier
    ds_read_b128 v[64:67], v8 offset:0
    ds_read_b128 v[68:71], v9 offset:0
    ds_read_b128 v[72:75], v10 offset:0
    ds_read_b128 v[76:79], v11 offset:0
    ds_read_b128 v[80:83], v12 offset:0
    ds_read_b128 v[84:87], v13 offset:0
    ds_read_b128 v[88:91], v14 offset:0
    s_waitcnt lgkmcnt(6)
    v_mfma_f32_32x32x16_bf16 v[112:127], v[64:67], v[128:131], 0
    ds_read_b128 v[92:95], v15 offset:0
    s_waitcnt lgkmcnt(6)
    v_mfma_f32_32x32x16_bf16 v[112:127], v[68:71], v[132:135], v[112:127]
    s_add_u32 m0, s44, 0
    s_add_u32 s46, s43, 393216
    buffer_load_dwordx4 v16, s[12:15], s46 offen offset:0 lds
    ds_read_b128 v[64:67], v8 offset:256
    s_waitcnt lgkmcnt(6)
    v_mfma_f32_32x32x16_bf16 v[112:127], v[72:75], v[136:139], v[112:127]
    ds_read_b128 v[68:71], v9 offset:256
    s_waitcnt lgkmcnt(6)
    v_mfma_f32_32x32x16_bf16 v[112:127], v[76:79], v[140:143], v[112:127]
    ds_read_b128 v[72:75], v10 offset:256
    s_waitcnt lgkmcnt(6)
    v_mfma_f32_32x32x16_bf16 v[112:127], v[80:83], v[144:147], v[112:127]
    buffer_load_dwordx4 v17, s[12:15], s46 offen offset:1024 lds
    ds_read_b128 v[76:79], v11 offset:256
    s_waitcnt lgkmcnt(6)
    v_mfma_f32_32x32x16_bf16 v[112:127], v[84:87], v[148:151], v[112:127]
    ds_read_b128 v[80:83], v12 offset:256
    s_waitcnt lgkmcnt(6)
    v_mfma_f32_32x32x16_bf16 v[112:127], v[88:91], v[152:155], v[112:127]
    ds_read_b128 v[84:87], v13 offset:256
    s_waitcnt lgkmcnt(6)
    v_mfma_f32_32x32x16_bf16 v[112:127], v[92:95], v[156:159], v[112:127]
    buffer_load_dwordx4 v18, s[12:15], s46 offen offset:2048 lds
    ds_read_b128 v[88:91], v14 offset:256
    s_waitcnt lgkmcnt(6)
    v_mfma_f32_32x32x16_bf16 v[112:127], v[64:67], v[160:163], v[112:127]
    ds_read_b128 v[92:95], v15 offset:256
    s_waitcnt lgkmcnt(6)
    v_mfma_f32_32x32x16_bf16 v[112:127], v[68:71], v[164:167], v[112:127]
    ds_read_b128 v[64:67], v8 offset:512
    s_waitcnt lgkmcnt(6)
    v_mfma_f32_32x32x16_bf16 v[112:127], v[72:75], v[168:171], v[112:127]
    buffer_load_dwordx4 v19, s[12:15], s46 offen offset:3072 lds
    ds_read_b128 v[68:71], v9 offset:512
    s_waitcnt lgkmcnt(6)
    v_mfma_f32_32x32x16_bf16 v[112:127], v[76:79], v[172:175], v[112:127]
    ds_read_b128 v[72:75], v10 offset:512
    s_waitcnt lgkmcnt(6)
    v_mfma_f32_32x32x16_bf16 v[112:127], v[80:83], v[176:179], v[112:127]
    ds_read_b128 v[76:79], v11 offset:512
    s_waitcnt lgkmcnt(6)
    v_mfma_f32_32x32x16_bf16 v[112:127], v[84:87], v[180:183], v[112:127]
    s_add_u32 m0, s44, 4096
    s_add_u32 s46, s43, 397312
    buffer_load_dwordx4 v20, s[12:15], s46 offen offset:0 lds
    ds_read_b128 v[80:83], v12 offset:512
    s_waitcnt lgkmcnt(6)
    v_mfma_f32_32x32x16_bf16 v[112:127], v[88:91], v[184:187], v[112:127]
    ds_read_b128 v[84:87], v13 offset:512
    s_waitcnt lgkmcnt(6)
    v_mfma_f32_32x32x16_bf16 v[112:127], v[92:95], v[188:191], v[112:127]
    ds_read_b128 v[88:91], v14 offset:512
    s_waitcnt lgkmcnt(6)
    v_mfma_f32_32x32x16_bf16 v[112:127], v[64:67], v[192:195], v[112:127]
    buffer_load_dwordx4 v21, s[12:15], s46 offen offset:1024 lds
    ds_read_b128 v[92:95], v15 offset:512
    s_waitcnt lgkmcnt(6)
    v_mfma_f32_32x32x16_bf16 v[112:127], v[68:71], v[196:199], v[112:127]
    ds_read_b128 v[64:67], v8 offset:768
    s_waitcnt lgkmcnt(6)
    v_mfma_f32_32x32x16_bf16 v[112:127], v[72:75], v[200:203], v[112:127]
    ds_read_b128 v[68:71], v9 offset:768
    s_waitcnt lgkmcnt(6)
    v_mfma_f32_32x32x16_bf16 v[112:127], v[76:79], v[204:207], v[112:127]
    buffer_load_dwordx4 v22, s[12:15], s46 offen offset:2048 lds
    ds_read_b128 v[72:75], v10 offset:768
    s_waitcnt lgkmcnt(6)
    v_mfma_f32_32x32x16_bf16 v[112:127], v[80:83], v[208:211], v[112:127]
    ds_read_b128 v[76:79], v11 offset:768
    s_waitcnt lgkmcnt(6)
    v_mfma_f32_32x32x16_bf16 v[112:127], v[84:87], v[212:215], v[112:127]
    ds_read_b128 v[80:83], v12 offset:768
    s_waitcnt lgkmcnt(6)
    v_mfma_f32_32x32x16_bf16 v[112:127], v[88:91], v[216:219], v[112:127]
    buffer_load_dwordx4 v23, s[12:15], s46 offen offset:3072 lds
    ds_read_b128 v[84:87], v13 offset:768
    s_waitcnt lgkmcnt(6)
    v_mfma_f32_32x32x16_bf16 v[112:127], v[92:95], v[220:223], v[112:127]
    ds_read_b128 v[88:91], v14 offset:768
    s_waitcnt lgkmcnt(6)
    v_mfma_f32_32x32x16_bf16 v[112:127], v[64:67], v[224:227], v[112:127]
    ds_read_b128 v[92:95], v15 offset:768
    s_waitcnt lgkmcnt(6)
    v_mfma_f32_32x32x16_bf16 v[112:127], v[68:71], v[228:231], v[112:127]
    s_waitcnt lgkmcnt(5)
    v_mfma_f32_32x32x16_bf16 v[112:127], v[72:75], v[232:235], v[112:127]
    s_waitcnt lgkmcnt(4)
    v_mfma_f32_32x32x16_bf16 v[112:127], v[76:79], v[236:239], v[112:127]
    s_waitcnt lgkmcnt(3)
    v_mfma_f32_32x32x16_bf16 v[112:127], v[80:83], v[240:243], v[112:127]
    v_cvt_pk_bf16_f32 v56, v96, v97
    v_cvt_pk_bf16_f32 v57, v98, v99
    v_cvt_pk_bf16_f32 v58, v100, v101
    v_cvt_pk_bf16_f32 v59, v102, v103
    v_cvt_pk_bf16_f32 v60, v104, v105
    v_cvt_pk_bf16_f32 v61, v106, v107
    v_cvt_pk_bf16_f32 v62, v108, v109
    v_cvt_pk_bf16_f32 v63, v110, v111
    s_add_u32 s47, s45, 131072
    buffer_store_dwordx4 v[56:59], v4, s[20:23], s47 offen sc1
    buffer_store_dwordx4 v[60:63], v4, s[20:23], s47 offen offset:1024 sc1
    s_waitcnt lgkmcnt(2)
    v_mfma_f32_32x32x16_bf16 v[112:127], v[84:87], v[244:247], v[112:127]
    s_waitcnt lgkmcnt(1)
    v_mfma_f32_32x32x16_bf16 v[112:127], v[88:91], v[248:251], v[112:127]
    s_waitcnt lgkmcnt(0)
    v_mfma_f32_32x32x16_bf16 v[112:127], v[92:95], v[252:255], v[112:127]
    v_xor_b32 v8, 0x10000, v8
    v_xor_b32 v9, 0x10000, v9
    v_xor_b32 v10, 0x10000, v10
    v_xor_b32 v11, 0x10000, v11
    v_xor_b32 v12, 0x10000, v12
    v_xor_b32 v13, 0x10000, v13
    v_xor_b32 v14, 0x10000, v14
    v_xor_b32 v15, 0x10000, v15
    s_waitcnt vmcnt(2)
    s_barrier
    ds_read_b128 v[64:67], v8 offset:0
    ds_read_b128 v[68:71], v9 offset:0
    ds_read_b128 v[72:75], v10 offset:0
    ds_read_b128 v[76:79], v11 offset:0
    ds_read_b128 v[80:83], v12 offset:0
    ds_read_b128 v[84:87], v13 offset:0
    ds_read_b128 v[88:91], v14 offset:0
    s_waitcnt lgkmcnt(6)
    v_mfma_f32_32x32x16_bf16 v[96:111], v[64:67], v[128:131], 0
    ds_read_b128 v[92:95], v15 offset:0
    s_waitcnt lgkmcnt(6)
    v_mfma_f32_32x32x16_bf16 v[96:111], v[68:71], v[132:135], v[96:111]
    s_add_u32 m0, s44, 65536
    s_add_u32 s46, s43, 458752
    buffer_load_dwordx4 v16, s[12:15], s46 offen offset:0 lds
    ds_read_b128 v[64:67], v8 offset:256
    s_waitcnt lgkmcnt(6)
    v_mfma_f32_32x32x16_bf16 v[96:111], v[72:75], v[136:139], v[96:111]
    ds_read_b128 v[68:71], v9 offset:256
    s_waitcnt lgkmcnt(6)
    v_mfma_f32_32x32x16_bf16 v[96:111], v[76:79], v[140:143], v[96:111]
    ds_read_b128 v[72:75], v10 offset:256
    s_waitcnt lgkmcnt(6)
    v_mfma_f32_32x32x16_bf16 v[96:111], v[80:83], v[144:147], v[96:111]
    buffer_load_dwordx4 v17, s[12:15], s46 offen offset:1024 lds
    ds_read_b128 v[76:79], v11 offset:256
    s_waitcnt lgkmcnt(6)
    v_mfma_f32_32x32x16_bf16 v[96:111], v[84:87], v[148:151], v[96:111]
    ds_read_b128 v[80:83], v12 offset:256
    s_waitcnt lgkmcnt(6)
    v_mfma_f32_32x32x16_bf16 v[96:111], v[88:91], v[152:155], v[96:111]
    ds_read_b128 v[84:87], v13 offset:256
    s_waitcnt lgkmcnt(6)
    v_mfma_f32_32x32x16_bf16 v[96:111], v[92:95], v[156:159], v[96:111]
    buffer_load_dwordx4 v18, s[12:15], s46 offen offset:2048 lds
    ds_read_b128 v[88:91], v14 offset:256
    s_waitcnt lgkmcnt(6)
    v_mfma_f32_32x32x16_bf16 v[96:111], v[64:67], v[160:163], v[96:111]
    ds_read_b128 v[92:95], v15 offset:256
    s_waitcnt lgkmcnt(6)
    v_mfma_f32_32x32x16_bf16 v[96:111], v[68:71], v[164:167], v[96:111]
    ds_read_b128 v[64:67], v8 offset:512
    s_waitcnt lgkmcnt(6)
    v_mfma_f32_32x32x16_bf16 v[96:111], v[72:75], v[168:171], v[96:111]
    buffer_load_dwordx4 v19, s[12:15], s46 offen offset:3072 lds
    ds_read_b128 v[68:71], v9 offset:512
    s_waitcnt lgkmcnt(6)
    v_mfma_f32_32x32x16_bf16 v[96:111], v[76:79], v[172:175], v[96:111]
    ds_read_b128 v[72:75], v10 offset:512
    s_waitcnt lgkmcnt(6)
    v_mfma_f32_32x32x16_bf16 v[96:111], v[80:83], v[176:179], v[96:111]
    ds_read_b128 v[76:79], v11 offset:512
    s_waitcnt lgkmcnt(6)
    v_mfma_f32_32x32x16_bf16 v[96:111], v[84:87], v[180:183], v[96:111]
    s_add_u32 m0, s44, 69632
    s_add_u32 s46, s43, 462848
    buffer_load_dwordx4 v20, s[12:15], s46 offen offset:0 lds
    ds_read_b128 v[80:83], v12 offset:512
    s_waitcnt lgkmcnt(6)
    v_mfma_f32_32x32x16_bf16 v[96:111], v[88:91], v[184:187], v[96:111]
    ds_read_b128 v[84:87], v13 offset:512
    s_waitcnt lgkmcnt(6)
    v_mfma_f32_32x32x16_bf16 v[96:111], v[92:95], v[188:191], v[96:111]
    ds_read_b128 v[88:91], v14 offset:512
    s_waitcnt lgkmcnt(6)
    v_mfma_f32_32x32x16_bf16 v[96:111], v[64:67], v[192:195], v[96:111]
    buffer_load_dwordx4 v21, s[12:15], s46 offen offset:1024 lds
    ds_read_b128 v[92:95], v15 offset:512
    s_waitcnt lgkmcnt(6)
    v_mfma_f32_32x32x16_bf16 v[96:111], v[68:71], v[196:199], v[96:111]
    ds_read_b128 v[64:67], v8 offset:768
    s_waitcnt lgkmcnt(6)
    v_mfma_f32_32x32x16_bf16 v[96:111], v[72:75], v[200:203], v[96:111]
    ds_read_b128 v[68:71], v9 offset:768
    s_waitcnt lgkmcnt(6)
    v_mfma_f32_32x32x16_bf16 v[96:111], v[76:79], v[204:207], v[96:111]
    buffer_load_dwordx4 v22, s[12:15], s46 offen offset:2048 lds
    ds_read_b128 v[72:75], v10 offset:768
    s_waitcnt lgkmcnt(6)
    v_mfma_f32_32x32x16_bf16 v[96:111], v[80:83], v[208:211], v[96:111]
    ds_read_b128 v[76:79], v11 offset:768
    s_waitcnt lgkmcnt(6)
    v_mfma_f32_32x32x16_bf16 v[96:111], v[84:87], v[212:215], v[96:111]
    ds_read_b128 v[80:83], v12 offset:768
    s_waitcnt lgkmcnt(6)
    v_mfma_f32_32x32x16_bf16 v[96:111], v[88:91], v[216:219], v[96:111]
    buffer_load_dwordx4 v23, s[12:15], s46 offen offset:3072 lds
    ds_read_b128 v[84:87], v13 offset:768
    s_waitcnt lgkmcnt(6)
    v_mfma_f32_32x32x16_bf16 v[96:111], v[92:95], v[220:223], v[96:111]
    ds_read_b128 v[88:91], v14 offset:768
    s_waitcnt lgkmcnt(6)
    v_mfma_f32_32x32x16_bf16 v[96:111], v[64:67], v[224:227], v[96:111]
    ds_read_b128 v[92:95], v15 offset:768
    s_waitcnt lgkmcnt(6)
    v_mfma_f32_32x32x16_bf16 v[96:111], v[68:71], v[228:231], v[96:111]
    s_waitcnt lgkmcnt(5)
    v_mfma_f32_32x32x16_bf16 v[96:111], v[72:75], v[232:235], v[96:111]
    s_waitcnt lgkmcnt(4)
    v_mfma_f32_32x32x16_bf16 v[96:111], v[76:79], v[236:239], v[96:111]
    s_waitcnt lgkmcnt(3)
    v_mfma_f32_32x32x16_bf16 v[96:111], v[80:83], v[240:243], v[96:111]
    v_cvt_pk_bf16_f32 v56, v112, v113
    v_cvt_pk_bf16_f32 v57, v114, v115
    v_cvt_pk_bf16_f32 v58, v116, v117
    v_cvt_pk_bf16_f32 v59, v118, v119
    v_cvt_pk_bf16_f32 v60, v120, v121
    v_cvt_pk_bf16_f32 v61, v122, v123
    v_cvt_pk_bf16_f32 v62, v124, v125
    v_cvt_pk_bf16_f32 v63, v126, v127
    s_add_u32 s47, s45, 163840
    buffer_store_dwordx4 v[56:59], v4, s[20:23], s47 offen sc1
    buffer_store_dwordx4 v[60:63], v4, s[20:23], s47 offen offset:1024 sc1
    s_waitcnt lgkmcnt(2)
    v_mfma_f32_32x32x16_bf16 v[96:111], v[84:87], v[244:247], v[96:111]
    s_waitcnt lgkmcnt(1)
    v_mfma_f32_32x32x16_bf16 v[96:111], v[88:91], v[248:251], v[96:111]
    s_waitcnt lgkmcnt(0)
    v_mfma_f32_32x32x16_bf16 v[96:111], v[92:95], v[252:255], v[96:111]
    v_xor_b32 v8, 0x10000, v8
    v_xor_b32 v9, 0x10000, v9
    v_xor_b32 v10, 0x10000, v10
    v_xor_b32 v11, 0x10000, v11
    v_xor_b32 v12, 0x10000, v12
    v_xor_b32 v13, 0x10000, v13
    v_xor_b32 v14, 0x10000, v14
    v_xor_b32 v15, 0x10000, v15
    s_waitcnt vmcnt(2)
    s_barrier
    ds_read_b128 v[64:67], v8 offset:0
    ds_read_b128 v[68:71], v9 offset:0
    ds_read_b128 v[72:75], v10 offset:0
    ds_read_b128 v[76:79], v11 offset:0
    ds_read_b128 v[80:83], v12 offset:0
    ds_read_b128 v[84:87], v13 offset:0
    ds_read_b128 v[88:91], v14 offset:0
    s_waitcnt lgkmcnt(6)
    v_mfma_f32_32x32x16_bf16 v[112:127], v[64:67], v[128:131], 0
    ds_read_b128 v[92:95], v15 offset:0
    s_waitcnt lgkmcnt(6)
    v_mfma_f32_32x32x16_bf16 v[112:127], v[68:71], v[132:135], v[112:127]
    ds_read_b128 v[64:67], v8 offset:256
    s_waitcnt lgkmcnt(6)
    v_mfma_f32_32x32x16_bf16 v[112:127], v[72:75], v[136:139], v[112:127]
    ds_read_b128 v[68:71], v9 offset:256
    s_waitcnt lgkmcnt(6)
    v_mfma_f32_32x32x16_bf16 v[112:127], v[76:79], v[140:143], v[112:127]
    ds_read_b128 v[72:75], v10 offset:256
    s_waitcnt lgkmcnt(6)
    v_mfma_f32_32x32x16_bf16 v[112:127], v[80:83], v[144:147], v[112:127]
    ds_read_b128 v[76:79], v11 offset:256
    s_waitcnt lgkmcnt(6)
    v_mfma_f32_32x32x16_bf16 v[112:127], v[84:87], v[148:151], v[112:127]
    ds_read_b128 v[80:83], v12 offset:256
    s_waitcnt lgkmcnt(6)
    v_mfma_f32_32x32x16_bf16 v[112:127], v[88:91], v[152:155], v[112:127]
    ds_read_b128 v[84:87], v13 offset:256
    s_waitcnt lgkmcnt(6)
    v_mfma_f32_32x32x16_bf16 v[112:127], v[92:95], v[156:159], v[112:127]
    ds_read_b128 v[88:91], v14 offset:256
    s_waitcnt lgkmcnt(6)
    v_mfma_f32_32x32x16_bf16 v[112:127], v[64:67], v[160:163], v[112:127]
    ds_read_b128 v[92:95], v15 offset:256
    s_waitcnt lgkmcnt(6)
    v_mfma_f32_32x32x16_bf16 v[112:127], v[68:71], v[164:167], v[112:127]
    ds_read_b128 v[64:67], v8 offset:512
    s_waitcnt lgkmcnt(6)
    v_mfma_f32_32x32x16_bf16 v[112:127], v[72:75], v[168:171], v[112:127]
    ds_read_b128 v[68:71], v9 offset:512
    s_waitcnt lgkmcnt(6)
    v_mfma_f32_32x32x16_bf16 v[112:127], v[76:79], v[172:175], v[112:127]
    ds_read_b128 v[72:75], v10 offset:512
    s_waitcnt lgkmcnt(6)
    v_mfma_f32_32x32x16_bf16 v[112:127], v[80:83], v[176:179], v[112:127]
    ds_read_b128 v[76:79], v11 offset:512
    s_waitcnt lgkmcnt(6)
    v_mfma_f32_32x32x16_bf16 v[112:127], v[84:87], v[180:183], v[112:127]
    ds_read_b128 v[80:83], v12 offset:512
    s_waitcnt lgkmcnt(6)
    v_mfma_f32_32x32x16_bf16 v[112:127], v[88:91], v[184:187], v[112:127]
    ds_read_b128 v[84:87], v13 offset:512
    s_waitcnt lgkmcnt(6)
    v_mfma_f32_32x32x16_bf16 v[112:127], v[92:95], v[188:191], v[112:127]
    ds_read_b128 v[88:91], v14 offset:512
    s_waitcnt lgkmcnt(6)
    v_mfma_f32_32x32x16_bf16 v[112:127], v[64:67], v[192:195], v[112:127]
    ds_read_b128 v[92:95], v15 offset:512
    s_waitcnt lgkmcnt(6)
    v_mfma_f32_32x32x16_bf16 v[112:127], v[68:71], v[196:199], v[112:127]
    ds_read_b128 v[64:67], v8 offset:768
    s_waitcnt lgkmcnt(6)
    v_mfma_f32_32x32x16_bf16 v[112:127], v[72:75], v[200:203], v[112:127]
    ds_read_b128 v[68:71], v9 offset:768
    s_waitcnt lgkmcnt(6)
    v_mfma_f32_32x32x16_bf16 v[112:127], v[76:79], v[204:207], v[112:127]
    ds_read_b128 v[72:75], v10 offset:768
    s_waitcnt lgkmcnt(6)
    v_mfma_f32_32x32x16_bf16 v[112:127], v[80:83], v[208:211], v[112:127]
    ds_read_b128 v[76:79], v11 offset:768
    s_waitcnt lgkmcnt(6)
    v_mfma_f32_32x32x16_bf16 v[112:127], v[84:87], v[212:215], v[112:127]
    ds_read_b128 v[80:83], v12 offset:768
    s_waitcnt lgkmcnt(6)
    v_mfma_f32_32x32x16_bf16 v[112:127], v[88:91], v[216:219], v[112:127]
    ds_read_b128 v[84:87], v13 offset:768
    s_waitcnt lgkmcnt(6)
    v_mfma_f32_32x32x16_bf16 v[112:127], v[92:95], v[220:223], v[112:127]
    ds_read_b128 v[88:91], v14 offset:768
    s_waitcnt lgkmcnt(6)
    v_mfma_f32_32x32x16_bf16 v[112:127], v[64:67], v[224:227], v[112:127]
    ds_read_b128 v[92:95], v15 offset:768
    s_waitcnt lgkmcnt(6)
    v_mfma_f32_32x32x16_bf16 v[112:127], v[68:71], v[228:231], v[112:127]
    s_waitcnt lgkmcnt(5)
    v_mfma_f32_32x32x16_bf16 v[112:127], v[72:75], v[232:235], v[112:127]
    s_waitcnt lgkmcnt(4)
    v_mfma_f32_32x32x16_bf16 v[112:127], v[76:79], v[236:239], v[112:127]
    s_waitcnt lgkmcnt(3)
    v_mfma_f32_32x32x16_bf16 v[112:127], v[80:83], v[240:243], v[112:127]
    v_cvt_pk_bf16_f32 v56, v96, v97
    v_cvt_pk_bf16_f32 v57, v98, v99
    v_cvt_pk_bf16_f32 v58, v100, v101
    v_cvt_pk_bf16_f32 v59, v102, v103
    v_cvt_pk_bf16_f32 v60, v104, v105
    v_cvt_pk_bf16_f32 v61, v106, v107
    v_cvt_pk_bf16_f32 v62, v108, v109
    v_cvt_pk_bf16_f32 v63, v110, v111
    s_add_u32 s47, s45, 196608
    buffer_store_dwordx4 v[56:59], v4, s[20:23], s47 offen sc1
    buffer_store_dwordx4 v[60:63], v4, s[20:23], s47 offen offset:1024 sc1
    s_waitcnt lgkmcnt(2)
    v_mfma_f32_32x32x16_bf16 v[112:127], v[84:87], v[244:247], v[112:127]
    s_waitcnt lgkmcnt(1)
    v_mfma_f32_32x32x16_bf16 v[112:127], v[88:91], v[248:251], v[112:127]
    s_waitcnt lgkmcnt(0)
    v_mfma_f32_32x32x16_bf16 v[112:127], v[92:95], v[252:255], v[112:127]
    s_nop 15
    v_cvt_pk_bf16_f32 v56, v112, v113
    v_cvt_pk_bf16_f32 v57, v114, v115
    v_cvt_pk_bf16_f32 v58, v116, v117
    v_cvt_pk_bf16_f32 v59, v118, v119
    v_cvt_pk_bf16_f32 v60, v120, v121
    v_cvt_pk_bf16_f32 v61, v122, v123
    v_cvt_pk_bf16_f32 v62, v124, v125
    v_cvt_pk_bf16_f32 v63, v126, v127
    s_add_u32 s47, s45, 229376
    buffer_store_dwordx4 v[56:59], v4, s[20:23], s47 offen sc1
    buffer_store_dwordx4 v[60:63], v4, s[20:23], s47 offen offset:1024 sc1
    s_load_dwordx2 s[50:51], s[0:1], 104
    s_load_dwordx2 s[56:57], s[0:1], 0
    s_lshl_b32 s52, s2, 3
    s_add_u32 s52, s52, s30
    s_lshl_b32 s53, s52, 10
    v_lshlrev_b32 v24, 4, v1
    v_add_u32 v24, s53, v24
    v_lshlrev_b32 v25, 5, v1
    v_mov_b32 v26, 0
    s_waitcnt lgkmcnt(0)
    global_load_dwordx4 v[28:31], v24, s[56:57]
kv_kernel_hw8:
    global_load_dword v27, v26, s[50:51] offset:64 sc0 sc1
    s_waitcnt vmcnt(0)
    v_readfirstlane_b32 s54, v27
    s_nop 3
    s_cmp_ge_u32 s54, 48
    s_cbranch_scc1 kv_kernel_hw8_ok
    s_sleep 8
    s_branch kv_kernel_hw8
kv_kernel_hw8_ok:
    global_load_dwordx4 v[40:43], v25, s[8:9] sc0 sc1
    global_load_dwordx4 v[44:47], v25, s[8:9] offset:16 sc0 sc1
    global_load_dwordx4 v[48:51], v25, s[8:9] offset:2048 sc0 sc1
    global_load_dwordx4 v[52:55], v25, s[8:9] offset:2064 sc0 sc1
    v_lshlrev_b32 v32, 16, v28
    v_and_b32 v33, 0xffff0000, v28
    v_lshlrev_b32 v34, 16, v29
    v_and_b32 v35, 0xffff0000, v29
    v_lshlrev_b32 v36, 16, v30
    v_and_b32 v37, 0xffff0000, v30
    v_lshlrev_b32 v38, 16, v31
    v_and_b32 v39, 0xffff0000, v31
    v_add_f32 v26, v32, v33
    v_add_f32 v26, v26, v34
    v_add_f32 v26, v26, v35
    v_add_f32 v26, v26, v36
    v_add_f32 v26, v26, v37
    v_add_f32 v26, v26, v38
    v_add_f32 v26, v26, v39
    s_nop 1
    v_add_f32_dpp v26, v26, v26 quad_perm:[1,0,3,2] row_mask:0xf bank_mask:0xf
    s_nop 1
    v_add_f32_dpp v26, v26, v26 quad_perm:[2,3,0,1] row_mask:0xf bank_mask:0xf
    s_nop 1
    v_add_f32_dpp v26, v26, v26 row_half_mirror row_mask:0xf bank_mask:0xf
    s_nop 1
    v_add_f32_dpp v26, v26, v26 row_mirror row_mask:0xf bank_mask:0xf
    s_nop 1
    v_readlane_b32 s54, v26, 0
    v_readlane_b32 s55, v26, 16
    v_readlane_b32 s56, v26, 32
    v_readlane_b32 s57, v26, 48
    s_nop 1
    v_mov_b32 v26, s54
    v_add_f32 v26, s55, v26
    v_add_f32 v26, s56, v26
    v_add_f32 v26, s57, v26
    v_mul_f32 v26, 0x3b000000, v26
    v_sub_f32 v32, v32, v26
    v_sub_f32 v33, v33, v26
    v_sub_f32 v34, v34, v26
    v_sub_f32 v35, v35, v26
    v_sub_f32 v36, v36, v26
    v_sub_f32 v37, v37, v26
    v_sub_f32 v38, v38, v26
    v_sub_f32 v39, v39, v26
    v_mul_f32 v26, v32, v32
    v_fmac_f32 v26, v33, v33
    v_fmac_f32 v26, v34, v34
    v_fmac_f32 v26, v35, v35
    v_fmac_f32 v26, v36, v36
    v_fmac_f32 v26, v37, v37
    v_fmac_f32 v26, v38, v38
    v_fmac_f32 v26, v39, v39
    s_nop 1
    v_add_f32_dpp v26, v26, v26 quad_perm:[1,0,3,2] row_mask:0xf bank_mask:0xf
    s_nop 1
    v_add_f32_dpp v26, v26, v26 quad_perm:[2,3,0,1] row_mask:0xf bank_mask:0xf
    s_nop 1
    v_add_f32_dpp v26, v26, v26 row_half_mirror row_mask:0xf bank_mask:0xf
    s_nop 1
    v_add_f32_dpp v26, v26, v26 row_mirror row_mask:0xf bank_mask:0xf
    s_nop 1
    v_readlane_b32 s54, v26, 0
    v_readlane_b32 s55, v26, 16
    v_readlane_b32 s56, v26, 32
    v_readlane_b32 s57, v26, 48
    s_nop 1
    v_mov_b32 v26, s54
    v_add_f32 v26, s55, v26
    v_add_f32 v26, s56, v26
    v_add_f32 v26, s57, v26
    v_mov_b32 v27, 0x3727c5ac
    v_fmac_f32 v27, 0x3b000000, v26
    v_rsq_f32 v27, v27
    s_nop 0
    v_mul_f32 v32, v32, v27
    v_mul_f32 v33, v33, v27
    v_mul_f32 v34, v34, v27
    v_mul_f32 v35, v35, v27
    v_mul_f32 v36, v36, v27
    v_mul_f32 v37, v37, v27
    v_mul_f32 v38, v38, v27
    v_mul_f32 v39, v39, v27
    s_waitcnt vmcnt(0)
    v_add_f32 v48, 1.0, v48
    v_fma_f32 v32, v32, v48, v40
    v_add_f32 v49, 1.0, v49
    v_fma_f32 v33, v33, v49, v41
    v_add_f32 v50, 1.0, v50
    v_fma_f32 v34, v34, v50, v42
    v_add_f32 v51, 1.0, v51
    v_fma_f32 v35, v35, v51, v43
    v_add_f32 v52, 1.0, v52
    v_fma_f32 v36, v36, v52, v44
    v_add_f32 v53, 1.0, v53
    v_fma_f32 v37, v37, v53, v45
    v_add_f32 v54, 1.0, v54
    v_fma_f32 v38, v38, v54, v46
    v_add_f32 v55, 1.0, v55
    v_fma_f32 v39, v39, v55, v47
    v_cvt_pk_bf16_f32 v28, v32, v33
    v_cvt_pk_bf16_f32 v29, v34, v35
    v_cvt_pk_bf16_f32 v30, v36, v37
    v_cvt_pk_bf16_f32 v31, v38, v39
    s_lshr_b32 s53, s52, 5
    s_lshl_b32 s53, s53, 15
    s_and_b32 s54, s52, 31
    s_lshl_b32 s54, s54, 4
    s_add_u32 s53, s53, s54
    s_add_u32 s53, s53, 1048576
    v_lshrrev_b32 v24, 1, v1
    v_lshlrev_b32 v24, 10, v24
    v_and_b32 v25, 1, v1
    v_lshlrev_b32 v25, 9, v25
    v_add_u32 v24, v24, v25
    v_add_u32 v24, s53, v24
    global_store_dwordx4 v24, v[28:31], s[8:9]
kv_kernel_end:
    s_endpgm
.globl attn_kernel
.p2align 8
.type attn_kernel,@function
attn_kernel:
    s_cmp_ge_u32 s2, 256
    s_cbranch_scc1 attn_kernel_end
    s_load_dwordx2 s[4:5], s[0:1], 16
    s_load_dwordx2 s[8:9], s[0:1], 112
    v_and_b32 v1, 63, v0
    v_lshrrev_b32 v5, 6, v0
    s_nop 0
    v_readfirstlane_b32 s30, v5
    s_and_b32 s31, s30, 3
    s_lshr_b32 s32, s30, 2
    s_and_b32 s33, s2, 7
    s_lshr_b32 s34, s2, 3
    s_and_b32 s35, s34, 3
    s_lshl_b32 s33, s33, 2
    s_add_u32 s33, s33, s35
    s_lshr_b32 s34, s34, 2
    s_sub_u32 s35, 15, s34
    s_waitcnt lgkmcnt(0)
    s_add_u32 s12, s8, 1048576
    s_addc_u32 s13, s9, 0
    s_mov_b32 s14, 2097152
    s_mov_b32 s15, 0x00020000
    s_mov_b32 s16, s4
    s_mov_b32 s17, s5
    s_mov_b32 s18, 4194304
    s_mov_b32 s19, 0x00020000
    s_add_u32 s20, s8, 51380224
    s_addc_u32 s21, s9, 0
    s_mov_b32 s22, 33554432
    s_mov_b32 s23, 0x00020000
    s_add_u32 s24, s8, 17825792
    s_addc_u32 s25, s9, 0
    s_mov_b32 s26, 16777216
    s_mov_b32 s27, 0x00020000
    s_add_u32 s4, s8, 84934656
    s_addc_u32 s5, s9, 0
    s_mov_b32 s6, 20971520
    s_mov_b32 s7, 0x00020000
    v_lshlrev_b32 v2, 4, v1
    s_cmp_eq_u32 s32, 0
    s_cselect_b32 s36, s35, s34
    s_lshl_b32 s36, s36, 2
    s_add_u32 s36, s36, s31
    s_lshl_b32 s36, s36, 15
    v_lshrrev_b32 v5, 4, v1
    v_and_b32 v6, 15, v1
    v_lshlrev_b32 v7, 2, v5
    v_xor_b32 v6, v6, v7
    v_lshlrev_b32 v6, 4, v6
    v_lshlrev_b32 v5, 13, v5
    v_add_u32 v3, v5, v6
    s_lshl_b32 s40, s33, 8
    s_lshl_b32 s41, s30, 17
    s_add_u32 s40, s40, s41
    s_lshl_b32 s42, s30, 12
    s_add_u32 m0, s42, 0
    s_add_u32 s46, s40, 0
    buffer_load_dwordx4 v3, s[16:19], s46 offen lds
    s_add_u32 m0, s42, 1024
    s_add_u32 s46, s40, 32768
    buffer_load_dwordx4 v3, s[16:19], s46 offen lds
    s_add_u32 m0, s42, 2048
    s_add_u32 s46, s40, 65536
    buffer_load_dwordx4 v3, s[16:19], s46 offen lds
    s_add_u32 m0, s42, 3072
    s_add_u32 s46, s40, 98304
    buffer_load_dwordx4 v3, s[16:19], s46 offen lds
    s_add_u32 s46, s36, 0
    buffer_load_dwordx4 v[128:131], v2, s[12:15], s46 offen offset:0
    s_add_u32 s46, s36, 0
    buffer_load_dwordx4 v[132:135], v2, s[12:15], s46 offen offset:1024
    s_add_u32 s46, s36, 0
    buffer_load_dwordx4 v[136:139], v2, s[12:15], s46 offen offset:2048
    s_add_u32 s46, s36, 0
    buffer_load_dwordx4 v[140:143], v2, s[12:15], s46 offen offset:3072
    s_add_u32 s46, s36, 4096
    buffer_load_dwordx4 v[144:147], v2, s[12:15], s46 offen offset:0
    s_add_u32 s46, s36, 4096
    buffer_load_dwordx4 v[148:151], v2, s[12:15], s46 offen offset:1024
    s_add_u32 s46, s36, 4096
    buffer_load_dwordx4 v[152:155], v2, s[12:15], s46 offen offset:2048
    s_add_u32 s46, s36, 4096
    buffer_load_dwordx4 v[156:159], v2, s[12:15], s46 offen offset:3072
    s_add_u32 m0, s42, 32768
    s_add_u32 s46, s40, 1048576
    buffer_load_dwordx4 v3, s[16:19], s46 offen lds
    s_add_u32 m0, s42, 33792
    s_add_u32 s46, s40, 1081344
    buffer_load_dwordx4 v3, s[16:19], s46 offen lds
    s_add_u32 m0, s42, 34816
    s_add_u32 s46, s40, 1114112
    buffer_load_dwordx4 v3, s[16:19], s46 offen lds
    s_add_u32 m0, s42, 35840
    s_add_u32 s46, s40, 1146880
    buffer_load_dwordx4 v3, s[16:19], s46 offen lds
    s_add_u32 s46, s36, 8192
    buffer_load_dwordx4 v[160:163], v2, s[12:15], s46 offen offset:0
    s_add_u32 s46, s36, 8192
    buffer_load_dwordx4 v[164:167], v2, s[12:15], s46 offen offset:1024
    s_add_u32 s46, s36, 8192
    buffer_load_dwordx4 v[168:171], v2, s[12:15], s46 offen offset:2048
    s_add_u32 s46, s36, 8192
    buffer_load_dwordx4 v[172:175], v2, s[12:15], s46 offen offset:3072
    s_add_u32 s46, s36, 12288
    buffer_load_dwordx4 v[176:179], v2, s[12:15], s46 offen offset:0
    s_add_u32 s46, s36, 12288
    buffer_load_dwordx4 v[180:183], v2, s[12:15], s46 offen offset:1024
    s_add_u32 s46, s36, 12288
    buffer_load_dwordx4 v[184:187], v2, s[12:15], s46 offen offset:2048
    s_add_u32 s46, s36, 12288
    buffer_load_dwordx4 v[188:191], v2, s[12:15], s46 offen offset:3072
    s_lshl_b32 s43, s32, 16
    s_lshl_b32 s44, s33, 20
    s_lshr_b32 s45, s31, 1
    s_lshl_b32 s45, s45, 14
    s_add_u32 s44, s44, s45
    s_and_b32 s45, s31, 1
    s_lshl_b32 s45, s45, 12
    s_add_u32 s44, s44, s45
    s_lshl_b32 s45, s31, 12
    s_add_u32 s45, s45, s43
    s_add_u32 s49, s34, 1
    s_lshl_b32 s49, s49, 1
    v_and_b32 v8, 15, v1
    v_lshrrev_b32 v9, 2, v8
    v_and_b32 v10, 3, v8
    v_lshrrev_b32 v8, 5, v1
    v_lshlrev_b32 v8, 3, v8
    v_add_u32 v8, v8, v9
    v_lshlrev_b32 v8, 8, v8
    v_lshrrev_b32 v11, 4, v1
    v_and_b32 v11, 1, v11
    v_lshlrev_b32 v11, 5, v11
    v_add_u32 v8, v8, v11
    v_lshlrev_b32 v10, 3, v10
    v_add_u32 v8, v8, v10
    v_xor_b32 v10, 0, v9
    v_lshlrev_b32 v10, 6, v10
    v_add_u32 v4, v8, v10
    v_xor_b32 v10, 1, v9
    v_lshlrev_b32 v10, 6, v10
    v_add_u32 v5, v8, v10
    v_xor_b32 v10, 2, v9
    v_lshlrev_b32 v10, 6, v10
    v_add_u32 v6, v8, v10
    v_xor_b32 v10, 3, v9
    v_lshlrev_b32 v10, 6, v10
    v_add_u32 v7, v8, v10
    v_add_u32 v12, 0x10000, v4
    v_add_u32 v16, 0x20000, v4
    v_add_u32 v13, 0x10000, v5
    v_add_u32 v17, 0x20000, v5
    v_add_u32 v14, 0x10000, v6
    v_add_u32 v18, 0x20000, v6
    v_add_u32 v15, 0x10000, v7
    v_add_u32 v19, 0x20000, v7
    s_waitcnt vmcnt(12)
    s_barrier
    ds_read_b64_tr_b16 v[32:33], v4 offset:0
    ds_read_b64_tr_b16 v[34:35], v4 offset:1024
    ds_read_b64_tr_b16 v[36:37], v5 offset:0
    ds_read_b64_tr_b16 v[38:39], v5 offset:1024
    ds_read_b64_tr_b16 v[40:41], v6 offset:0
    ds_read_b64_tr_b16 v[42:43], v6 offset:1024
    ds_read_b64_tr_b16 v[44:45], v7 offset:0
    ds_read_b64_tr_b16 v[46:47], v7 offset:1024
    ds_read_b64_tr_b16 v[48:49], v4 offset:4096
    ds_read_b64_tr_b16 v[50:51], v4 offset:5120
    ds_read_b64_tr_b16 v[52:53], v5 offset:4096
    ds_read_b64_tr_b16 v[54:55], v5 offset:5120
    ds_read_b64_tr_b16 v[56:57], v6 offset:4096
    ds_read_b64_tr_b16 v[58:59], v6 offset:5120
    s_waitcnt lgkmcnt(12)
    v_mfma_f32_32x32x16_bf16 v[64:79], v[32:35], v[128:131], 0
    ds_read_b64_tr_b16 v[60:61], v7 offset:4096
    ds_read_b64_tr_b16 v[62:63], v7 offset:5120
    s_waitcnt lgkmcnt(12)
    v_mfma_f32_32x32x16_bf16 v[80:95], v[36:39], v[128:131], 0
    s_add_u32 m0, s42, 98304
    s_add_u32 s46, s40, 2097152
    buffer_load_dwordx4 v3, s[16:19], s46 offen lds
    ds_read_b64_tr_b16 v[32:33], v4 offset:8192
    ds_read_b64_tr_b16 v[34:35], v4 offset:9216
    s_waitcnt lgkmcnt(12)
    v_mfma_f32_32x32x16_bf16 v[96:111], v[40:43], v[128:131], 0
    ds_read_b64_tr_b16 v[36:37], v5 offset:8192
    ds_read_b64_tr_b16 v[38:39], v5 offset:9216
    s_waitcnt lgkmcnt(12)
    v_mfma_f32_32x32x16_bf16 v[112:127], v[44:47], v[128:131], 0
    s_add_u32 m0, s42, 99328
    s_add_u32 s46, s40, 2129920
    buffer_load_dwordx4 v3, s[16:19], s46 offen lds
    ds_read_b64_tr_b16 v[40:41], v6 offset:8192
    ds_read_b64_tr_b16 v[42:43], v6 offset:9216
    s_waitcnt lgkmcnt(12)
    v_mfma_f32_32x32x16_bf16 v[64:79], v[48:51], v[132:135], v[64:79]
    ds_read_b64_tr_b16 v[44:45], v7 offset:8192
    ds_read_b64_tr_b16 v[46:47], v7 offset:9216
    s_waitcnt lgkmcnt(12)
    v_mfma_f32_32x32x16_bf16 v[80:95], v[52:55], v[132:135], v[80:95]
    s_add_u32 m0, s42, 100352
    s_add_u32 s46, s40, 2162688
    buffer_load_dwordx4 v3, s[16:19], s46 offen lds
    ds_read_b64_tr_b16 v[48:49], v4 offset:12288
    ds_read_b64_tr_b16 v[50:51], v4 offset:13312
    s_waitcnt lgkmcnt(12)
    v_mfma_f32_32x32x16_bf16 v[96:111], v[56:59], v[132:135], v[96:111]
    ds_read_b64_tr_b16 v[52:53], v5 offset:12288
    ds_read_b64_tr_b16 v[54:55], v5 offset:13312
    s_waitcnt lgkmcnt(12)
    v_mfma_f32_32x32x16_bf16 v[112:127], v[60:63], v[132:135], v[112:127]
    s_add_u32 m0, s42, 101376
    s_add_u32 s46, s40, 2195456
    buffer_load_dwordx4 v3, s[16:19], s46 offen lds
    ds_read_b64_tr_b16 v[56:57], v6 offset:12288
    ds_read_b64_tr_b16 v[58:59], v6 offset:13312
    s_waitcnt lgkmcnt(12)
    v_mfma_f32_32x32x16_bf16 v[64:79], v[32:35], v[136:139], v[64:79]
    ds_read_b64_tr_b16 v[60:61], v7 offset:12288
    ds_read_b64_tr_b16 v[62:63], v7 offset:13312
    s_waitcnt lgkmcnt(12)
    v_mfma_f32_32x32x16_bf16 v[80:95], v[36:39], v[136:139], v[80:95]
    s_add_u32 s46, s36, 16384
    buffer_load_dwordx4 v[192:195], v2, s[12:15], s46 offen offset:0
    ds_read_b64_tr_b16 v[32:33], v4 offset:16384
    ds_read_b64_tr_b16 v[34:35], v4 offset:17408
    s_waitcnt lgkmcnt(12)
    v_mfma_f32_32x32x16_bf16 v[96:111], v[40:43], v[136:139], v[96:111]
    ds_read_b64_tr_b16 v[36:37], v5 offset:16384
    ds_read_b64_tr_b16 v[38:39], v5 offset:17408
    s_waitcnt lgkmcnt(12)
    v_mfma_f32_32x32x16_bf16 v[112:127], v[44:47], v[136:139], v[112:127]
    s_add_u32 s46, s36, 16384
    buffer_load_dwordx4 v[196:199], v2, s[12:15], s46 offen offset:1024
    ds_read_b64_tr_b16 v[40:41], v6 offset:16384
    ds_read_b64_tr_b16 v[42:43], v6 offset:17408
    s_waitcnt lgkmcnt(12)
    v_mfma_f32_32x32x16_bf16 v[64:79], v[48:51], v[140:143], v[64:79]
    ds_read_b64_tr_b16 v[44:45], v7 offset:16384
    ds_read_b64_tr_b16 v[46:47], v7 offset:17408
    s_waitcnt lgkmcnt(12)
    v_mfma_f32_32x32x16_bf16 v[80:95], v[52:55], v[140:143], v[80:95]
    s_add_u32 s46, s36, 16384
    buffer_load_dwordx4 v[200:203], v2, s[12:15], s46 offen offset:2048
    ds_read_b64_tr_b16 v[48:49], v4 offset:20480
    ds_read_b64_tr_b16 v[50:51], v4 offset:21504
    s_waitcnt lgkmcnt(12)
    v_mfma_f32_32x32x16_bf16 v[96:111], v[56:59], v[140:143], v[96:111]
    ds_read_b64_tr_b16 v[52:53], v5 offset:20480
    ds_read_b64_tr_b16 v[54:55], v5 offset:21504
    s_waitcnt lgkmcnt(12)
    v_mfma_f32_32x32x16_bf16 v[112:127], v[60:63], v[140:143], v[112:127]
    s_add_u32 s46, s36, 16384
    buffer_load_dwordx4 v[204:207], v2, s[12:15], s46 offen offset:3072
    ds_read_b64_tr_b16 v[56:57], v6 offset:20480
    ds_read_b64_tr_b16 v[58:59], v6 offset:21504
    s_waitcnt lgkmcnt(12)
    v_mfma_f32_32x32x16_bf16 v[64:79], v[32:35], v[144:147], v[64:79]
    ds_read_b64_tr_b16 v[60:61], v7 offset:20480
    ds_read_b64_tr_b16 v[62:63], v7 offset:21504
    s_waitcnt lgkmcnt(12)
    v_mfma_f32_32x32x16_bf16 v[80:95], v[36:39], v[144:147], v[80:95]
    s_add_u32 s46, s36, 20480
    buffer_load_dwordx4 v[208:211], v2, s[12:15], s46 offen offset:0
    ds_read_b64_tr_b16 v[32:33], v4 offset:24576
    ds_read_b64_tr_b16 v[34:35], v4 offset:25600
    s_waitcnt lgkmcnt(12)
    v_mfma_f32_32x32x16_bf16 v[96:111], v[40:43], v[144:147], v[96:111]
    ds_read_b64_tr_b16 v[36:37], v5 offset:24576
    ds_read_b64_tr_b16 v[38:39], v5 offset:25600
    s_waitcnt lgkmcnt(12)
    v_mfma_f32_32x32x16_bf16 v[112:127], v[44:47], v[144:147], v[112:127]
    s_add_u32 s46, s36, 20480
    buffer_load_dwordx4 v[212:215], v2, s[12:15], s46 offen offset:1024
    ds_read_b64_tr_b16 v[40:41], v6 offset:24576
    ds_read_b64_tr_b16 v[42:43], v6 offset:25600
    s_waitcnt lgkmcnt(12)
    v_mfma_f32_32x32x16_bf16 v[64:79], v[48:51], v[148:151], v[64:79]
    ds_read_b64_tr_b16 v[44:45], v7 offset:24576
    ds_read_b64_tr_b16 v[46:47], v7 offset:25600
    s_waitcnt lgkmcnt(12)
    v_mfma_f32_32x32x16_bf16 v[80:95], v[52:55], v[148:151], v[80:95]
    s_add_u32 s46, s36, 20480
    buffer_load_dwordx4 v[216:219], v2, s[12:15], s46 offen offset:2048
    ds_read_b64_tr_b16 v[48:49], v4 offset:28672
    ds_read_b64_tr_b16 v[50:51], v4 offset:29696
    s_waitcnt lgkmcnt(12)
    v_mfma_f32_32x32x16_bf16 v[96:111], v[56:59], v[148:151], v[96:111]
    ds_read_b64_tr_b16 v[52:53], v5 offset:28672
    ds_read_b64_tr_b16 v[54:55], v5 offset:29696
    s_waitcnt lgkmcnt(12)
    v_mfma_f32_32x32x16_bf16 v[112:127], v[60:63], v[148:151], v[112:127]
    s_add_u32 s46, s36, 20480
    buffer_load_dwordx4 v[220:223], v2, s[12:15], s46 offen offset:3072
    ds_read_b64_tr_b16 v[56:57], v6 offset:28672
    ds_read_b64_tr_b16 v[58:59], v6 offset:29696
    s_waitcnt lgkmcnt(12)
    v_mfma_f32_32x32x16_bf16 v[64:79], v[32:35], v[152:155], v[64:79]
    ds_read_b64_tr_b16 v[60:61], v7 offset:28672
    ds_read_b64_tr_b16 v[62:63], v7 offset:29696
    s_waitcnt lgkmcnt(12)
    v_mfma_f32_32x32x16_bf16 v[80:95], v[36:39], v[152:155], v[80:95]
    s_waitcnt lgkmcnt(10)
    v_mfma_f32_32x32x16_bf16 v[96:111], v[40:43], v[152:155], v[96:111]
    s_waitcnt lgkmcnt(8)
    v_mfma_f32_32x32x16_bf16 v[112:127], v[44:47], v[152:155], v[112:127]
    s_waitcnt lgkmcnt(6)
    v_mfma_f32_32x32x16_bf16 v[64:79], v[48:51], v[156:159], v[64:79]
    s_waitcnt lgkmcnt(4)
    v_mfma_f32_32x32x16_bf16 v[80:95], v[52:55], v[156:159], v[80:95]
    s_waitcnt lgkmcnt(2)
    v_mfma_f32_32x32x16_bf16 v[96:111], v[56:59], v[156:159], v[96:111]
    s_waitcnt lgkmcnt(0)
    v_mfma_f32_32x32x16_bf16 v[112:127], v[60:63], v[156:159], v[112:127]
    s_waitcnt vmcnt(12)
    s_barrier
    ds_read_b64_tr_b16 v[32:33], v4 offset:32768
    ds_read_b64_tr_b16 v[34:35], v4 offset:33792
    ds_read_b64_tr_b16 v[36:37], v5 offset:32768
    ds_read_b64_tr_b16 v[38:39], v5 offset:33792
    ds_read_b64_tr_b16 v[40:41], v6 offset:32768
    ds_read_b64_tr_b16 v[42:43], v6 offset:33792
    ds_read_b64_tr_b16 v[44:45], v7 offset:32768
    ds_read_b64_tr_b16 v[46:47], v7 offset:33792
    ds_read_b64_tr_b16 v[48:49], v4 offset:36864
    ds_read_b64_tr_b16 v[50:51], v4 offset:37888
    ds_read_b64_tr_b16 v[52:53], v5 offset:36864
    ds_read_b64_tr_b16 v[54:55], v5 offset:37888
    ds_read_b64_tr_b16 v[56:57], v6 offset:36864
    ds_read_b64_tr_b16 v[58:59], v6 offset:37888
    s_waitcnt lgkmcnt(12)
    v_mfma_f32_32x32x16_bf16 v[64:79], v[32:35], v[160:163], v[64:79]
    ds_read_b64_tr_b16 v[60:61], v7 offset:36864
    ds_read_b64_tr_b16 v[62:63], v7 offset:37888
    s_waitcnt lgkmcnt(12)
    v_mfma_f32_32x32x16_bf16 v[80:95], v[36:39], v[160:163], v[80:95]
    s_add_u32 m0, s42, 131072
    s_add_u32 s46, s40, 3145728
    buffer_load_dwordx4 v3, s[16:19], s46 offen lds
    ds_read_b64_tr_b16 v[32:33], v4 offset:40960
    ds_read_b64_tr_b16 v[34:35], v4 offset:41984
    s_waitcnt lgkmcnt(12)
    v_mfma_f32_32x32x16_bf16 v[96:111], v[40:43], v[160:163], v[96:111]
    ds_read_b64_tr_b16 v[36:37], v5 offset:40960
    ds_read_b64_tr_b16 v[38:39], v5 offset:41984
    s_waitcnt lgkmcnt(12)
    v_mfma_f32_32x32x16_bf16 v[112:127], v[44:47], v[160:163], v[112:127]
    s_add_u32 m0, s42, 132096
    s_add_u32 s46, s40, 3178496
    buffer_load_dwordx4 v3, s[16:19], s46 offen lds
    ds_read_b64_tr_b16 v[40:41], v6 offset:40960
    ds_read_b64_tr_b16 v[42:43], v6 offset:41984
    s_waitcnt lgkmcnt(12)
    v_mfma_f32_32x32x16_bf16 v[64:79], v[48:51], v[164:167], v[64:79]
    ds_read_b64_tr_b16 v[44:45], v7 offset:40960
    ds_read_b64_tr_b16 v[46:47], v7 offset:41984
    s_waitcnt lgkmcnt(12)
    v_mfma_f32_32x32x16_bf16 v[80:95], v[52:55], v[164:167], v[80:95]
    s_add_u32 m0, s42, 133120
    s_add_u32 s46, s40, 3211264
    buffer_load_dwordx4 v3, s[16:19], s46 offen lds
    ds_read_b64_tr_b16 v[48:49], v4 offset:45056
    ds_read_b64_tr_b16 v[50:51], v4 offset:46080
    s_waitcnt lgkmcnt(12)
    v_mfma_f32_32x32x16_bf16 v[96:111], v[56:59], v[164:167], v[96:111]
    ds_read_b64_tr_b16 v[52:53], v5 offset:45056
    ds_read_b64_tr_b16 v[54:55], v5 offset:46080
    s_waitcnt lgkmcnt(12)
    v_mfma_f32_32x32x16_bf16 v[112:127], v[60:63], v[164:167], v[112:127]
    s_add_u32 m0, s42, 134144
    s_add_u32 s46, s40, 3244032
    buffer_load_dwordx4 v3, s[16:19], s46 offen lds
    ds_read_b64_tr_b16 v[56:57], v6 offset:45056
    ds_read_b64_tr_b16 v[58:59], v6 offset:46080
    s_waitcnt lgkmcnt(12)
    v_mfma_f32_32x32x16_bf16 v[64:79], v[32:35], v[168:171], v[64:79]
    ds_read_b64_tr_b16 v[60:61], v7 offset:45056
    ds_read_b64_tr_b16 v[62:63], v7 offset:46080
    s_waitcnt lgkmcnt(12)
    v_mfma_f32_32x32x16_bf16 v[80:95], v[36:39], v[168:171], v[80:95]
    s_add_u32 s46, s36, 24576
    buffer_load_dwordx4 v[224:227], v2, s[12:15], s46 offen offset:0
    ds_read_b64_tr_b16 v[32:33], v4 offset:49152
    ds_read_b64_tr_b16 v[34:35], v4 offset:50176
    s_waitcnt lgkmcnt(12)
    v_mfma_f32_32x32x16_bf16 v[96:111], v[40:43], v[168:171], v[96:111]
    ds_read_b64_tr_b16 v[36:37], v5 offset:49152
    ds_read_b64_tr_b16 v[38:39], v5 offset:50176
    s_waitcnt lgkmcnt(12)
    v_mfma_f32_32x32x16_bf16 v[112:127], v[44:47], v[168:171], v[112:127]
    s_add_u32 s46, s36, 24576
    buffer_load_dwordx4 v[228:231], v2, s[12:15], s46 offen offset:1024
    ds_read_b64_tr_b16 v[40:41], v6 offset:49152
    ds_read_b64_tr_b16 v[42:43], v6 offset:50176
    s_waitcnt lgkmcnt(12)
    v_mfma_f32_32x32x16_bf16 v[64:79], v[48:51], v[172:175], v[64:79]
    ds_read_b64_tr_b16 v[44:45], v7 offset:49152
    ds_read_b64_tr_b16 v[46:47], v7 offset:50176
    s_waitcnt lgkmcnt(12)
    v_mfma_f32_32x32x16_bf16 v[80:95], v[52:55], v[172:175], v[80:95]
    s_add_u32 s46, s36, 24576
    buffer_load_dwordx4 v[232:235], v2, s[12:15], s46 offen offset:2048
    ds_read_b64_tr_b16 v[48:49], v4 offset:53248
    ds_read_b64_tr_b16 v[50:51], v4 offset:54272
    s_waitcnt lgkmcnt(12)
    v_mfma_f32_32x32x16_bf16 v[96:111], v[56:59], v[172:175], v[96:111]
    ds_read_b64_tr_b16 v[52:53], v5 offset:53248
    ds_read_b64_tr_b16 v[54:55], v5 offset:54272
    s_waitcnt lgkmcnt(12)
    v_mfma_f32_32x32x16_bf16 v[112:127], v[60:63], v[172:175], v[112:127]
    s_add_u32 s46, s36, 24576
    buffer_load_dwordx4 v[236:239], v2, s[12:15], s46 offen offset:3072
    ds_read_b64_tr_b16 v[56:57], v6 offset:53248
    ds_read_b64_tr_b16 v[58:59], v6 offset:54272
    s_waitcnt lgkmcnt(12)
    v_mfma_f32_32x32x16_bf16 v[64:79], v[32:35], v[176:179], v[64:79]
    ds_read_b64_tr_b16 v[60:61], v7 offset:53248
    ds_read_b64_tr_b16 v[62:63], v7 offset:54272
    s_waitcnt lgkmcnt(12)
    v_mfma_f32_32x32x16_bf16 v[80:95], v[36:39], v[176:179], v[80:95]
    s_add_u32 s46, s36, 28672
    buffer_load_dwordx4 v[240:243], v2, s[12:15], s46 offen offset:0
    ds_read_b64_tr_b16 v[32:33], v4 offset:57344
    ds_read_b64_tr_b16 v[34:35], v4 offset:58368
    s_waitcnt lgkmcnt(12)
    v_mfma_f32_32x32x16_bf16 v[96:111], v[40:43], v[176:179], v[96:111]
    ds_read_b64_tr_b16 v[36:37], v5 offset:57344
    ds_read_b64_tr_b16 v[38:39], v5 offset:58368
    s_waitcnt lgkmcnt(12)
    v_mfma_f32_32x32x16_bf16 v[112:127], v[44:47], v[176:179], v[112:127]
    s_add_u32 s46, s36, 28672
    buffer_load_dwordx4 v[244:247], v2, s[12:15], s46 offen offset:1024
    ds_read_b64_tr_b16 v[40:41], v6 offset:57344
    ds_read_b64_tr_b16 v[42:43], v6 offset:58368
    s_waitcnt lgkmcnt(12)
    v_mfma_f32_32x32x16_bf16 v[64:79], v[48:51], v[180:183], v[64:79]
    ds_read_b64_tr_b16 v[44:45], v7 offset:57344
    ds_read_b64_tr_b16 v[46:47], v7 offset:58368
    s_waitcnt lgkmcnt(12)
    v_mfma_f32_32x32x16_bf16 v[80:95], v[52:55], v[180:183], v[80:95]
    s_add_u32 s46, s36, 28672
    buffer_load_dwordx4 v[248:251], v2, s[12:15], s46 offen offset:2048
    ds_read_b64_tr_b16 v[48:49], v4 offset:61440
    ds_read_b64_tr_b16 v[50:51], v4 offset:62464
    s_waitcnt lgkmcnt(12)
    v_mfma_f32_32x32x16_bf16 v[96:111], v[56:59], v[180:183], v[96:111]
    ds_read_b64_tr_b16 v[52:53], v5 offset:61440
    ds_read_b64_tr_b16 v[54:55], v5 offset:62464
    s_waitcnt lgkmcnt(12)
    v_mfma_f32_32x32x16_bf16 v[112:127], v[60:63], v[180:183], v[112:127]
    s_add_u32 s46, s36, 28672
    buffer_load_dwordx4 v[252:255], v2, s[12:15], s46 offen offset:3072
    ds_read_b64_tr_b16 v[56:57], v6 offset:61440
    ds_read_b64_tr_b16 v[58:59], v6 offset:62464
    s_waitcnt lgkmcnt(12)
    v_mfma_f32_32x32x16_bf16 v[64:79], v[32:35], v[184:187], v[64:79]
    ds_read_b64_tr_b16 v[60:61], v7 offset:61440
    ds_read_b64_tr_b16 v[62:63], v7 offset:62464
    s_waitcnt lgkmcnt(12)
    v_mfma_f32_32x32x16_bf16 v[80:95], v[36:39], v[184:187], v[80:95]
    s_waitcnt lgkmcnt(10)
    v_mfma_f32_32x32x16_bf16 v[96:111], v[40:43], v[184:187], v[96:111]
    s_waitcnt lgkmcnt(8)
    v_mfma_f32_32x32x16_bf16 v[112:127], v[44:47], v[184:187], v[112:127]
    s_waitcnt lgkmcnt(6)
    v_mfma_f32_32x32x16_bf16 v[64:79], v[48:51], v[188:191], v[64:79]
    s_waitcnt lgkmcnt(4)
    v_mfma_f32_32x32x16_bf16 v[80:95], v[52:55], v[188:191], v[80:95]
    s_waitcnt lgkmcnt(2)
    v_mfma_f32_32x32x16_bf16 v[96:111], v[56:59], v[188:191], v[96:111]
    s_waitcnt lgkmcnt(0)
    v_mfma_f32_32x32x16_bf16 v[112:127], v[60:63], v[188:191], v[112:127]
    s_waitcnt vmcnt(12)
    s_barrier
    ds_read_b64_tr_b16 v[32:33], v12 offset:32768
    ds_read_b64_tr_b16 v[34:35], v12 offset:33792
    ds_read_b64_tr_b16 v[36:37], v13 offset:32768
    ds_read_b64_tr_b16 v[38:39], v13 offset:33792
    ds_read_b64_tr_b16 v[40:41], v14 offset:32768
    ds_read_b64_tr_b16 v[42:43], v14 offset:33792
    ds_read_b64_tr_b16 v[44:45], v15 offset:32768
    ds_read_b64_tr_b16 v[46:47], v15 offset:33792
    ds_read_b64_tr_b16 v[48:49], v12 offset:36864
    ds_read_b64_tr_b16 v[50:51], v12 offset:37888
    ds_read_b64_tr_b16 v[52:53], v13 offset:36864
    ds_read_b64_tr_b16 v[54:55], v13 offset:37888
    ds_read_b64_tr_b16 v[56:57], v14 offset:36864
    ds_read_b64_tr_b16 v[58:59], v14 offset:37888
    s_waitcnt lgkmcnt(12)
    v_mfma_f32_32x32x16_bf16 v[64:79], v[32:35], v[192:195], v[64:79]
    ds_read_b64_tr_b16 v[60:61], v15 offset:36864
    ds_read_b64_tr_b16 v[62:63], v15 offset:37888
    s_waitcnt lgkmcnt(12)
    v_mfma_f32_32x32x16_bf16 v[80:95], v[36:39], v[192:195], v[80:95]
    s_mov_b32 s46, 0
    s_add_u32 s47, s46, 17
    s_sub_u32 s47, s47, s49
    s_cmp_lt_u32 s46, s49
    s_cselect_b32 s47, s46, s47
    s_cmp_eq_u32 s32, 0
    s_cselect_b32 s47, s46, s47
    s_cmp_lt_u32 s46, 17
    s_cselect_b32 s47, s47, 0
    s_lshl_b32 s47, s47, 15
    s_add_u32 s57, s47, s44
    s_add_u32 s48, s45, 0
    s_mov_b32 m0, s48
    s_nop 0
    buffer_load_dwordx4 v2, s[20:23], s57 offen offset:0 lds
    ds_read_b64_tr_b16 v[32:33], v12 offset:40960
    ds_read_b64_tr_b16 v[34:35], v12 offset:41984
    s_waitcnt lgkmcnt(12)
    v_mfma_f32_32x32x16_bf16 v[96:111], v[40:43], v[192:195], v[96:111]
    ds_read_b64_tr_b16 v[36:37], v13 offset:40960
    ds_read_b64_tr_b16 v[38:39], v13 offset:41984
    s_waitcnt lgkmcnt(12)
    v_mfma_f32_32x32x16_bf16 v[112:127], v[44:47], v[192:195], v[112:127]
    buffer_load_dwordx4 v2, s[20:23], s57 offen offset:1024 lds
    ds_read_b64_tr_b16 v[40:41], v14 offset:40960
    ds_read_b64_tr_b16 v[42:43], v14 offset:41984
    s_waitcnt lgkmcnt(12)
    v_mfma_f32_32x32x16_bf16 v[64:79], v[48:51], v[196:199], v[64:79]
    ds_read_b64_tr_b16 v[44:45], v15 offset:40960
    ds_read_b64_tr_b16 v[46:47], v15 offset:41984
    s_waitcnt lgkmcnt(12)
    v_mfma_f32_32x32x16_bf16 v[80:95], v[52:55], v[196:199], v[80:95]
    buffer_load_dwordx4 v2, s[20:23], s57 offen offset:2048 lds
    ds_read_b64_tr_b16 v[48:49], v12 offset:45056
    ds_read_b64_tr_b16 v[50:51], v12 offset:46080
    s_waitcnt lgkmcnt(12)
    v_mfma_f32_32x32x16_bf16 v[96:111], v[56:59], v[196:199], v[96:111]
    ds_read_b64_tr_b16 v[52:53], v13 offset:45056
    ds_read_b64_tr_b16 v[54:55], v13 offset:46080
    s_waitcnt lgkmcnt(12)
    v_mfma_f32_32x32x16_bf16 v[112:127], v[60:63], v[196:199], v[112:127]
    buffer_load_dwordx4 v2, s[20:23], s57 offen offset:3072 lds
    ds_read_b64_tr_b16 v[56:57], v14 offset:45056
    ds_read_b64_tr_b16 v[58:59], v14 offset:46080
    s_waitcnt lgkmcnt(12)
    v_mfma_f32_32x32x16_bf16 v[64:79], v[32:35], v[200:203], v[64:79]
    ds_read_b64_tr_b16 v[60:61], v15 offset:45056
    ds_read_b64_tr_b16 v[62:63], v15 offset:46080
    s_waitcnt lgkmcnt(12)
    v_mfma_f32_32x32x16_bf16 v[80:95], v[36:39], v[200:203], v[80:95]
    s_mov_b32 s46, 1
    s_add_u32 s47, s46, 17
    s_sub_u32 s47, s47, s49
    s_cmp_lt_u32 s46, s49
    s_cselect_b32 s47, s46, s47
    s_cmp_eq_u32 s32, 0
    s_cselect_b32 s47, s46, s47
    s_cmp_lt_u32 s46, 17
    s_cselect_b32 s47, s47, 0
    s_lshl_b32 s47, s47, 15
    s_add_u32 s57, s47, s44
    s_add_u32 s48, s45, 16384
    s_mov_b32 m0, s48
    s_nop 0
    buffer_load_dwordx4 v2, s[20:23], s57 offen offset:0 lds
    ds_read_b64_tr_b16 v[32:33], v12 offset:49152
    ds_read_b64_tr_b16 v[34:35], v12 offset:50176
    s_waitcnt lgkmcnt(12)
    v_mfma_f32_32x32x16_bf16 v[96:111], v[40:43], v[200:203], v[96:111]
    ds_read_b64_tr_b16 v[36:37], v13 offset:49152
    ds_read_b64_tr_b16 v[38:39], v13 offset:50176
    s_waitcnt lgkmcnt(12)
    v_mfma_f32_32x32x16_bf16 v[112:127], v[44:47], v[200:203], v[112:127]
    buffer_load_dwordx4 v2, s[20:23], s57 offen offset:1024 lds
    ds_read_b64_tr_b16 v[40:41], v14 offset:49152
    ds_read_b64_tr_b16 v[42:43], v14 offset:50176
    s_waitcnt lgkmcnt(12)
    v_mfma_f32_32x32x16_bf16 v[64:79], v[48:51], v[204:207], v[64:79]
    ds_read_b64_tr_b16 v[44:45], v15 offset:49152
    ds_read_b64_tr_b16 v[46:47], v15 offset:50176
    s_waitcnt lgkmcnt(12)
    v_mfma_f32_32x32x16_bf16 v[80:95], v[52:55], v[204:207], v[80:95]
    buffer_load_dwordx4 v2, s[20:23], s57 offen offset:2048 lds
    ds_read_b64_tr_b16 v[48:49], v12 offset:53248
    ds_read_b64_tr_b16 v[50:51], v12 offset:54272
    s_waitcnt lgkmcnt(12)
    v_mfma_f32_32x32x16_bf16 v[96:111], v[56:59], v[204:207], v[96:111]
    ds_read_b64_tr_b16 v[52:53], v13 offset:53248
    ds_read_b64_tr_b16 v[54:55], v13 offset:54272
    s_waitcnt lgkmcnt(12)
    v_mfma_f32_32x32x16_bf16 v[112:127], v[60:63], v[204:207], v[112:127]
    buffer_load_dwordx4 v2, s[20:23], s57 offen offset:3072 lds
    ds_read_b64_tr_b16 v[56:57], v14 offset:53248
    ds_read_b64_tr_b16 v[58:59], v14 offset:54272
    s_waitcnt lgkmcnt(12)
    v_mfma_f32_32x32x16_bf16 v[64:79], v[32:35], v[208:211], v[64:79]
    ds_read_b64_tr_b16 v[60:61], v15 offset:53248
    ds_read_b64_tr_b16 v[62:63], v15 offset:54272
    s_waitcnt lgkmcnt(12)
    v_mfma_f32_32x32x16_bf16 v[80:95], v[36:39], v[208:211], v[80:95]
    ds_read_b64_tr_b16 v[32:33], v12 offset:57344
    ds_read_b64_tr_b16 v[34:35], v12 offset:58368
    s_waitcnt lgkmcnt(12)
    v_mfma_f32_32x32x16_bf16 v[96:111], v[40:43], v[208:211], v[96:111]
    ds_read_b64_tr_b16 v[36:37], v13 offset:57344
    ds_read_b64_tr_b16 v[38:39], v13 offset:58368
    s_waitcnt lgkmcnt(12)
    v_mfma_f32_32x32x16_bf16 v[112:127], v[44:47], v[208:211], v[112:127]
    ds_read_b64_tr_b16 v[40:41], v14 offset:57344
    ds_read_b64_tr_b16 v[42:43], v14 offset:58368
    s_waitcnt lgkmcnt(12)
    v_mfma_f32_32x32x16_bf16 v[64:79], v[48:51], v[212:215], v[64:79]
    ds_read_b64_tr_b16 v[44:45], v15 offset:57344
    ds_read_b64_tr_b16 v[46:47], v15 offset:58368
    s_waitcnt lgkmcnt(12)
    v_mfma_f32_32x32x16_bf16 v[80:95], v[52:55], v[212:215], v[80:95]
    ds_read_b64_tr_b16 v[48:49], v12 offset:61440
    ds_read_b64_tr_b16 v[50:51], v12 offset:62464
    s_waitcnt lgkmcnt(12)
    v_mfma_f32_32x32x16_bf16 v[96:111], v[56:59], v[212:215], v[96:111]
    ds_read_b64_tr_b16 v[52:53], v13 offset:61440
    ds_read_b64_tr_b16 v[54:55], v13 offset:62464
    s_waitcnt lgkmcnt(12)
    v_mfma_f32_32x32x16_bf16 v[112:127], v[60:63], v[212:215], v[112:127]
    ds_read_b64_tr_b16 v[56:57], v14 offset:61440
    ds_read_b64_tr_b16 v[58:59], v14 offset:62464
    s_waitcnt lgkmcnt(12)
    v_mfma_f32_32x32x16_bf16 v[64:79], v[32:35], v[216:219], v[64:79]
    ds_read_b64_tr_b16 v[60:61], v15 offset:61440
    ds_read_b64_tr_b16 v[62:63], v15 offset:62464
    s_waitcnt lgkmcnt(12)
    v_mfma_f32_32x32x16_bf16 v[80:95], v[36:39], v[216:219], v[80:95]
    s_waitcnt lgkmcnt(10)
    v_mfma_f32_32x32x16_bf16 v[96:111], v[40:43], v[216:219], v[96:111]
    s_waitcnt lgkmcnt(8)
    v_mfma_f32_32x32x16_bf16 v[112:127], v[44:47], v[216:219], v[112:127]
    s_waitcnt lgkmcnt(6)
    v_mfma_f32_32x32x16_bf16 v[64:79], v[48:51], v[220:223], v[64:79]
    s_waitcnt lgkmcnt(4)
    v_mfma_f32_32x32x16_bf16 v[80:95], v[52:55], v[220:223], v[80:95]
    s_waitcnt lgkmcnt(2)
    v_mfma_f32_32x32x16_bf16 v[96:111], v[56:59], v[220:223], v[96:111]
    s_waitcnt lgkmcnt(0)
    v_mfma_f32_32x32x16_bf16 v[112:127], v[60:63], v[220:223], v[112:127]
    s_waitcnt vmcnt(8)
    s_barrier
    ds_read_b64_tr_b16 v[32:33], v16 offset:0
    ds_read_b64_tr_b16 v[34:35], v16 offset:1024
    ds_read_b64_tr_b16 v[36:37], v17 offset:0
    ds_read_b64_tr_b16 v[38:39], v17 offset:1024
    ds_read_b64_tr_b16 v[40:41], v18 offset:0
    ds_read_b64_tr_b16 v[42:43], v18 offset:1024
    ds_read_b64_tr_b16 v[44:45], v19 offset:0
    ds_read_b64_tr_b16 v[46:47], v19 offset:1024
    ds_read_b64_tr_b16 v[48:49], v16 offset:4096
    ds_read_b64_tr_b16 v[50:51], v16 offset:5120
    ds_read_b64_tr_b16 v[52:53], v17 offset:4096
    ds_read_b64_tr_b16 v[54:55], v17 offset:5120
    ds_read_b64_tr_b16 v[56:57], v18 offset:4096
    ds_read_b64_tr_b16 v[58:59], v18 offset:5120
    s_waitcnt lgkmcnt(12)
    v_mfma_f32_32x32x16_bf16 v[64:79], v[32:35], v[224:227], v[64:79]
    ds_read_b64_tr_b16 v[60:61], v19 offset:4096
    ds_read_b64_tr_b16 v[62:63], v19 offset:5120
    s_waitcnt lgkmcnt(12)
    v_mfma_f32_32x32x16_bf16 v[80:95], v[36:39], v[224:227], v[80:95]
    s_mov_b32 s46, 0
    s_add_u32 s47, s46, 17
    s_sub_u32 s47, s47, s49
    s_cmp_lt_u32 s46, s49
    s_cselect_b32 s47, s46, s47
    s_cmp_eq_u32 s32, 0
    s_cselect_b32 s47, s46, s47
    s_cmp_lt_u32 s46, 17
    s_cselect_b32 s47, s47, 0
    s_lshl_b32 s47, s47, 15
    s_add_u32 s57, s47, s44
    s_add_u32 s57, s57, 8192
    s_add_u32 s48, s45, 32768
    s_mov_b32 m0, s48
    s_nop 0
    buffer_load_dwordx4 v2, s[20:23], s57 offen offset:0 lds
    ds_read_b64_tr_b16 v[32:33], v16 offset:8192
    ds_read_b64_tr_b16 v[34:35], v16 offset:9216
    s_waitcnt lgkmcnt(12)
    v_mfma_f32_32x32x16_bf16 v[96:111], v[40:43], v[224:227], v[96:111]
    ds_read_b64_tr_b16 v[36:37], v17 offset:8192
    ds_read_b64_tr_b16 v[38:39], v17 offset:9216
    s_waitcnt lgkmcnt(12)
    v_mfma_f32_32x32x16_bf16 v[112:127], v[44:47], v[224:227], v[112:127]
    buffer_load_dwordx4 v2, s[20:23], s57 offen offset:1024 lds
    ds_read_b64_tr_b16 v[40:41], v18 offset:8192
    ds_read_b64_tr_b16 v[42:43], v18 offset:9216
    s_waitcnt lgkmcnt(12)
    v_mfma_f32_32x32x16_bf16 v[64:79], v[48:51], v[228:231], v[64:79]
    ds_read_b64_tr_b16 v[44:45], v19 offset:8192
    ds_read_b64_tr_b16 v[46:47], v19 offset:9216
    s_waitcnt lgkmcnt(12)
    v_mfma_f32_32x32x16_bf16 v[80:95], v[52:55], v[228:231], v[80:95]
    buffer_load_dwordx4 v2, s[20:23], s57 offen offset:2048 lds
    ds_read_b64_tr_b16 v[48:49], v16 offset:12288
    ds_read_b64_tr_b16 v[50:51], v16 offset:13312
    s_waitcnt lgkmcnt(12)
    v_mfma_f32_32x32x16_bf16 v[96:111], v[56:59], v[228:231], v[96:111]
    ds_read_b64_tr_b16 v[52:53], v17 offset:12288
    ds_read_b64_tr_b16 v[54:55], v17 offset:13312
    s_waitcnt lgkmcnt(12)
    v_mfma_f32_32x32x16_bf16 v[112:127], v[60:63], v[228:231], v[112:127]
    buffer_load_dwordx4 v2, s[20:23], s57 offen offset:3072 lds
    ds_read_b64_tr_b16 v[56:57], v18 offset:12288
    ds_read_b64_tr_b16 v[58:59], v18 offset:13312
    s_waitcnt lgkmcnt(12)
    v_mfma_f32_32x32x16_bf16 v[64:79], v[32:35], v[232:235], v[64:79]
    ds_read_b64_tr_b16 v[60:61], v19 offset:12288
    ds_read_b64_tr_b16 v[62:63], v19 offset:13312
    s_waitcnt lgkmcnt(12)
    v_mfma_f32_32x32x16_bf16 v[80:95], v[36:39], v[232:235], v[80:95]
    ds_read_b64_tr_b16 v[32:33], v16 offset:16384
    ds_read_b64_tr_b16 v[34:35], v16 offset:17408
    s_waitcnt lgkmcnt(12)
    v_mfma_f32_32x32x16_bf16 v[96:111], v[40:43], v[232:235], v[96:111]
    ds_read_b64_tr_b16 v[36:37], v17 offset:16384
    ds_read_b64_tr_b16 v[38:39], v17 offset:17408
    s_waitcnt lgkmcnt(12)
    v_mfma_f32_32x32x16_bf16 v[112:127], v[44:47], v[232:235], v[112:127]
    ds_read_b64_tr_b16 v[40:41], v18 offset:16384
    ds_read_b64_tr_b16 v[42:43], v18 offset:17408
    s_waitcnt lgkmcnt(12)
    v_mfma_f32_32x32x16_bf16 v[64:79], v[48:51], v[236:239], v[64:79]
    ds_read_b64_tr_b16 v[44:45], v19 offset:16384
    ds_read_b64_tr_b16 v[46:47], v19 offset:17408
    s_waitcnt lgkmcnt(12)
    v_mfma_f32_32x32x16_bf16 v[80:95], v[52:55], v[236:239], v[80:95]
    ds_read_b64_tr_b16 v[48:49], v16 offset:20480
    ds_read_b64_tr_b16 v[50:51], v16 offset:21504
    s_waitcnt lgkmcnt(12)
    v_mfma_f32_32x32x16_bf16 v[96:111], v[56:59], v[236:239], v[96:111]
    ds_read_b64_tr_b16 v[52:53], v17 offset:20480
    ds_read_b64_tr_b16 v[54:55], v17 offset:21504
    s_waitcnt lgkmcnt(12)
    v_mfma_f32_32x32x16_bf16 v[112:127], v[60:63], v[236:239], v[112:127]
    ds_read_b64_tr_b16 v[56:57], v18 offset:20480
    ds_read_b64_tr_b16 v[58:59], v18 offset:21504
    s_waitcnt lgkmcnt(12)
    v_mfma_f32_32x32x16_bf16 v[64:79], v[32:35], v[240:243], v[64:79]
    ds_read_b64_tr_b16 v[60:61], v19 offset:20480
    ds_read_b64_tr_b16 v[62:63], v19 offset:21504
    s_waitcnt lgkmcnt(12)
    v_mfma_f32_32x32x16_bf16 v[80:95], v[36:39], v[240:243], v[80:95]
    ds_read_b64_tr_b16 v[32:33], v16 offset:24576
    ds_read_b64_tr_b16 v[34:35], v16 offset:25600
    s_waitcnt lgkmcnt(12)
    v_mfma_f32_32x32x16_bf16 v[96:111], v[40:43], v[240:243], v[96:111]
    ds_read_b64_tr_b16 v[36:37], v17 offset:24576
    ds_read_b64_tr_b16 v[38:39], v17 offset:25600
    s_waitcnt lgkmcnt(12)
    v_mfma_f32_32x32x16_bf16 v[112:127], v[44:47], v[240:243], v[112:127]
    ds_read_b64_tr_b16 v[40:41], v18 offset:24576
    ds_read_b64_tr_b16 v[42:43], v18 offset:25600
    s_waitcnt lgkmcnt(12)
    v_mfma_f32_32x32x16_bf16 v[64:79], v[48:51], v[244:247], v[64:79]
    ds_read_b64_tr_b16 v[44:45], v19 offset:24576
    ds_read_b64_tr_b16 v[46:47], v19 offset:25600
    s_waitcnt lgkmcnt(12)
    v_mfma_f32_32x32x16_bf16 v[80:95], v[52:55], v[244:247], v[80:95]
    ds_read_b64_tr_b16 v[48:49], v16 offset:28672
    ds_read_b64_tr_b16 v[50:51], v16 offset:29696
    s_waitcnt lgkmcnt(12)
    v_mfma_f32_32x32x16_bf16 v[96:111], v[56:59], v[244:247], v[96:111]
    ds_read_b64_tr_b16 v[52:53], v17 offset:28672
    ds_read_b64_tr_b16 v[54:55], v17 offset:29696
    s_waitcnt lgkmcnt(12)
    v_mfma_f32_32x32x16_bf16 v[112:127], v[60:63], v[244:247], v[112:127]
    ds_read_b64_tr_b16 v[56:57], v18 offset:28672
    ds_read_b64_tr_b16 v[58:59], v18 offset:29696
    s_waitcnt lgkmcnt(12)
    v_mfma_f32_32x32x16_bf16 v[64:79], v[32:35], v[248:251], v[64:79]
    ds_read_b64_tr_b16 v[60:61], v19 offset:28672
    ds_read_b64_tr_b16 v[62:63], v19 offset:29696
    s_waitcnt lgkmcnt(12)
    v_mfma_f32_32x32x16_bf16 v[80:95], v[36:39], v[248:251], v[80:95]
    s_waitcnt lgkmcnt(10)
    v_mfma_f32_32x32x16_bf16 v[96:111], v[40:43], v[248:251], v[96:111]
    s_waitcnt lgkmcnt(8)
    v_mfma_f32_32x32x16_bf16 v[112:127], v[44:47], v[248:251], v[112:127]
    s_waitcnt lgkmcnt(6)
    v_mfma_f32_32x32x16_bf16 v[64:79], v[48:51], v[252:255], v[64:79]
    s_waitcnt lgkmcnt(4)
    v_mfma_f32_32x32x16_bf16 v[80:95], v[52:55], v[252:255], v[80:95]
    s_waitcnt lgkmcnt(2)
    v_mfma_f32_32x32x16_bf16 v[96:111], v[56:59], v[252:255], v[96:111]
    s_waitcnt lgkmcnt(0)
    v_mfma_f32_32x32x16_bf16 v[112:127], v[60:63], v[252:255], v[112:127]
    s_nop 15
    s_mov_b32 s46, 1040356334
    v_mul_f32 v64, s46, v64
    v_mul_f32 v65, s46, v65
    v_mul_f32 v66, s46, v66
    v_mul_f32 v67, s46, v67
    v_mul_f32 v68, s46, v68
    v_mul_f32 v69, s46, v69
    v_mul_f32 v70, s46, v70
    v_mul_f32 v71, s46, v71
    v_mul_f32 v72, s46, v72
    v_mul_f32 v73, s46, v73
    v_mul_f32 v74, s46, v74
    v_mul_f32 v75, s46, v75
    v_mul_f32 v76, s46, v76
    v_mul_f32 v77, s46, v77
    v_mul_f32 v78, s46, v78
    v_mul_f32 v79, s46, v79
    v_mul_f32 v80, s46, v80
    v_mul_f32 v81, s46, v81
    v_mul_f32 v82, s46, v82
    v_mul_f32 v83, s46, v83
    v_mul_f32 v84, s46, v84
    v_mul_f32 v85, s46, v85
    v_mul_f32 v86, s46, v86
    v_mul_f32 v87, s46, v87
    v_mul_f32 v88, s46, v88
    v_mul_f32 v89, s46, v89
    v_mul_f32 v90, s46, v90
    v_mul_f32 v91, s46, v91
    v_mul_f32 v92, s46, v92
    v_mul_f32 v93, s46, v93
    v_mul_f32 v94, s46, v94
    v_mul_f32 v95, s46, v95
    v_mul_f32 v96, s46, v96
    v_mul_f32 v97, s46, v97
    v_mul_f32 v98, s46, v98
    v_mul_f32 v99, s46, v99
    v_mul_f32 v100, s46, v100
    v_mul_f32 v101, s46, v101
    v_mul_f32 v102, s46, v102
    v_mul_f32 v103, s46, v103
    v_mul_f32 v104, s46, v104
    v_mul_f32 v105, s46, v105
    v_mul_f32 v106, s46, v106
    v_mul_f32 v107, s46, v107
    v_mul_f32 v108, s46, v108
    v_mul_f32 v109, s46, v109
    v_mul_f32 v110, s46, v110
    v_mul_f32 v111, s46, v111
    v_mul_f32 v112, s46, v112
    v_mul_f32 v113, s46, v113
    v_mul_f32 v114, s46, v114
    v_mul_f32 v115, s46, v115
    v_mul_f32 v116, s46, v116
    v_mul_f32 v117, s46, v117
    v_mul_f32 v118, s46, v118
    v_mul_f32 v119, s46, v119
    v_mul_f32 v120, s46, v120
    v_mul_f32 v121, s46, v121
    v_mul_f32 v122, s46, v122
    v_mul_f32 v123, s46, v123
    v_mul_f32 v124, s46, v124
    v_mul_f32 v125, s46, v125
    v_mul_f32 v126, s46, v126
    v_mul_f32 v127, s46, v127
    s_lshl_b32 s37, s31, 13
    s_lshr_b32 s38, s31, 1
    s_mul_i32 s38, s38, 49152
    s_add_u32 s38, s38, s37
    s_add_u32 s38, s38, 49152
    v_add_u32 v8, s38, v2
    s_cmp_eq_u32 s32, 0
    s_cbranch_scc0 attn_kernel_qb
    v_cvt_pk_bf16_f32 v224, v64, v65
    v_cvt_pk_bf16_f32 v225, v66, v67
    v_cvt_pk_bf16_f32 v226, v68, v69
    v_cvt_pk_bf16_f32 v227, v70, v71
    v_cvt_pk_bf16_f32 v228, v72, v73
    v_cvt_pk_bf16_f32 v229, v74, v75
    v_cvt_pk_bf16_f32 v230, v76, v77
    v_cvt_pk_bf16_f32 v231, v78, v79
    v_cvt_pk_bf16_f32 v232, v80, v81
    v_cvt_pk_bf16_f32 v233, v82, v83
    v_cvt_pk_bf16_f32 v234, v84, v85
    v_cvt_pk_bf16_f32 v235, v86, v87
    v_cvt_pk_bf16_f32 v236, v88, v89
    v_cvt_pk_bf16_f32 v237, v90, v91
    v_cvt_pk_bf16_f32 v238, v92, v93
    v_cvt_pk_bf16_f32 v239, v94, v95
    v_cvt_pk_bf16_f32 v240, v96, v97
    v_cvt_pk_bf16_f32 v241, v98, v99
    v_cvt_pk_bf16_f32 v242, v100, v101
    v_cvt_pk_bf16_f32 v243, v102, v103
    v_cvt_pk_bf16_f32 v244, v104, v105
    v_cvt_pk_bf16_f32 v245, v106, v107
    v_cvt_pk_bf16_f32 v246, v108, v109
    v_cvt_pk_bf16_f32 v247, v110, v111
    v_cvt_pk_bf16_f32 v248, v112, v113
    v_cvt_pk_bf16_f32 v249, v114, v115
    v_cvt_pk_bf16_f32 v250, v116, v117
    v_cvt_pk_bf16_f32 v251, v118, v119
    v_cvt_pk_bf16_f32 v252, v120, v121
    v_cvt_pk_bf16_f32 v253, v122, v123
    v_cvt_pk_bf16_f32 v254, v124, v125
    v_cvt_pk_bf16_f32 v255, v126, v127
    ds_write_b128 v8, v[224:227] offset:0
    ds_write_b128 v8, v[228:231] offset:1024
    ds_write_b128 v8, v[232:235] offset:2048
    ds_write_b128 v8, v[236:239] offset:3072
    ds_write_b128 v8, v[240:243] offset:4096
    ds_write_b128 v8, v[244:247] offset:5120
    ds_write_b128 v8, v[248:251] offset:6144
    ds_write_b128 v8, v[252:255] offset:7168
    s_branch attn_kernel_qb2
attn_kernel_qb:
    v_cvt_pk_bf16_f32 v224, v64, v65
    v_cvt_pk_bf16_f32 v225, v66, v67
    v_cvt_pk_bf16_f32 v226, v68, v69
    v_cvt_pk_bf16_f32 v227, v70, v71
    v_cvt_pk_bf16_f32 v228, v72, v73
    v_cvt_pk_bf16_f32 v229, v74, v75
    v_cvt_pk_bf16_f32 v230, v76, v77
    v_cvt_pk_bf16_f32 v231, v78, v79
    v_cvt_pk_bf16_f32 v232, v80, v81
    v_cvt_pk_bf16_f32 v233, v82, v83
    v_cvt_pk_bf16_f32 v234, v84, v85
    v_cvt_pk_bf16_f32 v235, v86, v87
    v_cvt_pk_bf16_f32 v236, v88, v89
    v_cvt_pk_bf16_f32 v237, v90, v91
    v_cvt_pk_bf16_f32 v238, v92, v93
    v_cvt_pk_bf16_f32 v239, v94, v95
    v_cvt_pk_bf16_f32 v240, v96, v97
    v_cvt_pk_bf16_f32 v241, v98, v99
    v_cvt_pk_bf16_f32 v242, v100, v101
    v_cvt_pk_bf16_f32 v243, v102, v103
    v_cvt_pk_bf16_f32 v244, v104, v105
    v_cvt_pk_bf16_f32 v245, v106, v107
    v_cvt_pk_bf16_f32 v246, v108, v109
    v_cvt_pk_bf16_f32 v247, v110, v111
    v_cvt_pk_bf16_f32 v248, v112, v113
    v_cvt_pk_bf16_f32 v249, v114, v115
    v_cvt_pk_bf16_f32 v250, v116, v117
    v_cvt_pk_bf16_f32 v251, v118, v119
    v_cvt_pk_bf16_f32 v252, v120, v121
    v_cvt_pk_bf16_f32 v253, v122, v123
    v_cvt_pk_bf16_f32 v254, v124, v125
    v_cvt_pk_bf16_f32 v255, v126, v127
attn_kernel_qb2:
    v_and_b32 v9, 31, v1
    v_lshrrev_b32 v10, 5, v1
    v_lshlrev_b32 v10, 2, v10
    v_sub_u32 v9, v9, v10
    v_cmp_gt_i32 s[64:65], 0, v9
    v_cmp_gt_i32 s[66:67], 1, v9
    v_cmp_gt_i32 s[68:69], 2, v9
    v_cmp_gt_i32 s[70:71], 3, v9
    v_cmp_gt_i32 s[72:73], 8, v9
    v_cmp_gt_i32 s[74:75], 9, v9
    v_cmp_gt_i32 s[76:77], 10, v9
    v_cmp_gt_i32 s[78:79], 11, v9
    v_cmp_gt_i32 s[80:81], 16, v9
    v_cmp_gt_i32 s[82:83], 17, v9
    v_cmp_gt_i32 s[84:85], 18, v9
    v_cmp_gt_i32 s[86:87], 19, v9
    v_cmp_gt_i32 s[88:89], 24, v9
    v_cmp_gt_i32 s[90:91], 25, v9
    v_cmp_gt_i32 s[92:93], 26, v9
    v_cmp_gt_i32 s[94:95], 27, v9
    s_lshl_b32 s39, s2, 16
    s_lshl_b32 s46, s31, 14
    s_add_u32 s39, s39, s46
    v_lshlrev_b32 v18, 3, v1
    s_lshl_b32 s46, s2, 11
    s_lshl_b32 s47, s31, 9
    s_add_u32 s46, s46, s47
    s_add_u32 s46, s46, 17825792
    v_add_u32 v18, s46, v18
    v_mov_b32 v96, 0
    v_mov_b32 v97, 0
    v_mov_b32 v98, 0
    v_mov_b32 v99, 0
    v_mov_b32 v100, 0
    v_mov_b32 v101, 0
    v_mov_b32 v102, 0
    v_mov_b32 v103, 0
    v_mov_b32 v104, 0
    v_mov_b32 v105, 0
    v_mov_b32 v106, 0
    v_mov_b32 v107, 0
    v_mov_b32 v108, 0
    v_mov_b32 v109, 0
    v_mov_b32 v110, 0
    v_mov_b32 v111, 0
    v_mov_b32 v26, 0
    v_mov_b32 v27, 0
    s_mov_b32 s54, 3212836864
    s_mov_b32 s55, 4048155338
    v_add_u32 v24, s43, v2
    v_add_u32 v25, 32768, v24
    s_mov_b32 s53, 0
    s_mov_b32 s63, 0
    s_mov_b32 s62, 1
    s_mov_b32 s60, 0
    s_cmp_eq_u32 s32, 0
    s_cselect_b32 s51, s35, s34
    s_cselect_b32 s61, 99, s49
    s_waitcnt lgkmcnt(0)
    s_barrier
    s_cmp_eq_u32 s32, 0
    s_cbranch_scc1 attn_kernel_qr
    ds_read_b128 v[32:35], v8 offset:0
    ds_read_b128 v[36:39], v8 offset:1024
    ds_read_b128 v[40:43], v8 offset:2048
    ds_read_b128 v[44:47], v8 offset:3072
    ds_read_b128 v[48:51], v8 offset:4096
    ds_read_b128 v[52:55], v8 offset:5120
    ds_read_b128 v[56:59], v8 offset:6144
    ds_read_b128 v[60:63], v8 offset:7168
attn_kernel_qr:
    s_waitcnt vmcnt(0) lgkmcnt(0)
    s_barrier
    s_cmp_eq_u32 s32, 0
    s_cbranch_scc1 attn_kernel_qk0
    s_barrier
attn_kernel_qk0:
    ds_read_b128 v[64:67], v24 offset:0
    ds_read_b128 v[68:71], v24 offset:1024
    ds_read_b128 v[72:75], v24 offset:2048
    ds_read_b128 v[76:79], v24 offset:3072
    ds_read_b128 v[80:83], v24 offset:4096
    ds_read_b128 v[84:87], v24 offset:5120
    ds_read_b128 v[88:91], v24 offset:6144
    s_waitcnt lgkmcnt(6)
    v_mfma_f32_32x32x16_bf16 v[128:143], v[64:67], v[224:227], v[96:111]
    ds_read_b128 v[92:95], v24 offset:7168
    s_waitcnt lgkmcnt(6)
    v_mfma_f32_32x32x16_bf16 v[128:143], v[68:71], v[228:231], v[128:143]
    s_add_u32 s46, s53, 1
    s_add_u32 s47, s46, 17
    s_sub_u32 s47, s47, s49
    ds_read_b128 v[64:67], v24 offset:8192
    s_waitcnt lgkmcnt(6)
    v_mfma_f32_32x32x16_bf16 v[128:143], v[72:75], v[232:235], v[128:143]
    s_cmp_lt_u32 s46, s49
    s_cselect_b32 s47, s46, s47
    s_cmp_eq_u32 s32, 0
    ds_read_b128 v[68:71], v24 offset:9216
    s_waitcnt lgkmcnt(6)
    v_mfma_f32_32x32x16_bf16 v[128:143], v[76:79], v[236:239], v[128:143]
    s_cselect_b32 s47, s46, s47
    s_cmp_lt_u32 s46, 17
    s_cselect_b32 s47, s47, 0
    ds_read_b128 v[72:75], v24 offset:10240
    s_waitcnt lgkmcnt(6)
    v_mfma_f32_32x32x16_bf16 v[128:143], v[80:83], v[240:243], v[128:143]
    s_lshl_b32 s47, s47, 15
    s_add_u32 s57, s47, s44
    s_add_u32 s56, s57, 8192
    ds_read_b128 v[76:79], v24 offset:11264
    s_waitcnt lgkmcnt(6)
    v_mfma_f32_32x32x16_bf16 v[128:143], v[84:87], v[244:247], v[128:143]
    s_and_b32 s46, s53, 1
    s_xor_b32 s46, s46, 1
    s_lshl_b32 s46, s46, 14
    ds_read_b128 v[80:83], v24 offset:12288
    s_waitcnt lgkmcnt(6)
    v_mfma_f32_32x32x16_bf16 v[128:143], v[88:91], v[248:251], v[128:143]
    s_add_u32 s58, s46, s45
    s_add_u32 s48, s58, 32768
    s_mov_b32 m0, s58
    ds_read_b128 v[84:87], v24 offset:13312
    s_waitcnt lgkmcnt(6)
    v_mfma_f32_32x32x16_bf16 v[128:143], v[92:95], v[252:255], v[128:143]
    ds_read_b128 v[88:91], v24 offset:14336
    s_waitcnt lgkmcnt(6)
    v_mfma_f32_32x32x16_bf16 v[144:159], v[64:67], v[224:227], v[96:111]
    ds_read_b128 v[92:95], v24 offset:15360
    s_waitcnt lgkmcnt(6)
    v_mfma_f32_32x32x16_bf16 v[144:159], v[68:71], v[228:231], v[144:159]
    s_waitcnt lgkmcnt(5)
    v_mfma_f32_32x32x16_bf16 v[144:159], v[72:75], v[232:235], v[144:159]
    s_waitcnt lgkmcnt(4)
    v_mfma_f32_32x32x16_bf16 v[144:159], v[76:79], v[236:239], v[144:159]
    s_waitcnt lgkmcnt(3)
    v_mfma_f32_32x32x16_bf16 v[144:159], v[80:83], v[240:243], v[144:159]
    s_waitcnt lgkmcnt(2)
    v_mfma_f32_32x32x16_bf16 v[144:159], v[84:87], v[244:247], v[144:159]
    s_waitcnt lgkmcnt(1)
    v_mfma_f32_32x32x16_bf16 v[144:159], v[88:91], v[248:251], v[144:159]
    s_waitcnt lgkmcnt(0)
    v_mfma_f32_32x32x16_bf16 v[144:159], v[92:95], v[252:255], v[144:159]
    s_branch attn_kernel_mend0
attn_kernel_pv:
    s_setprio 1
    s_cmp_ge_u32 s53, 17
    s_cbranch_scc1 attn_kernel_mlast
    s_cmp_eq_u32 s62, 1
    s_cbranch_scc1 attn_kernel_pvf
    ds_read_b128 v[88:91], v25 offset:5120
    s_waitcnt lgkmcnt(6)
    v_mfma_f32_32x32x16_bf16 v[160:175], v[64:67], v[112:115], v[160:175]
    s_add_u32 s46, s53, 1
    s_add_u32 s47, s46, 17
    s_sub_u32 s47, s47, s49
    ds_read_b128 v[92:95], v25 offset:7168
    s_waitcnt lgkmcnt(6)
    v_mfma_f32_32x32x16_bf16 v[176:191], v[68:71], v[112:115], v[176:191]
    s_cmp_lt_u32 s46, s49
    s_cselect_b32 s47, s46, s47
    s_cmp_eq_u32 s32, 0
    ds_read_b128 v[64:67], v25 offset:8192
    s_waitcnt lgkmcnt(6)
    v_mfma_f32_32x32x16_bf16 v[192:207], v[72:75], v[112:115], v[192:207]
    s_cselect_b32 s47, s46, s47
    s_cmp_lt_u32 s46, 17
    s_cselect_b32 s47, s47, 0
    ds_read_b128 v[68:71], v25 offset:10240
    s_waitcnt lgkmcnt(6)
    v_mfma_f32_32x32x16_bf16 v[208:223], v[76:79], v[112:115], v[208:223]
    s_lshl_b32 s47, s47, 15
    s_add_u32 s57, s47, s44
    s_add_u32 s56, s57, 8192
    ds_read_b128 v[72:75], v25 offset:12288
    s_waitcnt lgkmcnt(6)
    v_mfma_f32_32x32x16_bf16 v[160:175], v[80:83], v[116:119], v[160:175]
    s_and_b32 s46, s53, 1
    s_xor_b32 s46, s46, 1
    s_lshl_b32 s46, s46, 14
    ds_read_b128 v[76:79], v25 offset:14336
    s_waitcnt lgkmcnt(6)
    v_mfma_f32_32x32x16_bf16 v[176:191], v[84:87], v[116:119], v[176:191]
    s_add_u32 s58, s46, s45
    s_add_u32 s48, s58, 32768
    s_mov_b32 m0, s58
    ds_read_b128 v[80:83], v25 offset:9216
    s_waitcnt lgkmcnt(6)
    v_mfma_f32_32x32x16_bf16 v[192:207], v[88:91], v[116:119], v[192:207]
    ds_read_b128 v[84:87], v25 offset:11264
    s_waitcnt lgkmcnt(6)
    v_mfma_f32_32x32x16_bf16 v[208:223], v[92:95], v[116:119], v[208:223]
    buffer_load_dwordx4 v2, s[20:23], s57 offen offset:0 lds
    ds_read_b128 v[88:91], v25 offset:13312
    s_waitcnt lgkmcnt(6)
    v_mfma_f32_32x32x16_bf16 v[160:175], v[64:67], v[120:123], v[160:175]
    ds_read_b128 v[92:95], v25 offset:15360
    s_waitcnt lgkmcnt(6)
    v_mfma_f32_32x32x16_bf16 v[176:191], v[68:71], v[120:123], v[176:191]
    ds_read_b128 v[64:67], v24 offset:0
    s_waitcnt lgkmcnt(6)
    v_mfma_f32_32x32x16_bf16 v[192:207], v[72:75], v[120:123], v[192:207]
    buffer_load_dwordx4 v2, s[20:23], s57 offen offset:1024 lds
    ds_read_b128 v[68:71], v24 offset:1024
    s_waitcnt lgkmcnt(6)
    v_mfma_f32_32x32x16_bf16 v[208:223], v[76:79], v[120:123], v[208:223]
    ds_read_b128 v[72:75], v24 offset:2048
    s_waitcnt lgkmcnt(6)
    v_mfma_f32_32x32x16_bf16 v[160:175], v[80:83], v[124:127], v[160:175]
    ds_read_b128 v[76:79], v24 offset:3072
    s_waitcnt lgkmcnt(6)
    v_mfma_f32_32x32x16_bf16 v[176:191], v[84:87], v[124:127], v[176:191]
    buffer_load_dwordx4 v2, s[20:23], s57 offen offset:2048 lds
    ds_read_b128 v[80:83], v24 offset:4096
    s_waitcnt lgkmcnt(6)
    v_mfma_f32_32x32x16_bf16 v[192:207], v[88:91], v[124:127], v[192:207]
    ds_read_b128 v[84:87], v24 offset:5120
    s_waitcnt lgkmcnt(6)
    v_mfma_f32_32x32x16_bf16 v[208:223], v[92:95], v[124:127], v[208:223]
    ds_read_b128 v[88:91], v24 offset:6144
    s_waitcnt lgkmcnt(6)
    v_mfma_f32_32x32x16_bf16 v[128:143], v[64:67], v[224:227], v[96:111]
    buffer_load_dwordx4 v2, s[20:23], s57 offen offset:3072 lds
    ds_read_b128 v[92:95], v24 offset:7168
    s_waitcnt lgkmcnt(6)
    v_mfma_f32_32x32x16_bf16 v[128:143], v[68:71], v[228:231], v[128:143]
    ds_read_b128 v[64:67], v24 offset:8192
    s_waitcnt lgkmcnt(6)
    v_mfma_f32_32x32x16_bf16 v[128:143], v[72:75], v[232:235], v[128:143]
    ds_read_b128 v[68:71], v24 offset:9216
    s_waitcnt lgkmcnt(6)
    v_mfma_f32_32x32x16_bf16 v[128:143], v[76:79], v[236:239], v[128:143]
    ds_read_b128 v[72:75], v24 offset:10240
    s_waitcnt lgkmcnt(6)
    v_mfma_f32_32x32x16_bf16 v[128:143], v[80:83], v[240:243], v[128:143]
    ds_read_b128 v[76:79], v24 offset:11264
    s_waitcnt lgkmcnt(6)
    v_mfma_f32_32x32x16_bf16 v[128:143], v[84:87], v[244:247], v[128:143]
    ds_read_b128 v[80:83], v24 offset:12288
    s_waitcnt lgkmcnt(6)
    v_mfma_f32_32x32x16_bf16 v[128:143], v[88:91], v[248:251], v[128:143]
    ds_read_b128 v[84:87], v24 offset:13312
    s_waitcnt lgkmcnt(6)
    v_mfma_f32_32x32x16_bf16 v[128:143], v[92:95], v[252:255], v[128:143]
    ds_read_b128 v[88:91], v24 offset:14336
    s_waitcnt lgkmcnt(6)
    v_mfma_f32_32x32x16_bf16 v[144:159], v[64:67], v[224:227], v[96:111]
    ds_read_b128 v[92:95], v24 offset:15360
    s_waitcnt lgkmcnt(6)
    v_mfma_f32_32x32x16_bf16 v[144:159], v[68:71], v[228:231], v[144:159]
    s_waitcnt lgkmcnt(5)
    v_mfma_f32_32x32x16_bf16 v[144:159], v[72:75], v[232:235], v[144:159]
    s_waitcnt lgkmcnt(4)
    v_mfma_f32_32x32x16_bf16 v[144:159], v[76:79], v[236:239], v[144:159]
    s_waitcnt lgkmcnt(3)
    v_mfma_f32_32x32x16_bf16 v[144:159], v[80:83], v[240:243], v[144:159]
    s_waitcnt lgkmcnt(2)
    v_mfma_f32_32x32x16_bf16 v[144:159], v[84:87], v[244:247], v[144:159]
    s_waitcnt lgkmcnt(1)
    v_mfma_f32_32x32x16_bf16 v[144:159], v[88:91], v[248:251], v[144:159]
    s_waitcnt lgkmcnt(0)
    v_mfma_f32_32x32x16_bf16 v[144:159], v[92:95], v[252:255], v[144:159]
    s_branch attn_kernel_mend
attn_kernel_pvf:
    ds_read_b128 v[88:91], v25 offset:5120
    s_waitcnt lgkmcnt(6)
    v_mfma_f32_32x32x16_bf16 v[160:175], v[64:67], v[112:115], 0
    s_add_u32 s46, s53, 1
    s_add_u32 s47, s46, 17
    s_sub_u32 s47, s47, s49
    ds_read_b128 v[92:95], v25 offset:7168
    s_waitcnt lgkmcnt(6)
    v_mfma_f32_32x32x16_bf16 v[176:191], v[68:71], v[112:115], 0
    s_cmp_lt_u32 s46, s49
    s_cselect_b32 s47, s46, s47
    s_cmp_eq_u32 s32, 0
    ds_read_b128 v[64:67], v25 offset:8192
    s_waitcnt lgkmcnt(6)
    v_mfma_f32_32x32x16_bf16 v[192:207], v[72:75], v[112:115], 0
    s_cselect_b32 s47, s46, s47
    s_cmp_lt_u32 s46, 17
    s_cselect_b32 s47, s47, 0
    ds_read_b128 v[68:71], v25 offset:10240
    s_waitcnt lgkmcnt(6)
    v_mfma_f32_32x32x16_bf16 v[208:223], v[76:79], v[112:115], 0
    s_lshl_b32 s47, s47, 15
    s_add_u32 s57, s47, s44
    s_add_u32 s56, s57, 8192
    ds_read_b128 v[72:75], v25 offset:12288
    s_waitcnt lgkmcnt(6)
    v_mfma_f32_32x32x16_bf16 v[160:175], v[80:83], v[116:119], v[160:175]
    s_and_b32 s46, s53, 1
    s_xor_b32 s46, s46, 1
    s_lshl_b32 s46, s46, 14
    ds_read_b128 v[76:79], v25 offset:14336
    s_waitcnt lgkmcnt(6)
    v_mfma_f32_32x32x16_bf16 v[176:191], v[84:87], v[116:119], v[176:191]
    s_add_u32 s58, s46, s45
    s_add_u32 s48, s58, 32768
    s_mov_b32 m0, s58
    ds_read_b128 v[80:83], v25 offset:9216
    s_waitcnt lgkmcnt(6)
    v_mfma_f32_32x32x16_bf16 v[192:207], v[88:91], v[116:119], v[192:207]
    ds_read_b128 v[84:87], v25 offset:11264
    s_waitcnt lgkmcnt(6)
    v_mfma_f32_32x32x16_bf16 v[208:223], v[92:95], v[116:119], v[208:223]
    buffer_load_dwordx4 v2, s[20:23], s57 offen offset:0 lds
    ds_read_b128 v[88:91], v25 offset:13312
    s_waitcnt lgkmcnt(6)
    v_mfma_f32_32x32x16_bf16 v[160:175], v[64:67], v[120:123], v[160:175]
    ds_read_b128 v[92:95], v25 offset:15360
    s_waitcnt lgkmcnt(6)
    v_mfma_f32_32x32x16_bf16 v[176:191], v[68:71], v[120:123], v[176:191]
    ds_read_b128 v[64:67], v24 offset:0
    s_waitcnt lgkmcnt(6)
    v_mfma_f32_32x32x16_bf16 v[192:207], v[72:75], v[120:123], v[192:207]
    buffer_load_dwordx4 v2, s[20:23], s57 offen offset:1024 lds
    ds_read_b128 v[68:71], v24 offset:1024
    s_waitcnt lgkmcnt(6)
    v_mfma_f32_32x32x16_bf16 v[208:223], v[76:79], v[120:123], v[208:223]
    ds_read_b128 v[72:75], v24 offset:2048
    s_waitcnt lgkmcnt(6)
    v_mfma_f32_32x32x16_bf16 v[160:175], v[80:83], v[124:127], v[160:175]
    ds_read_b128 v[76:79], v24 offset:3072
    s_waitcnt lgkmcnt(6)
    v_mfma_f32_32x32x16_bf16 v[176:191], v[84:87], v[124:127], v[176:191]
    buffer_load_dwordx4 v2, s[20:23], s57 offen offset:2048 lds
    ds_read_b128 v[80:83], v24 offset:4096
    s_waitcnt lgkmcnt(6)
    v_mfma_f32_32x32x16_bf16 v[192:207], v[88:91], v[124:127], v[192:207]
    ds_read_b128 v[84:87], v24 offset:5120
    s_waitcnt lgkmcnt(6)
    v_mfma_f32_32x32x16_bf16 v[208:223], v[92:95], v[124:127], v[208:223]
    ds_read_b128 v[88:91], v24 offset:6144
    s_waitcnt lgkmcnt(6)
    v_mfma_f32_32x32x16_bf16 v[128:143], v[64:67], v[224:227], v[96:111]
    buffer_load_dwordx4 v2, s[20:23], s57 offen offset:3072 lds
    ds_read_b128 v[92:95], v24 offset:7168
    s_waitcnt lgkmcnt(6)
    v_mfma_f32_32x32x16_bf16 v[128:143], v[68:71], v[228:231], v[128:143]
    ds_read_b128 v[64:67], v24 offset:8192
    s_waitcnt lgkmcnt(6)
    v_mfma_f32_32x32x16_bf16 v[128:143], v[72:75], v[232:235], v[128:143]
    ds_read_b128 v[68:71], v24 offset:9216
    s_waitcnt lgkmcnt(6)
    v_mfma_f32_32x32x16_bf16 v[128:143], v[76:79], v[236:239], v[128:143]
    ds_read_b128 v[72:75], v24 offset:10240
    s_waitcnt lgkmcnt(6)
    v_mfma_f32_32x32x16_bf16 v[128:143], v[80:83], v[240:243], v[128:143]
    ds_read_b128 v[76:79], v24 offset:11264
    s_waitcnt lgkmcnt(6)
    v_mfma_f32_32x32x16_bf16 v[128:143], v[84:87], v[244:247], v[128:143]
    ds_read_b128 v[80:83], v24 offset:12288
    s_waitcnt lgkmcnt(6)
    v_mfma_f32_32x32x16_bf16 v[128:143], v[88:91], v[248:251], v[128:143]
    ds_read_b128 v[84:87], v24 offset:13312
    s_waitcnt lgkmcnt(6)
    v_mfma_f32_32x32x16_bf16 v[128:143], v[92:95], v[252:255], v[128:143]
    ds_read_b128 v[88:91], v24 offset:14336
    s_waitcnt lgkmcnt(6)
    v_mfma_f32_32x32x16_bf16 v[144:159], v[64:67], v[224:227], v[96:111]
    ds_read_b128 v[92:95], v24 offset:15360
    s_waitcnt lgkmcnt(6)
    v_mfma_f32_32x32x16_bf16 v[144:159], v[68:71], v[228:231], v[144:159]
    s_waitcnt lgkmcnt(5)
    v_mfma_f32_32x32x16_bf16 v[144:159], v[72:75], v[232:235], v[144:159]
    s_waitcnt lgkmcnt(4)
    v_mfma_f32_32x32x16_bf16 v[144:159], v[76:79], v[236:239], v[144:159]
    s_waitcnt lgkmcnt(3)
    v_mfma_f32_32x32x16_bf16 v[144:159], v[80:83], v[240:243], v[144:159]
    s_waitcnt lgkmcnt(2)
    v_mfma_f32_32x32x16_bf16 v[144:159], v[84:87], v[244:247], v[144:159]
    s_waitcnt lgkmcnt(1)
    v_mfma_f32_32x32x16_bf16 v[144:159], v[88:91], v[248:251], v[144:159]
    s_waitcnt lgkmcnt(0)
    v_mfma_f32_32x32x16_bf16 v[144:159], v[92:95], v[252:255], v[144:159]
    s_mov_b32 s62, 0
attn_kernel_mend:
    v_xor_b32 v25, 0x4000, v25
    v_xor_b32 v24, 0x4000, v24
    s_waitcnt vmcnt(4)
    s_barrier
    s_branch attn_kernel_xs
attn_kernel_mend0:
    v_xor_b32 v24, 0x4000, v24
    s_barrier
attn_kernel_xs:
    s_setprio 0
    s_lshl_b32 s46, s51, 1
    s_cmp_ge_u32 s60, s46
    s_cbranch_scc0 attn_kernel_nomask
    s_sub_u32 s47, s60, s46
    s_lshl_b32 s47, s47, 1
    v_mov_b32 v8, 0xff800000
    s_add_u32 s46, s47, 0
    s_cmp_lt_u32 s46, s31
    s_cbranch_scc1 attn_kernel_mk1_e
    s_cmp_eq_u32 s46, s31
    s_cbranch_scc1 attn_kernel_mk1_d
    v_mov_b32 v128, v8
    v_mov_b32 v129, v8
    v_mov_b32 v130, v8
    v_mov_b32 v131, v8
    v_mov_b32 v132, v8
    v_mov_b32 v133, v8
    v_mov_b32 v134, v8
    v_mov_b32 v135, v8
    v_mov_b32 v136, v8
    v_mov_b32 v137, v8
    v_mov_b32 v138, v8
    v_mov_b32 v139, v8
    v_mov_b32 v140, v8
    v_mov_b32 v141, v8
    v_mov_b32 v142, v8
    v_mov_b32 v143, v8
    s_branch attn_kernel_mk1_e
attn_kernel_mk1_d:
    v_cndmask_b32 v128, v128, v8, s[64:65]
    v_cndmask_b32 v129, v129, v8, s[66:67]
    v_cndmask_b32 v130, v130, v8, s[68:69]
    v_cndmask_b32 v131, v131, v8, s[70:71]
    v_cndmask_b32 v132, v132, v8, s[72:73]
    v_cndmask_b32 v133, v133, v8, s[74:75]
    v_cndmask_b32 v134, v134, v8, s[76:77]
    v_cndmask_b32 v135, v135, v8, s[78:79]
    v_cndmask_b32 v136, v136, v8, s[80:81]
    v_cndmask_b32 v137, v137, v8, s[82:83]
    v_cndmask_b32 v138, v138, v8, s[84:85]
    v_cndmask_b32 v139, v139, v8, s[86:87]
    v_cndmask_b32 v140, v140, v8, s[88:89]
    v_cndmask_b32 v141, v141, v8, s[90:91]
    v_cndmask_b32 v142, v142, v8, s[92:93]
    v_cndmask_b32 v143, v143, v8, s[94:95]
attn_kernel_mk1_e:
    s_add_u32 s46, s47, 1
    s_cmp_lt_u32 s46, s31
    s_cbranch_scc1 attn_kernel_mk2_e
    s_cmp_eq_u32 s46, s31
    s_cbranch_scc1 attn_kernel_mk2_d
    v_mov_b32 v144, v8
    v_mov_b32 v145, v8
    v_mov_b32 v146, v8
    v_mov_b32 v147, v8
    v_mov_b32 v148, v8
    v_mov_b32 v149, v8
    v_mov_b32 v150, v8
    v_mov_b32 v151, v8
    v_mov_b32 v152, v8
    v_mov_b32 v153, v8
    v_mov_b32 v154, v8
    v_mov_b32 v155, v8
    v_mov_b32 v156, v8
    v_mov_b32 v157, v8
    v_mov_b32 v158, v8
    v_mov_b32 v159, v8
    s_branch attn_kernel_mk2_e
attn_kernel_mk2_d:
    v_cndmask_b32 v144, v144, v8, s[64:65]
    v_cndmask_b32 v145, v145, v8, s[66:67]
    v_cndmask_b32 v146, v146, v8, s[68:69]
    v_cndmask_b32 v147, v147, v8, s[70:71]
    v_cndmask_b32 v148, v148, v8, s[72:73]
    v_cndmask_b32 v149, v149, v8, s[74:75]
    v_cndmask_b32 v150, v150, v8, s[76:77]
    v_cndmask_b32 v151, v151, v8, s[78:79]
    v_cndmask_b32 v152, v152, v8, s[80:81]
    v_cndmask_b32 v153, v153, v8, s[82:83]
    v_cndmask_b32 v154, v154, v8, s[84:85]
    v_cndmask_b32 v155, v155, v8, s[86:87]
    v_cndmask_b32 v156, v156, v8, s[88:89]
    v_cndmask_b32 v157, v157, v8, s[90:91]
    v_cndmask_b32 v158, v158, v8, s[92:93]
    v_cndmask_b32 v159, v159, v8, s[94:95]
attn_kernel_mk2_e:
attn_kernel_nomask:
    s_cmp_eq_u32 s55, 0
    s_cbranch_scc0 attn_kernel_rare
attn_kernel_exp:
    v_mov_b32 v29, 0
    v_mov_b32 v30, 0
    s_mov_b32 m0, s48
    v_exp_f32 v8, v128
    v_exp_f32 v9, v129
    buffer_load_dwordx4 v2, s[20:23], s56 offen offset:0 lds
    v_exp_f32 v10, v130
    v_exp_f32 v11, v131
    v_add_f32 v29, v29, v8
    v_add_f32 v30, v30, v9
    v_cvt_pk_bf16_f32 v112, v8, v9
    v_exp_f32 v12, v132
    v_exp_f32 v13, v133
    v_add_f32 v29, v29, v10
    v_add_f32 v30, v30, v11
    v_cvt_pk_bf16_f32 v113, v10, v11
    buffer_load_dwordx4 v2, s[20:23], s56 offen offset:1024 lds
    v_exp_f32 v14, v134
    v_exp_f32 v15, v135
    v_add_f32 v29, v29, v12
    v_add_f32 v30, v30, v13
    v_cvt_pk_bf16_f32 v114, v12, v13
    v_exp_f32 v8, v136
    v_exp_f32 v9, v137
    v_add_f32 v29, v29, v14
    v_add_f32 v30, v30, v15
    v_cvt_pk_bf16_f32 v115, v14, v15
    buffer_load_dwordx4 v2, s[20:23], s56 offen offset:2048 lds
    v_exp_f32 v10, v138
    v_exp_f32 v11, v139
    v_add_f32 v29, v29, v8
    v_add_f32 v30, v30, v9
    v_cvt_pk_bf16_f32 v116, v8, v9
    v_exp_f32 v12, v140
    v_exp_f32 v13, v141
    v_add_f32 v29, v29, v10
    v_add_f32 v30, v30, v11
    v_cvt_pk_bf16_f32 v117, v10, v11
    buffer_load_dwordx4 v2, s[20:23], s56 offen offset:3072 lds
    v_exp_f32 v14, v142
    v_exp_f32 v15, v143
    v_add_f32 v29, v29, v12
    v_add_f32 v30, v30, v13
    v_cvt_pk_bf16_f32 v118, v12, v13
    v_exp_f32 v8, v144
    v_exp_f32 v9, v145
    v_add_f32 v29, v29, v14
    v_add_f32 v30, v30, v15
    v_cvt_pk_bf16_f32 v119, v14, v15
    v_exp_f32 v10, v146
    v_exp_f32 v11, v147
    v_add_f32 v29, v29, v8
    v_add_f32 v30, v30, v9
    v_cvt_pk_bf16_f32 v120, v8, v9
    v_exp_f32 v12, v148
    v_exp_f32 v13, v149
    v_add_f32 v29, v29, v10
    v_add_f32 v30, v30, v11
    v_cvt_pk_bf16_f32 v121, v10, v11
    v_exp_f32 v14, v150
    v_exp_f32 v15, v151
    v_add_f32 v29, v29, v12
    v_add_f32 v30, v30, v13
    v_cvt_pk_bf16_f32 v122, v12, v13
    v_exp_f32 v8, v152
    v_exp_f32 v9, v153
    v_add_f32 v29, v29, v14
    v_add_f32 v30, v30, v15
    v_cvt_pk_bf16_f32 v123, v14, v15
    v_exp_f32 v10, v154
    v_exp_f32 v11, v155
    v_add_f32 v29, v29, v8
    v_add_f32 v30, v30, v9
    v_cvt_pk_bf16_f32 v124, v8, v9
    v_exp_f32 v12, v156
    v_exp_f32 v13, v157
    v_add_f32 v29, v29, v10
    v_add_f32 v30, v30, v11
    v_cvt_pk_bf16_f32 v125, v10, v11
    v_exp_f32 v14, v158
    v_exp_f32 v15, v159
    v_add_f32 v29, v29, v12
    v_add_f32 v30, v30, v13
    v_cvt_pk_bf16_f32 v126, v12, v13
    s_nop 0
    v_add_f32 v29, v29, v14
    v_add_f32 v30, v30, v15
    v_cvt_pk_bf16_f32 v127, v14, v15
    v_add_f32 v29, v29, v30
    v_mov_b32 v31, s54
    v_cmp_nle_f32 vcc, v29, v31
    s_cmp_eq_u32 s63, 1
    s_cbranch_scc1 attn_kernel_chk2
    s_cbranch_vccnz attn_kernel_rare
attn_kernel_chk2:
    s_mov_b32 s63, 0
    v_add_f32 v26, v26, v29
    s_add_u32 s53, s53, 1
    s_add_u32 s60, s60, 1
    s_cmp_eq_u32 s53, 3
    s_cbranch_scc1 attn_kernel_evP
attn_kernel_evP_ret:
    s_cmp_eq_u32 s53, s61
    s_cbranch_scc1 attn_kernel_evA
attn_kernel_evA_ret:
    s_sub_u32 s46, s53, 1
    s_cmp_eq_u32 s46, s61
    s_cbranch_scc1 attn_kernel_evB
attn_kernel_evB_ret:
    s_waitcnt vmcnt(4)
attn_kernel_xend:
    ds_read_b128 v[64:67], v25 offset:0
    ds_read_b128 v[68:71], v25 offset:2048
    ds_read_b128 v[72:75], v25 offset:4096
    ds_read_b128 v[76:79], v25 offset:6144
    ds_read_b128 v[80:83], v25 offset:1024
    ds_read_b128 v[84:87], v25 offset:3072
    s_barrier
    s_branch attn_kernel_pv
attn_kernel_evP:
    s_cmp_eq_u32 s32, 0
    s_cbranch_scc0 attn_kernel_evP_ret
    s_waitcnt vmcnt(4)
    s_load_dwordx2 s[12:13], s[0:1], 40
    s_load_dwordx4 s[16:19], s[0:1], 56
    s_load_dwordx2 s[14:15], s[0:1], 72
    v_lshlrev_b32 v12, 4, v0
    s_lshl_b32 s46, s2, 14
    v_add_u32 v13, s46, v12
    s_lshl_b32 s46, s2, 13
    v_add_u32 v14, s46, v12
    s_waitcnt lgkmcnt(0)
    v_add_u32 v15, 0, v13
    global_load_dwordx4 v[32:35], v15, s[12:13]
    v_add_u32 v15, 4096, v13
    global_load_dwordx4 v[36:39], v15, s[12:13]
    v_add_u32 v15, 8192, v13
    global_load_dwordx4 v[40:43], v15, s[12:13]
    v_add_u32 v15, 12288, v13
    global_load_dwordx4 v[44:47], v15, s[12:13]
    s_cmp_ge_u32 s2, 224
    s_cbranch_scc1 attn_kernel_xend
    global_load_dwordx4 v[48:51], v14, s[16:17]
    v_add_u32 v15, 4096, v14
    global_load_dwordx4 v[48:51], v15, s[16:17]
    global_load_dwordx4 v[52:55], v14, s[18:19]
    v_add_u32 v15, 4096, v14
    global_load_dwordx4 v[52:55], v15, s[18:19]
    global_load_dwordx4 v[56:59], v14, s[14:15]
    v_add_u32 v15, 4096, v14
    global_load_dwordx4 v[56:59], v15, s[14:15]
    s_branch attn_kernel_xend
attn_kernel_evA:
    v_mov_b32 v17, v26
    v_mov_b32 v12, v26
    s_nop 1
    v_permlane32_swap_b32 v17, v12
    s_nop 1
    v_add_f32 v17, v17, v12
    v_mov_b32 v224, v32
    v_mov_b32 v225, v33
    v_mov_b32 v226, v34
    v_mov_b32 v227, v35
    v_mov_b32 v228, v36
    v_mov_b32 v229, v37
    v_mov_b32 v230, v38
    v_mov_b32 v231, v39
    v_mov_b32 v232, v40
    v_mov_b32 v233, v41
    v_mov_b32 v234, v42
    v_mov_b32 v235, v43
    v_mov_b32 v236, v44
    v_mov_b32 v237, v45
    v_mov_b32 v238, v46
    v_mov_b32 v239, v47
    v_mov_b32 v240, v48
    v_mov_b32 v241, v49
    v_mov_b32 v242, v50
    v_mov_b32 v243, v51
    v_mov_b32 v244, v52
    v_mov_b32 v245, v53
    v_mov_b32 v246, v54
    v_mov_b32 v247, v55
    v_mov_b32 v248, v56
    v_mov_b32 v249, v57
    v_mov_b32 v250, v58
    v_mov_b32 v251, v59
    v_mov_b32 v252, v60
    v_mov_b32 v253, v61
    v_mov_b32 v254, v62
    v_mov_b32 v255, v63
    v_mov_b32 v96, 0
    v_mov_b32 v97, 0
    v_mov_b32 v98, 0
    v_mov_b32 v99, 0
    v_mov_b32 v100, 0
    v_mov_b32 v101, 0
    v_mov_b32 v102, 0
    v_mov_b32 v103, 0
    v_mov_b32 v104, 0
    v_mov_b32 v105, 0
    v_mov_b32 v106, 0
    v_mov_b32 v107, 0
    v_mov_b32 v108, 0
    v_mov_b32 v109, 0
    v_mov_b32 v110, 0
    v_mov_b32 v111, 0
    v_mov_b32 v26, 0
    v_mov_b32 v27, 0
    s_mov_b32 s54, 3212836864
    s_mov_b32 s55, 4048155338
    s_mov_b32 s50, s51
    s_mov_b32 s51, s35
    s_mov_b32 s60, 17
    s_waitcnt vmcnt(4)
    ds_read_b128 v[64:67], v25 offset:0
    ds_read_b128 v[68:71], v25 offset:2048
    ds_read_b128 v[72:75], v25 offset:4096
    ds_read_b128 v[76:79], v25 offset:6144
    ds_read_b128 v[80:83], v25 offset:1024
    ds_read_b128 v[84:87], v25 offset:3072
    s_barrier
    s_branch attn_kernel_pv
attn_kernel_evB:
    v_rcp_f32 v13, v17
    s_lshl_b32 s46, s50, 2
    s_add_u32 s46, s46, s31
    s_lshl_b32 s46, s46, 18
    s_lshl_b32 s47, s33, 13
    s_add_u32 s50, s46, s47
    v_mul_f32 v160, v160, v13
    v_mul_f32 v161, v161, v13
    v_mul_f32 v162, v162, v13
    v_mul_f32 v163, v163, v13
    v_mul_f32 v164, v164, v13
    v_mul_f32 v165, v165, v13
    v_mul_f32 v166, v166, v13
    v_mul_f32 v167, v167, v13
    v_mul_f32 v168, v168, v13
    v_mul_f32 v169, v169, v13
    v_mul_f32 v170, v170, v13
    v_mul_f32 v171, v171, v13
    v_mul_f32 v172, v172, v13
    v_mul_f32 v173, v173, v13
    v_mul_f32 v174, v174, v13
    v_mul_f32 v175, v175, v13
    v_mul_f32 v176, v176, v13
    v_mul_f32 v177, v177, v13
    v_mul_f32 v178, v178, v13
    v_mul_f32 v179, v179, v13
    v_mul_f32 v180, v180, v13
    v_mul_f32 v181, v181, v13
    v_mul_f32 v182, v182, v13
    v_mul_f32 v183, v183, v13
    v_mul_f32 v184, v184, v13
    v_mul_f32 v185, v185, v13
    v_mul_f32 v186, v186, v13
    v_mul_f32 v187, v187, v13
    v_mul_f32 v188, v188, v13
    v_mul_f32 v189, v189, v13
    v_mul_f32 v190, v190, v13
    v_mul_f32 v191, v191, v13
    v_mul_f32 v192, v192, v13
    v_mul_f32 v193, v193, v13
    v_mul_f32 v194, v194, v13
    v_mul_f32 v195, v195, v13
    v_mul_f32 v196, v196, v13
    v_mul_f32 v197, v197, v13
    v_mul_f32 v198, v198, v13
    v_mul_f32 v199, v199, v13
    v_mul_f32 v200, v200, v13
    v_mul_f32 v201, v201, v13
    v_mul_f32 v202, v202, v13
    v_mul_f32 v203, v203, v13
    v_mul_f32 v204, v204, v13
    v_mul_f32 v205, v205, v13
    v_mul_f32 v206, v206, v13
    v_mul_f32 v207, v207, v13
    v_mul_f32 v208, v208, v13
    v_mul_f32 v209, v209, v13
    v_mul_f32 v210, v210, v13
    v_mul_f32 v211, v211, v13
    v_mul_f32 v212, v212, v13
    v_mul_f32 v213, v213, v13
    v_mul_f32 v214, v214, v13
    v_mul_f32 v215, v215, v13
    v_mul_f32 v216, v216, v13
    v_mul_f32 v217, v217, v13
    v_mul_f32 v218, v218, v13
    v_mul_f32 v219, v219, v13
    v_mul_f32 v220, v220, v13
    v_mul_f32 v221, v221, v13
    v_mul_f32 v222, v222, v13
    v_mul_f32 v223, v223, v13
    v_cvt_pk_bf16_f32 v128, v160, v161
    v_cvt_pk_bf16_f32 v129, v162, v163
    v_cvt_pk_bf16_f32 v130, v164, v165
    v_cvt_pk_bf16_f32 v131, v166, v167
    v_cvt_pk_bf16_f32 v132, v168, v169
    v_cvt_pk_bf16_f32 v133, v170, v171
    v_cvt_pk_bf16_f32 v134, v172, v173
    v_cvt_pk_bf16_f32 v135, v174, v175
    v_cvt_pk_bf16_f32 v136, v176, v177
    v_cvt_pk_bf16_f32 v137, v178, v179
    v_cvt_pk_bf16_f32 v138, v180, v181
    v_cvt_pk_bf16_f32 v139, v182, v183
    v_cvt_pk_bf16_f32 v140, v184, v185
    v_cvt_pk_bf16_f32 v141, v186, v187
    v_cvt_pk_bf16_f32 v142, v188, v189
    v_cvt_pk_bf16_f32 v143, v190, v191
    v_cvt_pk_bf16_f32 v144, v192, v193
    v_cvt_pk_bf16_f32 v145, v194, v195
    v_cvt_pk_bf16_f32 v146, v196, v197
    v_cvt_pk_bf16_f32 v147, v198, v199
    v_cvt_pk_bf16_f32 v148, v200, v201
    v_cvt_pk_bf16_f32 v149, v202, v203
    v_cvt_pk_bf16_f32 v150, v204, v205
    v_cvt_pk_bf16_f32 v151, v206, v207
    v_cvt_pk_bf16_f32 v152, v208, v209
    v_cvt_pk_bf16_f32 v153, v210, v211
    v_cvt_pk_bf16_f32 v154, v212, v213
    v_cvt_pk_bf16_f32 v155, v214, v215
    v_cvt_pk_bf16_f32 v156, v216, v217
    v_cvt_pk_bf16_f32 v157, v218, v219
    v_cvt_pk_bf16_f32 v158, v220, v221
    v_cvt_pk_bf16_f32 v159, v222, v223
    s_add_u32 s46, s50, 0
    buffer_store_dwordx4 v[128:131], v2, s[24:27], s46 offen offset:0 sc1
    buffer_store_dwordx4 v[132:135], v2, s[24:27], s46 offen offset:1024 sc1
    buffer_store_dwordx4 v[136:139], v2, s[24:27], s46 offen offset:2048 sc1
    buffer_store_dwordx4 v[140:143], v2, s[24:27], s46 offen offset:3072 sc1
    s_add_u32 s46, s50, 4096
    buffer_store_dwordx4 v[144:147], v2, s[24:27], s46 offen offset:0 sc1
    buffer_store_dwordx4 v[148:151], v2, s[24:27], s46 offen offset:1024 sc1
    buffer_store_dwordx4 v[152:155], v2, s[24:27], s46 offen offset:2048 sc1
    buffer_store_dwordx4 v[156:159], v2, s[24:27], s46 offen offset:3072 sc1
    s_mov_b32 s62, 1
    s_waitcnt vmcnt(12)
    ds_read_b128 v[64:67], v25 offset:0
    ds_read_b128 v[68:71], v25 offset:2048
    ds_read_b128 v[72:75], v25 offset:4096
    ds_read_b128 v[76:79], v25 offset:6144
    ds_read_b128 v[80:83], v25 offset:1024
    ds_read_b128 v[84:87], v25 offset:3072
    s_barrier
    s_branch attn_kernel_pv
attn_kernel_mlast:
    s_cmp_eq_u32 s62, 1
    s_cbranch_scc1 attn_kernel_mlastf
    ds_read_b128 v[88:91], v25 offset:5120
    s_waitcnt lgkmcnt(6)
    v_mfma_f32_32x32x16_bf16 v[160:175], v[64:67], v[112:115], v[160:175]
    ds_read_b128 v[92:95], v25 offset:7168
    s_waitcnt lgkmcnt(6)
    v_mfma_f32_32x32x16_bf16 v[176:191], v[68:71], v[112:115], v[176:191]
    ds_read_b128 v[64:67], v25 offset:8192
    s_waitcnt lgkmcnt(6)
    v_mfma_f32_32x32x16_bf16 v[192:207], v[72:75], v[112:115], v[192:207]
    ds_read_b128 v[68:71], v25 offset:10240
    s_waitcnt lgkmcnt(6)
    v_mfma_f32_32x32x16_bf16 v[208:223], v[76:79], v[112:115], v[208:223]
    ds_read_b128 v[72:75], v25 offset:12288
    s_waitcnt lgkmcnt(6)
    v_mfma_f32_32x32x16_bf16 v[160:175], v[80:83], v[116:119], v[160:175]
    ds_read_b128 v[76:79], v25 offset:14336
    s_waitcnt lgkmcnt(6)
    v_mfma_f32_32x32x16_bf16 v[176:191], v[84:87], v[116:119], v[176:191]
    ds_read_b128 v[80:83], v25 offset:9216
    s_waitcnt lgkmcnt(6)
    v_mfma_f32_32x32x16_bf16 v[192:207], v[88:91], v[116:119], v[192:207]
    ds_read_b128 v[84:87], v25 offset:11264
    s_waitcnt lgkmcnt(6)
    v_mfma_f32_32x32x16_bf16 v[208:223], v[92:95], v[116:119], v[208:223]
    ds_read_b128 v[88:91], v25 offset:13312
    s_waitcnt lgkmcnt(6)
    v_mfma_f32_32x32x16_bf16 v[160:175], v[64:67], v[120:123], v[160:175]
    ds_read_b128 v[92:95], v25 offset:15360
    s_waitcnt lgkmcnt(6)
    v_mfma_f32_32x32x16_bf16 v[176:191], v[68:71], v[120:123], v[176:191]
    s_waitcnt lgkmcnt(5)
    v_mfma_f32_32x32x16_bf16 v[192:207], v[72:75], v[120:123], v[192:207]
    s_waitcnt lgkmcnt(4)
    v_mfma_f32_32x32x16_bf16 v[208:223], v[76:79], v[120:123], v[208:223]
    s_waitcnt lgkmcnt(3)
    v_mfma_f32_32x32x16_bf16 v[160:175], v[80:83], v[124:127], v[160:175]
    s_waitcnt lgkmcnt(2)
    v_mfma_f32_32x32x16_bf16 v[176:191], v[84:87], v[124:127], v[176:191]
    s_waitcnt lgkmcnt(1)
    v_mfma_f32_32x32x16_bf16 v[192:207], v[88:91], v[124:127], v[192:207]
    s_waitcnt lgkmcnt(0)
    v_mfma_f32_32x32x16_bf16 v[208:223], v[92:95], v[124:127], v[208:223]
    s_branch attn_kernel_mlastz
attn_kernel_mlastf:
    ds_read_b128 v[88:91], v25 offset:5120
    s_waitcnt lgkmcnt(6)
    v_mfma_f32_32x32x16_bf16 v[160:175], v[64:67], v[112:115], 0
    ds_read_b128 v[92:95], v25 offset:7168
    s_waitcnt lgkmcnt(6)
    v_mfma_f32_32x32x16_bf16 v[176:191], v[68:71], v[112:115], 0
    ds_read_b128 v[64:67], v25 offset:8192
    s_waitcnt lgkmcnt(6)
    v_mfma_f32_32x32x16_bf16 v[192:207], v[72:75], v[112:115], 0
    ds_read_b128 v[68:71], v25 offset:10240
    s_waitcnt lgkmcnt(6)
    v_mfma_f32_32x32x16_bf16 v[208:223], v[76:79], v[112:115], 0
    ds_read_b128 v[72:75], v25 offset:12288
    s_waitcnt lgkmcnt(6)
    v_mfma_f32_32x32x16_bf16 v[160:175], v[80:83], v[116:119], v[160:175]
    ds_read_b128 v[76:79], v25 offset:14336
    s_waitcnt lgkmcnt(6)
    v_mfma_f32_32x32x16_bf16 v[176:191], v[84:87], v[116:119], v[176:191]
    ds_read_b128 v[80:83], v25 offset:9216
    s_waitcnt lgkmcnt(6)
    v_mfma_f32_32x32x16_bf16 v[192:207], v[88:91], v[116:119], v[192:207]
    ds_read_b128 v[84:87], v25 offset:11264
    s_waitcnt lgkmcnt(6)
    v_mfma_f32_32x32x16_bf16 v[208:223], v[92:95], v[116:119], v[208:223]
    ds_read_b128 v[88:91], v25 offset:13312
    s_waitcnt lgkmcnt(6)
    v_mfma_f32_32x32x16_bf16 v[160:175], v[64:67], v[120:123], v[160:175]
    ds_read_b128 v[92:95], v25 offset:15360
    s_waitcnt lgkmcnt(6)
    v_mfma_f32_32x32x16_bf16 v[176:191], v[68:71], v[120:123], v[176:191]
    s_waitcnt lgkmcnt(5)
    v_mfma_f32_32x32x16_bf16 v[192:207], v[72:75], v[120:123], v[192:207]
    s_waitcnt lgkmcnt(4)
    v_mfma_f32_32x32x16_bf16 v[208:223], v[76:79], v[120:123], v[208:223]
    s_waitcnt lgkmcnt(3)
    v_mfma_f32_32x32x16_bf16 v[160:175], v[80:83], v[124:127], v[160:175]
    s_waitcnt lgkmcnt(2)
    v_mfma_f32_32x32x16_bf16 v[176:191], v[84:87], v[124:127], v[176:191]
    s_waitcnt lgkmcnt(1)
    v_mfma_f32_32x32x16_bf16 v[192:207], v[88:91], v[124:127], v[192:207]
    s_waitcnt lgkmcnt(0)
    v_mfma_f32_32x32x16_bf16 v[208:223], v[92:95], v[124:127], v[208:223]
attn_kernel_mlastz:
    s_waitcnt vmcnt(0)
    s_barrier
    v_mov_b32 v17, v26
    v_mov_b32 v12, v26
    s_nop 1
    v_permlane32_swap_b32 v17, v12
    s_nop 1
    v_add_f32 v17, v17, v12
    v_mov_b32 v16, v27
    s_lshl_b32 s46, s31, 14
    s_add_u32 s46, s46, s43
    v_add_u32 v8, s46, v2
    ds_write_b64 v8, v[16:17] offset:8192
    s_cmp_eq_u32 s32, 0
    s_cbranch_scc1 attn_kernel_g0x
    ds_write_b128 v8, v[160:163] offset:0
    ds_write_b128 v8, v[164:167] offset:1024
    ds_write_b128 v8, v[168:171] offset:2048
    ds_write_b128 v8, v[172:175] offset:3072
    ds_write_b128 v8, v[176:179] offset:4096
    ds_write_b128 v8, v[180:183] offset:5120
    ds_write_b128 v8, v[184:187] offset:6144
    ds_write_b128 v8, v[188:191] offset:7168
    s_branch attn_kernel_x2
attn_kernel_g0x:
    ds_write_b128 v8, v[192:195] offset:0
    ds_write_b128 v8, v[196:199] offset:1024
    ds_write_b128 v8, v[200:203] offset:2048
    ds_write_b128 v8, v[204:207] offset:3072
    ds_write_b128 v8, v[208:211] offset:4096
    ds_write_b128 v8, v[212:215] offset:5120
    ds_write_b128 v8, v[216:219] offset:6144
    ds_write_b128 v8, v[220:223] offset:7168
    s_waitcnt lgkmcnt(0)
    s_barrier
attn_kernel_x2:
    s_waitcnt lgkmcnt(0)
    s_barrier
    v_xor_b32 v8, 0x10000, v8
    ds_read_b128 v[128:131], v8 offset:0
    ds_read_b128 v[132:135], v8 offset:1024
    ds_read_b128 v[136:139], v8 offset:2048
    ds_read_b128 v[140:143], v8 offset:3072
    ds_read_b128 v[144:147], v8 offset:4096
    ds_read_b128 v[148:151], v8 offset:5120
    ds_read_b128 v[152:155], v8 offset:6144
    ds_read_b128 v[156:159], v8 offset:7168
    ds_read_b64 v[4:5], v8 offset:8192
    s_waitcnt lgkmcnt(0)
    v_max_f32 v12, v27, v4
    v_sub_f32 v13, v27, v12
    v_sub_f32 v14, v4, v12
    v_exp_f32 v13, v13
    v_exp_f32 v14, v14
    s_nop 0
    v_mul_f32 v15, v13, v17
    v_fmac_f32 v15, v14, v5
    v_rcp_f32 v15, v15
    s_nop 0
    v_mul_f32 v13, v13, v15
    v_mul_f32 v14, v14, v15
    s_lshl_b32 s46, s35, 2
    s_add_u32 s46, s46, s31
    s_lshl_b32 s46, s46, 18
    s_lshl_b32 s47, s33, 13
    s_add_u32 s46, s46, s47
    s_lshl_b32 s47, s32, 12
    s_add_u32 s46, s46, s47
    s_cmp_eq_u32 s32, 0
    s_cbranch_scc0 attn_kernel_fin1
    v_mul_f32 v160, v160, v13
    v_fmac_f32 v160, v128, v14
    v_mul_f32 v161, v161, v13
    v_fmac_f32 v161, v129, v14
    v_mul_f32 v162, v162, v13
    v_fmac_f32 v162, v130, v14
    v_mul_f32 v163, v163, v13
    v_fmac_f32 v163, v131, v14
    v_mul_f32 v164, v164, v13
    v_fmac_f32 v164, v132, v14
    v_mul_f32 v165, v165, v13
    v_fmac_f32 v165, v133, v14
    v_mul_f32 v166, v166, v13
    v_fmac_f32 v166, v134, v14
    v_mul_f32 v167, v167, v13
    v_fmac_f32 v167, v135, v14
    v_mul_f32 v168, v168, v13
    v_fmac_f32 v168, v136, v14
    v_mul_f32 v169, v169, v13
    v_fmac_f32 v169, v137, v14
    v_mul_f32 v170, v170, v13
    v_fmac_f32 v170, v138, v14
    v_mul_f32 v171, v171, v13
    v_fmac_f32 v171, v139, v14
    v_mul_f32 v172, v172, v13
    v_fmac_f32 v172, v140, v14
    v_mul_f32 v173, v173, v13
    v_fmac_f32 v173, v141, v14
    v_mul_f32 v174, v174, v13
    v_fmac_f32 v174, v142, v14
    v_mul_f32 v175, v175, v13
    v_fmac_f32 v175, v143, v14
    v_mul_f32 v176, v176, v13
    v_fmac_f32 v176, v144, v14
    v_mul_f32 v177, v177, v13
    v_fmac_f32 v177, v145, v14
    v_mul_f32 v178, v178, v13
    v_fmac_f32 v178, v146, v14
    v_mul_f32 v179, v179, v13
    v_fmac_f32 v179, v147, v14
    v_mul_f32 v180, v180, v13
    v_fmac_f32 v180, v148, v14
    v_mul_f32 v181, v181, v13
    v_fmac_f32 v181, v149, v14
    v_mul_f32 v182, v182, v13
    v_fmac_f32 v182, v150, v14
    v_mul_f32 v183, v183, v13
    v_fmac_f32 v183, v151, v14
    v_mul_f32 v184, v184, v13
    v_fmac_f32 v184, v152, v14
    v_mul_f32 v185, v185, v13
    v_fmac_f32 v185, v153, v14
    v_mul_f32 v186, v186, v13
    v_fmac_f32 v186, v154, v14
    v_mul_f32 v187, v187, v13
    v_fmac_f32 v187, v155, v14
    v_mul_f32 v188, v188, v13
    v_fmac_f32 v188, v156, v14
    v_mul_f32 v189, v189, v13
    v_fmac_f32 v189, v157, v14
    v_mul_f32 v190, v190, v13
    v_fmac_f32 v190, v158, v14
    v_mul_f32 v191, v191, v13
    v_fmac_f32 v191, v159, v14
    v_cvt_pk_bf16_f32 v112, v160, v161
    v_cvt_pk_bf16_f32 v113, v162, v163
    v_cvt_pk_bf16_f32 v114, v164, v165
    v_cvt_pk_bf16_f32 v115, v166, v167
    v_cvt_pk_bf16_f32 v116, v168, v169
    v_cvt_pk_bf16_f32 v117, v170, v171
    v_cvt_pk_bf16_f32 v118, v172, v173
    v_cvt_pk_bf16_f32 v119, v174, v175
    v_cvt_pk_bf16_f32 v120, v176, v177
    v_cvt_pk_bf16_f32 v121, v178, v179
    v_cvt_pk_bf16_f32 v122, v180, v181
    v_cvt_pk_bf16_f32 v123, v182, v183
    v_cvt_pk_bf16_f32 v124, v184, v185
    v_cvt_pk_bf16_f32 v125, v186, v187
    v_cvt_pk_bf16_f32 v126, v188, v189
    v_cvt_pk_bf16_f32 v127, v190, v191
    s_branch attn_kernel_fin2
attn_kernel_fin1:
    v_mul_f32 v192, v192, v13
    v_fmac_f32 v192, v128, v14
    v_mul_f32 v193, v193, v13
    v_fmac_f32 v193, v129, v14
    v_mul_f32 v194, v194, v13
    v_fmac_f32 v194, v130, v14
    v_mul_f32 v195, v195, v13
    v_fmac_f32 v195, v131, v14
    v_mul_f32 v196, v196, v13
    v_fmac_f32 v196, v132, v14
    v_mul_f32 v197, v197, v13
    v_fmac_f32 v197, v133, v14
    v_mul_f32 v198, v198, v13
    v_fmac_f32 v198, v134, v14
    v_mul_f32 v199, v199, v13
    v_fmac_f32 v199, v135, v14
    v_mul_f32 v200, v200, v13
    v_fmac_f32 v200, v136, v14
    v_mul_f32 v201, v201, v13
    v_fmac_f32 v201, v137, v14
    v_mul_f32 v202, v202, v13
    v_fmac_f32 v202, v138, v14
    v_mul_f32 v203, v203, v13
    v_fmac_f32 v203, v139, v14
    v_mul_f32 v204, v204, v13
    v_fmac_f32 v204, v140, v14
    v_mul_f32 v205, v205, v13
    v_fmac_f32 v205, v141, v14
    v_mul_f32 v206, v206, v13
    v_fmac_f32 v206, v142, v14
    v_mul_f32 v207, v207, v13
    v_fmac_f32 v207, v143, v14
    v_mul_f32 v208, v208, v13
    v_fmac_f32 v208, v144, v14
    v_mul_f32 v209, v209, v13
    v_fmac_f32 v209, v145, v14
    v_mul_f32 v210, v210, v13
    v_fmac_f32 v210, v146, v14
    v_mul_f32 v211, v211, v13
    v_fmac_f32 v211, v147, v14
    v_mul_f32 v212, v212, v13
    v_fmac_f32 v212, v148, v14
    v_mul_f32 v213, v213, v13
    v_fmac_f32 v213, v149, v14
    v_mul_f32 v214, v214, v13
    v_fmac_f32 v214, v150, v14
    v_mul_f32 v215, v215, v13
    v_fmac_f32 v215, v151, v14
    v_mul_f32 v216, v216, v13
    v_fmac_f32 v216, v152, v14
    v_mul_f32 v217, v217, v13
    v_fmac_f32 v217, v153, v14
    v_mul_f32 v218, v218, v13
    v_fmac_f32 v218, v154, v14
    v_mul_f32 v219, v219, v13
    v_fmac_f32 v219, v155, v14
    v_mul_f32 v220, v220, v13
    v_fmac_f32 v220, v156, v14
    v_mul_f32 v221, v221, v13
    v_fmac_f32 v221, v157, v14
    v_mul_f32 v222, v222, v13
    v_fmac_f32 v222, v158, v14
    v_mul_f32 v223, v223, v13
    v_fmac_f32 v223, v159, v14
    v_cvt_pk_bf16_f32 v112, v192, v193
    v_cvt_pk_bf16_f32 v113, v194, v195
    v_cvt_pk_bf16_f32 v114, v196, v197
    v_cvt_pk_bf16_f32 v115, v198, v199
    v_cvt_pk_bf16_f32 v116, v200, v201
    v_cvt_pk_bf16_f32 v117, v202, v203
    v_cvt_pk_bf16_f32 v118, v204, v205
    v_cvt_pk_bf16_f32 v119, v206, v207
    v_cvt_pk_bf16_f32 v120, v208, v209
    v_cvt_pk_bf16_f32 v121, v210, v211
    v_cvt_pk_bf16_f32 v122, v212, v213
    v_cvt_pk_bf16_f32 v123, v214, v215
    v_cvt_pk_bf16_f32 v124, v216, v217
    v_cvt_pk_bf16_f32 v125, v218, v219
    v_cvt_pk_bf16_f32 v126, v220, v221
    v_cvt_pk_bf16_f32 v127, v222, v223
attn_kernel_fin2:
    buffer_store_dwordx4 v[112:115], v2, s[24:27], s46 offen offset:0 sc1
    buffer_store_dwordx4 v[116:119], v2, s[24:27], s46 offen offset:1024 sc1
    buffer_store_dwordx4 v[120:123], v2, s[24:27], s46 offen offset:2048 sc1
    buffer_store_dwordx4 v[124:127], v2, s[24:27], s46 offen offset:3072 sc1
    s_branch attn_kernel_fini
attn_kernel_rare:
    v_max3_f32 v8, v128, v129, v130
    v_max3_f32 v8, v8, v131, v132
    v_max3_f32 v8, v8, v133, v134
    v_max3_f32 v8, v8, v135, v136
    v_max3_f32 v8, v8, v137, v138
    v_max3_f32 v8, v8, v139, v140
    v_max3_f32 v8, v8, v141, v142
    v_max3_f32 v8, v8, v143, v144
    v_max3_f32 v8, v8, v145, v146
    v_max3_f32 v8, v8, v147, v148
    v_max3_f32 v8, v8, v149, v150
    v_max3_f32 v8, v8, v151, v152
    v_max3_f32 v8, v8, v153, v154
    v_max3_f32 v8, v8, v155, v156
    v_max3_f32 v8, v8, v157, v158
    v_max_f32 v8, v8, v159
    v_mov_b32 v9, v8
    s_nop 1
    v_permlane32_swap_b32 v8, v9
    s_nop 1
    v_max_f32 v8, v8, v9
    v_max_f32 v8, s55, v8
    v_max_f32 v9, 0, v8
    v_sub_f32 v9, 0, v9
    v_exp_f32 v9, v9
    v_add_f32 v27, v27, v8
    v_sub_f32 v96, v96, v8
    v_sub_f32 v97, v97, v8
    v_sub_f32 v98, v98, v8
    v_sub_f32 v99, v99, v8
    v_sub_f32 v100, v100, v8
    v_sub_f32 v101, v101, v8
    v_sub_f32 v102, v102, v8
    v_sub_f32 v103, v103, v8
    v_sub_f32 v104, v104, v8
    v_sub_f32 v105, v105, v8
    v_sub_f32 v106, v106, v8
    v_sub_f32 v107, v107, v8
    v_sub_f32 v108, v108, v8
    v_sub_f32 v109, v109, v8
    v_sub_f32 v110, v110, v8
    v_sub_f32 v111, v111, v8
    v_sub_f32 v128, v128, v8
    v_sub_f32 v129, v129, v8
    v_sub_f32 v130, v130, v8
    v_sub_f32 v131, v131, v8
    v_sub_f32 v132, v132, v8
    v_sub_f32 v133, v133, v8
    v_sub_f32 v134, v134, v8
    v_sub_f32 v135, v135, v8
    v_sub_f32 v136, v136, v8
    v_sub_f32 v137, v137, v8
    v_sub_f32 v138, v138, v8
    v_sub_f32 v139, v139, v8
    v_sub_f32 v140, v140, v8
    v_sub_f32 v141, v141, v8
    v_sub_f32 v142, v142, v8
    v_sub_f32 v143, v143, v8
    v_sub_f32 v144, v144, v8
    v_sub_f32 v145, v145, v8
    v_sub_f32 v146, v146, v8
    v_sub_f32 v147, v147, v8
    v_sub_f32 v148, v148, v8
    v_sub_f32 v149, v149, v8
    v_sub_f32 v150, v150, v8
    v_sub_f32 v151, v151, v8
    v_sub_f32 v152, v152, v8
    v_sub_f32 v153, v153, v8
    v_sub_f32 v154, v154, v8
    v_sub_f32 v155, v155, v8
    v_sub_f32 v156, v156, v8
    v_sub_f32 v157, v157, v8
    v_sub_f32 v158, v158, v8
    v_sub_f32 v159, v159, v8
    s_cmp_eq_u32 s55, 0
    s_cbranch_scc0 attn_kernel_rare2
    v_mul_f32 v160, v160, v9
    v_mul_f32 v161, v161, v9
    v_mul_f32 v162, v162, v9
    v_mul_f32 v163, v163, v9
    v_mul_f32 v164, v164, v9
    v_mul_f32 v165, v165, v9
    v_mul_f32 v166, v166, v9
    v_mul_f32 v167, v167, v9
    v_mul_f32 v168, v168, v9
    v_mul_f32 v169, v169, v9
    v_mul_f32 v170, v170, v9
    v_mul_f32 v171, v171, v9
    v_mul_f32 v172, v172, v9
    v_mul_f32 v173, v173, v9
    v_mul_f32 v174, v174, v9
    v_mul_f32 v175, v175, v9
    v_mul_f32 v176, v176, v9
    v_mul_f32 v177, v177, v9
    v_mul_f32 v178, v178, v9
    v_mul_f32 v179, v179, v9
    v_mul_f32 v180, v180, v9
    v_mul_f32 v181, v181, v9
    v_mul_f32 v182, v182, v9
    v_mul_f32 v183, v183, v9
    v_mul_f32 v184, v184, v9
    v_mul_f32 v185, v185, v9
    v_mul_f32 v186, v186, v9
    v_mul_f32 v187, v187, v9
    v_mul_f32 v188, v188, v9
    v_mul_f32 v189, v189, v9
    v_mul_f32 v190, v190, v9
    v_mul_f32 v191, v191, v9
    v_mul_f32 v192, v192, v9
    v_mul_f32 v193, v193, v9
    v_mul_f32 v194, v194, v9
    v_mul_f32 v195, v195, v9
    v_mul_f32 v196, v196, v9
    v_mul_f32 v197, v197, v9
    v_mul_f32 v198, v198, v9
    v_mul_f32 v199, v199, v9
    v_mul_f32 v200, v200, v9
    v_mul_f32 v201, v201, v9
    v_mul_f32 v202, v202, v9
    v_mul_f32 v203, v203, v9
    v_mul_f32 v204, v204, v9
    v_mul_f32 v205, v205, v9
    v_mul_f32 v206, v206, v9
    v_mul_f32 v207, v207, v9
    v_mul_f32 v208, v208, v9
    v_mul_f32 v209, v209, v9
    v_mul_f32 v210, v210, v9
    v_mul_f32 v211, v211, v9
    v_mul_f32 v212, v212, v9
    v_mul_f32 v213, v213, v9
    v_mul_f32 v214, v214, v9
    v_mul_f32 v215, v215, v9
    v_mul_f32 v216, v216, v9
    v_mul_f32 v217, v217, v9
    v_mul_f32 v218, v218, v9
    v_mul_f32 v219, v219, v9
    v_mul_f32 v220, v220, v9
    v_mul_f32 v221, v221, v9
    v_mul_f32 v222, v222, v9
    v_mul_f32 v223, v223, v9
    v_mul_f32 v26, v26, v9
attn_kernel_rare2:
    s_mov_b32 s54, 1166016512
    s_mov_b32 s55, 0
    s_mov_b32 s63, 1
    s_branch attn_kernel_exp
attn_kernel_fini:
attn_kernel_end:
    s_endpgm
.globl oproj_kernel
.p2align 8
.type oproj_kernel,@function
oproj_kernel:
    s_cmp_ge_u32 s2, 256
    s_cbranch_scc1 oproj_kernel_end
    s_load_dwordx2 s[4:5], s[0:1], 40
    s_load_dwordx2 s[8:9], s[0:1], 112
    v_and_b32 v1, 63, v0
    v_lshrrev_b32 v5, 6, v0
    s_nop 0
    v_readfirstlane_b32 s30, v5
    s_and_b32 s31, s30, 1
    s_lshr_b32 s32, s30, 1
    s_and_b32 s32, s32, 1
    s_lshr_b32 s33, s30, 2
    s_and_b32 s34, s2, 7
    s_lshr_b32 s35, s2, 3
    s_and_b32 s37, s34, 3
    s_lshr_b32 s34, s34, 2
    s_lshl_b32 s34, s34, 3
    s_and_b32 s36, s35, 7
    s_add_u32 s34, s34, s36
    s_lshr_b32 s36, s35, 3
    s_waitcnt lgkmcnt(0)
    s_add_u32 s12, s8, 17825792
    s_addc_u32 s13, s9, 0
    s_mov_b32 s14, 16777216
    s_mov_b32 s15, 0x00020000
    s_mov_b32 s16, s4
    s_mov_b32 s17, s5
    s_mov_b32 s18, 4194304
    s_mov_b32 s19, 0x00020000
    s_add_u32 s20, s8, 34603008
    s_addc_u32 s21, s9, 0
    s_mov_b32 s22, 16777216
    s_mov_b32 s23, 0x00020000
    v_lshlrev_b32 v2, 4, v1
    v_lshrrev_b32 v5, 4, v1
    v_and_b32 v6, 15, v1
    v_lshlrev_b32 v7, 2, v5
    v_xor_b32 v6, v6, v7
    v_lshlrev_b32 v6, 4, v6
    v_lshlrev_b32 v5, 10, v5
    v_add_u32 v3, v5, v6
    s_lshl_b32 s40, s37, 20
    s_lshl_b32 s41, s30, 13
    s_add_u32 s40, s40, s41
    s_lshl_b32 s41, s36, 8
    s_add_u32 s40, s40, s41
    s_lshl_b32 s42, s30, 11
    s_lshl_b32 s43, s34, 2
    s_lshr_b32 s41, s30, 1
    s_add_u32 s43, s43, s41
    s_lshl_b32 s43, s43, 18
    s_lshl_b32 s41, s37, 16
    s_add_u32 s43, s43, s41
    s_lshl_b32 s41, s31, 11
    s_add_u32 s43, s43, s41
    v_and_b32 v8, 15, v1
    v_lshrrev_b32 v9, 2, v8
    v_and_b32 v10, 3, v8
    v_lshrrev_b32 v8, 5, v1
    v_lshlrev_b32 v8, 2, v8
    v_add_u32 v8, v8, v9
    v_lshlrev_b32 v8, 8, v8
    v_lshrrev_b32 v11, 4, v1
    v_and_b32 v11, 1, v11
    v_lshlrev_b32 v11, 5, v11
    v_add_u32 v8, v8, v11
    v_lshlrev_b32 v10, 3, v10
    v_add_u32 v8, v8, v10
    s_lshl_b32 s44, s33, 13
    v_add_u32 v8, s44, v8
    s_lshl_b32 s45, s31, 13
    s_lshl_b32 s44, s33, 11
    s_add_u32 s44, s44, s45
    s_add_u32 s44, s44, 16384
    v_add_u32 v6, s44, v2
    s_lshl_b32 s44, s32, 1
    s_add_u32 s44, s44, 0
    v_xor_b32 v10, s44, v9
    v_lshlrev_b32 v10, 6, v10
    v_add_u32 v10, v8, v10
    v_add_u32 v16, 0, v10
    v_add_u32 v17, 32768, v10
    v_add_u32 v18, 65536, v10
    v_add_u32 v19, 98304, v10
    v_add_u32 v20, 131072, v10
    s_lshl_b32 s44, s32, 1
    s_add_u32 s44, s44, 1
    v_xor_b32 v10, s44, v9
    v_lshlrev_b32 v10, 6, v10
    v_add_u32 v10, v8, v10
    v_add_u32 v21, 0, v10
    v_add_u32 v22, 32768, v10
    v_add_u32 v23, 65536, v10
    v_add_u32 v24, 98304, v10
    v_add_u32 v25, 131072, v10
    v_add_u32 v26, 0, v6
    v_add_u32 v27, 32768, v6
    v_add_u32 v28, 65536, v6
    v_add_u32 v29, 98304, v6
    v_add_u32 v30, 131072, v6
    s_add_u32 m0, s42, 0
    s_add_u32 s46, s40, 0
    buffer_load_dwordx4 v3, s[16:19], s46 offen lds
    s_add_u32 m0, s42, 1024
    s_add_u32 s46, s40, 4096
    buffer_load_dwordx4 v3, s[16:19], s46 offen lds
    s_add_u32 m0, s42, 16384
    s_add_u32 s47, s43, 0
    buffer_load_dwordx4 v2, s[12:15], s47 offen offset:0 lds
    buffer_load_dwordx4 v2, s[12:15], s47 offen offset:1024 lds
    s_add_u32 m0, s42, 32768
    s_add_u32 s46, s40, 65536
    buffer_load_dwordx4 v3, s[16:19], s46 offen lds
    s_add_u32 m0, s42, 33792
    s_add_u32 s46, s40, 69632
    buffer_load_dwordx4 v3, s[16:19], s46 offen lds
    s_add_u32 m0, s42, 49152
    s_add_u32 s47, s43, 4096
    buffer_load_dwordx4 v2, s[12:15], s47 offen offset:0 lds
    buffer_load_dwordx4 v2, s[12:15], s47 offen offset:1024 lds
    s_add_u32 m0, s42, 65536
    s_add_u32 s46, s40, 131072
    buffer_load_dwordx4 v3, s[16:19], s46 offen lds
    s_add_u32 m0, s42, 66560
    s_add_u32 s46, s40, 135168
    buffer_load_dwordx4 v3, s[16:19], s46 offen lds
    s_add_u32 m0, s42, 81920
    s_add_u32 s47, s43, 8192
    buffer_load_dwordx4 v2, s[12:15], s47 offen offset:0 lds
    buffer_load_dwordx4 v2, s[12:15], s47 offen offset:1024 lds
    s_add_u32 m0, s42, 98304
    s_add_u32 s46, s40, 196608
    buffer_load_dwordx4 v3, s[16:19], s46 offen lds
    s_add_u32 m0, s42, 99328
    s_add_u32 s46, s40, 200704
    buffer_load_dwordx4 v3, s[16:19], s46 offen lds
    s_add_u32 m0, s42, 114688
    s_add_u32 s47, s43, 12288
    buffer_load_dwordx4 v2, s[12:15], s47 offen offset:0 lds
    buffer_load_dwordx4 v2, s[12:15], s47 offen offset:1024 lds
    s_waitcnt vmcnt(12)
    s_barrier
    ds_read_b64_tr_b16 v[160:161], v16 offset:0
    ds_read_b64_tr_b16 v[162:163], v16 offset:2048
    ds_read_b64_tr_b16 v[164:165], v21 offset:0
    ds_read_b64_tr_b16 v[166:167], v21 offset:2048
    ds_read_b128 v[128:131], v26 offset:0
    ds_read_b128 v[132:135], v26 offset:4096
    ds_read_b64_tr_b16 v[168:169], v16 offset:4096
    ds_read_b64_tr_b16 v[170:171], v16 offset:6144
    ds_read_b64_tr_b16 v[172:173], v21 offset:4096
    ds_read_b64_tr_b16 v[174:175], v21 offset:6144
    ds_read_b128 v[136:139], v26 offset:1024
    ds_read_b128 v[140:143], v26 offset:5120
    s_waitcnt lgkmcnt(6)
    v_mfma_f32_32x32x16_bf16 v[64:79], v[160:163], v[128:131], 0
    v_mfma_f32_32x32x16_bf16 v[80:95], v[160:163], v[132:135], 0
    s_add_u32 m0, s42, 131072
    s_add_u32 s46, s40, 262144
    buffer_load_dwordx4 v3, s[16:19], s46 offen lds
    v_mfma_f32_32x32x16_bf16 v[96:111], v[164:167], v[128:131], 0
    v_mfma_f32_32x32x16_bf16 v[112:127], v[164:167], v[132:135], 0
    s_add_u32 m0, s42, 132096
    s_add_u32 s46, s40, 266240
    buffer_load_dwordx4 v3, s[16:19], s46 offen lds
    s_waitcnt lgkmcnt(0)
    v_mfma_f32_32x32x16_bf16 v[64:79], v[168:171], v[136:139], v[64:79]
    v_mfma_f32_32x32x16_bf16 v[80:95], v[168:171], v[140:143], v[80:95]
    s_add_u32 m0, s42, 147456
    s_add_u32 s47, s43, 16384
    buffer_load_dwordx4 v2, s[12:15], s47 offen offset:0 lds
    v_mfma_f32_32x32x16_bf16 v[96:111], v[172:175], v[136:139], v[96:111]
    v_mfma_f32_32x32x16_bf16 v[112:127], v[172:175], v[140:143], v[112:127]
    buffer_load_dwordx4 v2, s[12:15], s47 offen offset:1024 lds
    s_waitcnt vmcnt(12)
    s_barrier
    ds_read_b64_tr_b16 v[160:161], v17 offset:0
    ds_read_b64_tr_b16 v[162:163], v17 offset:2048
    ds_read_b64_tr_b16 v[164:165], v22 offset:0
    ds_read_b64_tr_b16 v[166:167], v22 offset:2048
    ds_read_b128 v[128:131], v27 offset:0
    ds_read_b128 v[132:135], v27 offset:4096
    ds_read_b64_tr_b16 v[168:169], v17 offset:4096
    ds_read_b64_tr_b16 v[170:171], v17 offset:6144
    ds_read_b64_tr_b16 v[172:173], v22 offset:4096
    ds_read_b64_tr_b16 v[174:175], v22 offset:6144
    ds_read_b128 v[136:139], v27 offset:1024
    ds_read_b128 v[140:143], v27 offset:5120
    s_waitcnt lgkmcnt(6)
    v_mfma_f32_32x32x16_bf16 v[64:79], v[160:163], v[128:131], v[64:79]
    v_mfma_f32_32x32x16_bf16 v[80:95], v[160:163], v[132:135], v[80:95]
    s_add_u32 m0, s42, 0
    s_add_u32 s46, s40, 327680
    buffer_load_dwordx4 v3, s[16:19], s46 offen lds
    v_mfma_f32_32x32x16_bf16 v[96:111], v[164:167], v[128:131], v[96:111]
    v_mfma_f32_32x32x16_bf16 v[112:127], v[164:167], v[132:135], v[112:127]
    s_add_u32 m0, s42, 1024
    s_add_u32 s46, s40, 331776
    buffer_load_dwordx4 v3, s[16:19], s46 offen lds
    s_waitcnt lgkmcnt(0)
    v_mfma_f32_32x32x16_bf16 v[64:79], v[168:171], v[136:139], v[64:79]
    v_mfma_f32_32x32x16_bf16 v[80:95], v[168:171], v[140:143], v[80:95]
    s_add_u32 m0, s42, 16384
    s_add_u32 s47, s43, 20480
    buffer_load_dwordx4 v2, s[12:15], s47 offen offset:0 lds
    v_mfma_f32_32x32x16_bf16 v[96:111], v[172:175], v[136:139], v[96:111]
    v_mfma_f32_32x32x16_bf16 v[112:127], v[172:175], v[140:143], v[112:127]
    buffer_load_dwordx4 v2, s[12:15], s47 offen offset:1024 lds
    s_waitcnt vmcnt(12)
    s_barrier
    ds_read_b64_tr_b16 v[160:161], v18 offset:0
    ds_read_b64_tr_b16 v[162:163], v18 offset:2048
    ds_read_b64_tr_b16 v[164:165], v23 offset:0
    ds_read_b64_tr_b16 v[166:167], v23 offset:2048
    ds_read_b128 v[128:131], v28 offset:0
    ds_read_b128 v[132:135], v28 offset:4096
    ds_read_b64_tr_b16 v[168:169], v18 offset:4096
    ds_read_b64_tr_b16 v[170:171], v18 offset:6144
    ds_read_b64_tr_b16 v[172:173], v23 offset:4096
    ds_read_b64_tr_b16 v[174:175], v23 offset:6144
    ds_read_b128 v[136:139], v28 offset:1024
    ds_read_b128 v[140:143], v28 offset:5120
    s_waitcnt lgkmcnt(6)
    v_mfma_f32_32x32x16_bf16 v[64:79], v[160:163], v[128:131], v[64:79]
    v_mfma_f32_32x32x16_bf16 v[80:95], v[160:163], v[132:135], v[80:95]
    s_add_u32 m0, s42, 32768
    s_add_u32 s46, s40, 393216
    buffer_load_dwordx4 v3, s[16:19], s46 offen lds
    v_mfma_f32_32x32x16_bf16 v[96:111], v[164:167], v[128:131], v[96:111]
    v_mfma_f32_32x32x16_bf16 v[112:127], v[164:167], v[132:135], v[112:127]
    s_add_u32 m0, s42, 33792
    s_add_u32 s46, s40, 397312
    buffer_load_dwordx4 v3, s[16:19], s46 offen lds
    s_waitcnt lgkmcnt(0)
    v_mfma_f32_32x32x16_bf16 v[64:79], v[168:171], v[136:139], v[64:79]
    v_mfma_f32_32x32x16_bf16 v[80:95], v[168:171], v[140:143], v[80:95]
    s_add_u32 m0, s42, 49152
    s_add_u32 s47, s43, 24576
    buffer_load_dwordx4 v2, s[12:15], s47 offen offset:0 lds
    v_mfma_f32_32x32x16_bf16 v[96:111], v[172:175], v[136:139], v[96:111]
    v_mfma_f32_32x32x16_bf16 v[112:127], v[172:175], v[140:143], v[112:127]
    buffer_load_dwordx4 v2, s[12:15], s47 offen offset:1024 lds
    s_waitcnt vmcnt(12)
    s_barrier
    ds_read_b64_tr_b16 v[160:161], v19 offset:0
    ds_read_b64_tr_b16 v[162:163], v19 offset:2048
    ds_read_b64_tr_b16 v[164:165], v24 offset:0
    ds_read_b64_tr_b16 v[166:167], v24 offset:2048
    ds_read_b128 v[128:131], v29 offset:0
    ds_read_b128 v[132:135], v29 offset:4096
    ds_read_b64_tr_b16 v[168:169], v19 offset:4096
    ds_read_b64_tr_b16 v[170:171], v19 offset:6144
    ds_read_b64_tr_b16 v[172:173], v24 offset:4096
    ds_read_b64_tr_b16 v[174:175], v24 offset:6144
    ds_read_b128 v[136:139], v29 offset:1024
    ds_read_b128 v[140:143], v29 offset:5120
    s_waitcnt lgkmcnt(6)
    v_mfma_f32_32x32x16_bf16 v[64:79], v[160:163], v[128:131], v[64:79]
    v_mfma_f32_32x32x16_bf16 v[80:95], v[160:163], v[132:135], v[80:95]
    s_add_u32 m0, s42, 65536
    s_add_u32 s46, s40, 458752
    buffer_load_dwordx4 v3, s[16:19], s46 offen lds
    v_mfma_f32_32x32x16_bf16 v[96:111], v[164:167], v[128:131], v[96:111]
    v_mfma_f32_32x32x16_bf16 v[112:127], v[164:167], v[132:135], v[112:127]
    s_add_u32 m0, s42, 66560
    s_add_u32 s46, s40, 462848
    buffer_load_dwordx4 v3, s[16:19], s46 offen lds
    s_waitcnt lgkmcnt(0)
    v_mfma_f32_32x32x16_bf16 v[64:79], v[168:171], v[136:139], v[64:79]
    v_mfma_f32_32x32x16_bf16 v[80:95], v[168:171], v[140:143], v[80:95]
    s_add_u32 m0, s42, 81920
    s_add_u32 s47, s43, 28672
    buffer_load_dwordx4 v2, s[12:15], s47 offen offset:0 lds
    v_mfma_f32_32x32x16_bf16 v[96:111], v[172:175], v[136:139], v[96:111]
    v_mfma_f32_32x32x16_bf16 v[112:127], v[172:175], v[140:143], v[112:127]
    buffer_load_dwordx4 v2, s[12:15], s47 offen offset:1024 lds
    s_waitcnt vmcnt(12)
    s_barrier
    ds_read_b64_tr_b16 v[160:161], v20 offset:0
    ds_read_b64_tr_b16 v[162:163], v20 offset:2048
    ds_read_b64_tr_b16 v[164:165], v25 offset:0
    ds_read_b64_tr_b16 v[166:167], v25 offset:2048
    ds_read_b128 v[128:131], v30 offset:0
    ds_read_b128 v[132:135], v30 offset:4096
    ds_read_b64_tr_b16 v[168:169], v20 offset:4096
    ds_read_b64_tr_b16 v[170:171], v20 offset:6144
    ds_read_b64_tr_b16 v[172:173], v25 offset:4096
    ds_read_b64_tr_b16 v[174:175], v25 offset:6144
    ds_read_b128 v[136:139], v30 offset:1024
    ds_read_b128 v[140:143], v30 offset:5120
    s_waitcnt lgkmcnt(6)
    v_mfma_f32_32x32x16_bf16 v[64:79], v[160:163], v[128:131], v[64:79]
    v_mfma_f32_32x32x16_bf16 v[80:95], v[160:163], v[132:135], v[80:95]
    s_add_u32 m0, s42, 98304
    s_add_u32 s46, s40, 524288
    buffer_load_dwordx4 v3, s[16:19], s46 offen lds
    v_mfma_f32_32x32x16_bf16 v[96:111], v[164:167], v[128:131], v[96:111]
    v_mfma_f32_32x32x16_bf16 v[112:127], v[164:167], v[132:135], v[112:127]
    s_add_u32 m0, s42, 99328
    s_add_u32 s46, s40, 528384
    buffer_load_dwordx4 v3, s[16:19], s46 offen lds
    s_waitcnt lgkmcnt(0)
    v_mfma_f32_32x32x16_bf16 v[64:79], v[168:171], v[136:139], v[64:79]
    v_mfma_f32_32x32x16_bf16 v[80:95], v[168:171], v[140:143], v[80:95]
    s_add_u32 m0, s42, 114688
    s_add_u32 s47, s43, 32768
    buffer_load_dwordx4 v2, s[12:15], s47 offen offset:0 lds
    v_mfma_f32_32x32x16_bf16 v[96:111], v[172:175], v[136:139], v[96:111]
    v_mfma_f32_32x32x16_bf16 v[112:127], v[172:175], v[140:143], v[112:127]
    buffer_load_dwordx4 v2, s[12:15], s47 offen offset:1024 lds
    s_waitcnt vmcnt(12)
    s_barrier
    ds_read_b64_tr_b16 v[160:161], v16 offset:0
    ds_read_b64_tr_b16 v[162:163], v16 offset:2048
    ds_read_b64_tr_b16 v[164:165], v21 offset:0
    ds_read_b64_tr_b16 v[166:167], v21 offset:2048
    ds_read_b128 v[128:131], v26 offset:0
    ds_read_b128 v[132:135], v26 offset:4096
    ds_read_b64_tr_b16 v[168:169], v16 offset:4096
    ds_read_b64_tr_b16 v[170:171], v16 offset:6144
    ds_read_b64_tr_b16 v[172:173], v21 offset:4096
    ds_read_b64_tr_b16 v[174:175], v21 offset:6144
    ds_read_b128 v[136:139], v26 offset:1024
    ds_read_b128 v[140:143], v26 offset:5120
    s_waitcnt lgkmcnt(6)
    v_mfma_f32_32x32x16_bf16 v[64:79], v[160:163], v[128:131], v[64:79]
    v_mfma_f32_32x32x16_bf16 v[80:95], v[160:163], v[132:135], v[80:95]
    s_add_u32 m0, s42, 131072
    s_add_u32 s46, s40, 589824
    buffer_load_dwordx4 v3, s[16:19], s46 offen lds
    v_mfma_f32_32x32x16_bf16 v[96:111], v[164:167], v[128:131], v[96:111]
    v_mfma_f32_32x32x16_bf16 v[112:127], v[164:167], v[132:135], v[112:127]
    s_add_u32 m0, s42, 132096
    s_add_u32 s46, s40, 593920
    buffer_load_dwordx4 v3, s[16:19], s46 offen lds
    s_waitcnt lgkmcnt(0)
    v_mfma_f32_32x32x16_bf16 v[64:79], v[168:171], v[136:139], v[64:79]
    v_mfma_f32_32x32x16_bf16 v[80:95], v[168:171], v[140:143], v[80:95]
    s_add_u32 m0, s42, 147456
    s_add_u32 s47, s43, 36864
    buffer_load_dwordx4 v2, s[12:15], s47 offen offset:0 lds
    v_mfma_f32_32x32x16_bf16 v[96:111], v[172:175], v[136:139], v[96:111]
    v_mfma_f32_32x32x16_bf16 v[112:127], v[172:175], v[140:143], v[112:127]
    buffer_load_dwordx4 v2, s[12:15], s47 offen offset:1024 lds
    s_waitcnt vmcnt(12)
    s_barrier
    ds_read_b64_tr_b16 v[160:161], v17 offset:0
    ds_read_b64_tr_b16 v[162:163], v17 offset:2048
    ds_read_b64_tr_b16 v[164:165], v22 offset:0
    ds_read_b64_tr_b16 v[166:167], v22 offset:2048
    ds_read_b128 v[128:131], v27 offset:0
    ds_read_b128 v[132:135], v27 offset:4096
    ds_read_b64_tr_b16 v[168:169], v17 offset:4096
    ds_read_b64_tr_b16 v[170:171], v17 offset:6144
    ds_read_b64_tr_b16 v[172:173], v22 offset:4096
    ds_read_b64_tr_b16 v[174:175], v22 offset:6144
    ds_read_b128 v[136:139], v27 offset:1024
    ds_read_b128 v[140:143], v27 offset:5120
    s_waitcnt lgkmcnt(6)
    v_mfma_f32_32x32x16_bf16 v[64:79], v[160:163], v[128:131], v[64:79]
    v_mfma_f32_32x32x16_bf16 v[80:95], v[160:163], v[132:135], v[80:95]
    s_add_u32 m0, s42, 0
    s_add_u32 s46, s40, 655360
    buffer_load_dwordx4 v3, s[16:19], s46 offen lds
    v_mfma_f32_32x32x16_bf16 v[96:111], v[164:167], v[128:131], v[96:111]
    v_mfma_f32_32x32x16_bf16 v[112:127], v[164:167], v[132:135], v[112:127]
    s_add_u32 m0, s42, 1024
    s_add_u32 s46, s40, 659456
    buffer_load_dwordx4 v3, s[16:19], s46 offen lds
    s_waitcnt lgkmcnt(0)
    v_mfma_f32_32x32x16_bf16 v[64:79], v[168:171], v[136:139], v[64:79]
    v_mfma_f32_32x32x16_bf16 v[80:95], v[168:171], v[140:143], v[80:95]
    s_add_u32 m0, s42, 16384
    s_add_u32 s47, s43, 40960
    buffer_load_dwordx4 v2, s[12:15], s47 offen offset:0 lds
    v_mfma_f32_32x32x16_bf16 v[96:111], v[172:175], v[136:139], v[96:111]
    v_mfma_f32_32x32x16_bf16 v[112:127], v[172:175], v[140:143], v[112:127]
    buffer_load_dwordx4 v2, s[12:15], s47 offen offset:1024 lds
    s_waitcnt vmcnt(12)
    s_barrier
    ds_read_b64_tr_b16 v[160:161], v18 offset:0
    ds_read_b64_tr_b16 v[162:163], v18 offset:2048
    ds_read_b64_tr_b16 v[164:165], v23 offset:0
    ds_read_b64_tr_b16 v[166:167], v23 offset:2048
    ds_read_b128 v[128:131], v28 offset:0
    ds_read_b128 v[132:135], v28 offset:4096
    ds_read_b64_tr_b16 v[168:169], v18 offset:4096
    ds_read_b64_tr_b16 v[170:171], v18 offset:6144
    ds_read_b64_tr_b16 v[172:173], v23 offset:4096
    ds_read_b64_tr_b16 v[174:175], v23 offset:6144
    ds_read_b128 v[136:139], v28 offset:1024
    ds_read_b128 v[140:143], v28 offset:5120
    s_waitcnt lgkmcnt(6)
    v_mfma_f32_32x32x16_bf16 v[64:79], v[160:163], v[128:131], v[64:79]
    v_mfma_f32_32x32x16_bf16 v[80:95], v[160:163], v[132:135], v[80:95]
    s_add_u32 m0, s42, 32768
    s_add_u32 s46, s40, 720896
    buffer_load_dwordx4 v3, s[16:19], s46 offen lds
    v_mfma_f32_32x32x16_bf16 v[96:111], v[164:167], v[128:131], v[96:111]
    v_mfma_f32_32x32x16_bf16 v[112:127], v[164:167], v[132:135], v[112:127]
    s_add_u32 m0, s42, 33792
    s_add_u32 s46, s40, 724992
    buffer_load_dwordx4 v3, s[16:19], s46 offen lds
    s_waitcnt lgkmcnt(0)
    v_mfma_f32_32x32x16_bf16 v[64:79], v[168:171], v[136:139], v[64:79]
    v_mfma_f32_32x32x16_bf16 v[80:95], v[168:171], v[140:143], v[80:95]
    s_add_u32 m0, s42, 49152
    s_add_u32 s47, s43, 45056
    buffer_load_dwordx4 v2, s[12:15], s47 offen offset:0 lds
    v_mfma_f32_32x32x16_bf16 v[96:111], v[172:175], v[136:139], v[96:111]
    v_mfma_f32_32x32x16_bf16 v[112:127], v[172:175], v[140:143], v[112:127]
    buffer_load_dwordx4 v2, s[12:15], s47 offen offset:1024 lds
    s_waitcnt vmcnt(12)
    s_barrier
    ds_read_b64_tr_b16 v[160:161], v19 offset:0
    ds_read_b64_tr_b16 v[162:163], v19 offset:2048
    ds_read_b64_tr_b16 v[164:165], v24 offset:0
    ds_read_b64_tr_b16 v[166:167], v24 offset:2048
    ds_read_b128 v[128:131], v29 offset:0
    ds_read_b128 v[132:135], v29 offset:4096
    ds_read_b64_tr_b16 v[168:169], v19 offset:4096
    ds_read_b64_tr_b16 v[170:171], v19 offset:6144
    ds_read_b64_tr_b16 v[172:173], v24 offset:4096
    ds_read_b64_tr_b16 v[174:175], v24 offset:6144
    ds_read_b128 v[136:139], v29 offset:1024
    ds_read_b128 v[140:143], v29 offset:5120
    s_waitcnt lgkmcnt(6)
    v_mfma_f32_32x32x16_bf16 v[64:79], v[160:163], v[128:131], v[64:79]
    v_mfma_f32_32x32x16_bf16 v[80:95], v[160:163], v[132:135], v[80:95]
    s_add_u32 m0, s42, 65536
    s_add_u32 s46, s40, 786432
    buffer_load_dwordx4 v3, s[16:19], s46 offen lds
    v_mfma_f32_32x32x16_bf16 v[96:111], v[164:167], v[128:131], v[96:111]
    v_mfma_f32_32x32x16_bf16 v[112:127], v[164:167], v[132:135], v[112:127]
    s_add_u32 m0, s42, 66560
    s_add_u32 s46, s40, 790528
    buffer_load_dwordx4 v3, s[16:19], s46 offen lds
    s_waitcnt lgkmcnt(0)
    v_mfma_f32_32x32x16_bf16 v[64:79], v[168:171], v[136:139], v[64:79]
    v_mfma_f32_32x32x16_bf16 v[80:95], v[168:171], v[140:143], v[80:95]
    s_add_u32 m0, s42, 81920
    s_add_u32 s47, s43, 49152
    buffer_load_dwordx4 v2, s[12:15], s47 offen offset:0 lds
    v_mfma_f32_32x32x16_bf16 v[96:111], v[172:175], v[136:139], v[96:111]
    v_mfma_f32_32x32x16_bf16 v[112:127], v[172:175], v[140:143], v[112:127]
    buffer_load_dwordx4 v2, s[12:15], s47 offen offset:1024 lds
    s_waitcnt vmcnt(12)
    s_barrier
    ds_read_b64_tr_b16 v[160:161], v20 offset:0
    ds_read_b64_tr_b16 v[162:163], v20 offset:2048
    ds_read_b64_tr_b16 v[164:165], v25 offset:0
    ds_read_b64_tr_b16 v[166:167], v25 offset:2048
    ds_read_b128 v[128:131], v30 offset:0
    ds_read_b128 v[132:135], v30 offset:4096
    ds_read_b64_tr_b16 v[168:169], v20 offset:4096
    ds_read_b64_tr_b16 v[170:171], v20 offset:6144
    ds_read_b64_tr_b16 v[172:173], v25 offset:4096
    ds_read_b64_tr_b16 v[174:175], v25 offset:6144
    ds_read_b128 v[136:139], v30 offset:1024
    ds_read_b128 v[140:143], v30 offset:5120
    s_waitcnt lgkmcnt(6)
    v_mfma_f32_32x32x16_bf16 v[64:79], v[160:163], v[128:131], v[64:79]
    v_mfma_f32_32x32x16_bf16 v[80:95], v[160:163], v[132:135], v[80:95]
    s_add_u32 m0, s42, 98304
    s_add_u32 s46, s40, 851968
    buffer_load_dwordx4 v3, s[16:19], s46 offen lds
    v_mfma_f32_32x32x16_bf16 v[96:111], v[164:167], v[128:131], v[96:111]
    v_mfma_f32_32x32x16_bf16 v[112:127], v[164:167], v[132:135], v[112:127]
    s_add_u32 m0, s42, 99328
    s_add_u32 s46, s40, 856064
    buffer_load_dwordx4 v3, s[16:19], s46 offen lds
    s_waitcnt lgkmcnt(0)
    v_mfma_f32_32x32x16_bf16 v[64:79], v[168:171], v[136:139], v[64:79]
    v_mfma_f32_32x32x16_bf16 v[80:95], v[168:171], v[140:143], v[80:95]
    s_add_u32 m0, s42, 114688
    s_add_u32 s47, s43, 53248
    buffer_load_dwordx4 v2, s[12:15], s47 offen offset:0 lds
    v_mfma_f32_32x32x16_bf16 v[96:111], v[172:175], v[136:139], v[96:111]
    v_mfma_f32_32x32x16_bf16 v[112:127], v[172:175], v[140:143], v[112:127]
    buffer_load_dwordx4 v2, s[12:15], s47 offen offset:1024 lds
    s_waitcnt vmcnt(12)
    s_barrier
    ds_read_b64_tr_b16 v[160:161], v16 offset:0
    ds_read_b64_tr_b16 v[162:163], v16 offset:2048
    ds_read_b64_tr_b16 v[164:165], v21 offset:0
    ds_read_b64_tr_b16 v[166:167], v21 offset:2048
    ds_read_b128 v[128:131], v26 offset:0
    ds_read_b128 v[132:135], v26 offset:4096
    ds_read_b64_tr_b16 v[168:169], v16 offset:4096
    ds_read_b64_tr_b16 v[170:171], v16 offset:6144
    ds_read_b64_tr_b16 v[172:173], v21 offset:4096
    ds_read_b64_tr_b16 v[174:175], v21 offset:6144
    ds_read_b128 v[136:139], v26 offset:1024
    ds_read_b128 v[140:143], v26 offset:5120
    s_waitcnt lgkmcnt(6)
    v_mfma_f32_32x32x16_bf16 v[64:79], v[160:163], v[128:131], v[64:79]
    v_mfma_f32_32x32x16_bf16 v[80:95], v[160:163], v[132:135], v[80:95]
    s_add_u32 m0, s42, 131072
    s_add_u32 s46, s40, 917504
    buffer_load_dwordx4 v3, s[16:19], s46 offen lds
    v_mfma_f32_32x32x16_bf16 v[96:111], v[164:167], v[128:131], v[96:111]
    v_mfma_f32_32x32x16_bf16 v[112:127], v[164:167], v[132:135], v[112:127]
    s_add_u32 m0, s42, 132096
    s_add_u32 s46, s40, 921600
    buffer_load_dwordx4 v3, s[16:19], s46 offen lds
    s_waitcnt lgkmcnt(0)
    v_mfma_f32_32x32x16_bf16 v[64:79], v[168:171], v[136:139], v[64:79]
    v_mfma_f32_32x32x16_bf16 v[80:95], v[168:171], v[140:143], v[80:95]
    s_add_u32 m0, s42, 147456
    s_add_u32 s47, s43, 57344
    buffer_load_dwordx4 v2, s[12:15], s47 offen offset:0 lds
    v_mfma_f32_32x32x16_bf16 v[96:111], v[172:175], v[136:139], v[96:111]
    v_mfma_f32_32x32x16_bf16 v[112:127], v[172:175], v[140:143], v[112:127]
    buffer_load_dwordx4 v2, s[12:15], s47 offen offset:1024 lds
    s_waitcnt vmcnt(12)
    s_barrier
    ds_read_b64_tr_b16 v[160:161], v17 offset:0
    ds_read_b64_tr_b16 v[162:163], v17 offset:2048
    ds_read_b64_tr_b16 v[164:165], v22 offset:0
    ds_read_b64_tr_b16 v[166:167], v22 offset:2048
    ds_read_b128 v[128:131], v27 offset:0
    ds_read_b128 v[132:135], v27 offset:4096
    ds_read_b64_tr_b16 v[168:169], v17 offset:4096
    ds_read_b64_tr_b16 v[170:171], v17 offset:6144
    ds_read_b64_tr_b16 v[172:173], v22 offset:4096
    ds_read_b64_tr_b16 v[174:175], v22 offset:6144
    ds_read_b128 v[136:139], v27 offset:1024
    ds_read_b128 v[140:143], v27 offset:5120
    s_waitcnt lgkmcnt(6)
    v_mfma_f32_32x32x16_bf16 v[64:79], v[160:163], v[128:131], v[64:79]
    v_mfma_f32_32x32x16_bf16 v[80:95], v[160:163], v[132:135], v[80:95]
    s_add_u32 m0, s42, 0
    s_add_u32 s46, s40, 983040
    buffer_load_dwordx4 v3, s[16:19], s46 offen lds
    v_mfma_f32_32x32x16_bf16 v[96:111], v[164:167], v[128:131], v[96:111]
    v_mfma_f32_32x32x16_bf16 v[112:127], v[164:167], v[132:135], v[112:127]
    s_add_u32 m0, s42, 1024
    s_add_u32 s46, s40, 987136
    buffer_load_dwordx4 v3, s[16:19], s46 offen lds
    s_waitcnt lgkmcnt(0)
    v_mfma_f32_32x32x16_bf16 v[64:79], v[168:171], v[136:139], v[64:79]
    v_mfma_f32_32x32x16_bf16 v[80:95], v[168:171], v[140:143], v[80:95]
    s_add_u32 m0, s42, 16384
    s_add_u32 s47, s43, 61440
    buffer_load_dwordx4 v2, s[12:15], s47 offen offset:0 lds
    v_mfma_f32_32x32x16_bf16 v[96:111], v[172:175], v[136:139], v[96:111]
    v_mfma_f32_32x32x16_bf16 v[112:127], v[172:175], v[140:143], v[112:127]
    buffer_load_dwordx4 v2, s[12:15], s47 offen offset:1024 lds
    s_waitcnt vmcnt(12)
    s_barrier
    ds_read_b64_tr_b16 v[160:161], v18 offset:0
    ds_read_b64_tr_b16 v[162:163], v18 offset:2048
    ds_read_b64_tr_b16 v[164:165], v23 offset:0
    ds_read_b64_tr_b16 v[166:167], v23 offset:2048
    ds_read_b128 v[128:131], v28 offset:0
    ds_read_b128 v[132:135], v28 offset:4096
    ds_read_b64_tr_b16 v[168:169], v18 offset:4096
    ds_read_b64_tr_b16 v[170:171], v18 offset:6144
    ds_read_b64_tr_b16 v[172:173], v23 offset:4096
    ds_read_b64_tr_b16 v[174:175], v23 offset:6144
    ds_read_b128 v[136:139], v28 offset:1024
    ds_read_b128 v[140:143], v28 offset:5120
    s_waitcnt lgkmcnt(6)
    v_mfma_f32_32x32x16_bf16 v[64:79], v[160:163], v[128:131], v[64:79]
    v_mfma_f32_32x32x16_bf16 v[80:95], v[160:163], v[132:135], v[80:95]
    v_mfma_f32_32x32x16_bf16 v[96:111], v[164:167], v[128:131], v[96:111]
    v_mfma_f32_32x32x16_bf16 v[112:127], v[164:167], v[132:135], v[112:127]
    s_waitcnt lgkmcnt(0)
    v_mfma_f32_32x32x16_bf16 v[64:79], v[168:171], v[136:139], v[64:79]
    v_mfma_f32_32x32x16_bf16 v[80:95], v[168:171], v[140:143], v[80:95]
    v_mfma_f32_32x32x16_bf16 v[96:111], v[172:175], v[136:139], v[96:111]
    v_mfma_f32_32x32x16_bf16 v[112:127], v[172:175], v[140:143], v[112:127]
    s_waitcnt vmcnt(8)
    s_barrier
    ds_read_b64_tr_b16 v[160:161], v19 offset:0
    ds_read_b64_tr_b16 v[162:163], v19 offset:2048
    ds_read_b64_tr_b16 v[164:165], v24 offset:0
    ds_read_b64_tr_b16 v[166:167], v24 offset:2048
    ds_read_b128 v[128:131], v29 offset:0
    ds_read_b128 v[132:135], v29 offset:4096
    ds_read_b64_tr_b16 v[168:169], v19 offset:4096
    ds_read_b64_tr_b16 v[170:171], v19 offset:6144
    ds_read_b64_tr_b16 v[172:173], v24 offset:4096
    ds_read_b64_tr_b16 v[174:175], v24 offset:6144
    ds_read_b128 v[136:139], v29 offset:1024
    ds_read_b128 v[140:143], v29 offset:5120
    s_waitcnt lgkmcnt(6)
    v_mfma_f32_32x32x16_bf16 v[64:79], v[160:163], v[128:131], v[64:79]
    v_mfma_f32_32x32x16_bf16 v[80:95], v[160:163], v[132:135], v[80:95]
    v_mfma_f32_32x32x16_bf16 v[96:111], v[164:167], v[128:131], v[96:111]
    v_mfma_f32_32x32x16_bf16 v[112:127], v[164:167], v[132:135], v[112:127]
    s_waitcnt lgkmcnt(0)
    v_mfma_f32_32x32x16_bf16 v[64:79], v[168:171], v[136:139], v[64:79]
    v_mfma_f32_32x32x16_bf16 v[80:95], v[168:171], v[140:143], v[80:95]
    v_mfma_f32_32x32x16_bf16 v[96:111], v[172:175], v[136:139], v[96:111]
    v_mfma_f32_32x32x16_bf16 v[112:127], v[172:175], v[140:143], v[112:127]
    s_waitcnt vmcnt(4)
    s_barrier
    ds_read_b64_tr_b16 v[160:161], v20 offset:0
    ds_read_b64_tr_b16 v[162:163], v20 offset:2048
    ds_read_b64_tr_b16 v[164:165], v25 offset:0
    ds_read_b64_tr_b16 v[166:167], v25 offset:2048
    ds_read_b128 v[128:131], v30 offset:0
    ds_read_b128 v[132:135], v30 offset:4096
    ds_read_b64_tr_b16 v[168:169], v20 offset:4096
    ds_read_b64_tr_b16 v[170:171], v20 offset:6144
    ds_read_b64_tr_b16 v[172:173], v25 offset:4096
    ds_read_b64_tr_b16 v[174:175], v25 offset:6144
    ds_read_b128 v[136:139], v30 offset:1024
    ds_read_b128 v[140:143], v30 offset:5120
    s_waitcnt lgkmcnt(6)
    v_mfma_f32_32x32x16_bf16 v[64:79], v[160:163], v[128:131], v[64:79]
    v_mfma_f32_32x32x16_bf16 v[80:95], v[160:163], v[132:135], v[80:95]
    v_mfma_f32_32x32x16_bf16 v[96:111], v[164:167], v[128:131], v[96:111]
    v_mfma_f32_32x32x16_bf16 v[112:127], v[164:167], v[132:135], v[112:127]
    s_waitcnt lgkmcnt(0)
    v_mfma_f32_32x32x16_bf16 v[64:79], v[168:171], v[136:139], v[64:79]
    v_mfma_f32_32x32x16_bf16 v[80:95], v[168:171], v[140:143], v[80:95]
    v_mfma_f32_32x32x16_bf16 v[96:111], v[172:175], v[136:139], v[96:111]
    v_mfma_f32_32x32x16_bf16 v[112:127], v[172:175], v[140:143], v[112:127]
    s_waitcnt vmcnt(0)
    s_barrier
    ds_read_b64_tr_b16 v[160:161], v16 offset:0
    ds_read_b64_tr_b16 v[162:163], v16 offset:2048
    ds_read_b64_tr_b16 v[164:165], v21 offset:0
    ds_read_b64_tr_b16 v[166:167], v21 offset:2048
    ds_read_b128 v[128:131], v26 offset:0
    ds_read_b128 v[132:135], v26 offset:4096
    ds_read_b64_tr_b16 v[168:169], v16 offset:4096
    ds_read_b64_tr_b16 v[170:171], v16 offset:6144
    ds_read_b64_tr_b16 v[172:173], v21 offset:4096
    ds_read_b64_tr_b16 v[174:175], v21 offset:6144
    ds_read_b128 v[136:139], v26 offset:1024
    ds_read_b128 v[140:143], v26 offset:5120
    s_waitcnt lgkmcnt(6)
    v_mfma_f32_32x32x16_bf16 v[64:79], v[160:163], v[128:131], v[64:79]
    v_mfma_f32_32x32x16_bf16 v[80:95], v[160:163], v[132:135], v[80:95]
    v_mfma_f32_32x32x16_bf16 v[96:111], v[164:167], v[128:131], v[96:111]
    v_mfma_f32_32x32x16_bf16 v[112:127], v[164:167], v[132:135], v[112:127]
    s_waitcnt lgkmcnt(0)
    v_mfma_f32_32x32x16_bf16 v[64:79], v[168:171], v[136:139], v[64:79]
    v_mfma_f32_32x32x16_bf16 v[80:95], v[168:171], v[140:143], v[80:95]
    v_mfma_f32_32x32x16_bf16 v[96:111], v[172:175], v[136:139], v[96:111]
    v_mfma_f32_32x32x16_bf16 v[112:127], v[172:175], v[140:143], v[112:127]
    s_nop 15
    s_barrier
    v_and_b32 v8, 31, v1
    s_lshl_b32 s44, s31, 6
    v_add_u32 v8, s44, v8
    s_mov_b32 s45, 528
    v_mul_lo_u32 v8, v8, s45
    v_lshrrev_b32 v9, 5, v1
    v_lshlrev_b32 v9, 4, v9
    v_add_u32 v8, v8, v9
    s_lshl_b32 s44, s32, 8
    s_mul_i32 s45, s33, 67584
    s_add_u32 s44, s44, s45
    v_add_u32 v8, s44, v8
    ds_write_b128 v8, v[64:67] offset:0
    ds_write_b128 v8, v[68:71] offset:32
    ds_write_b128 v8, v[72:75] offset:64
    ds_write_b128 v8, v[76:79] offset:96
    ds_write_b128 v8, v[80:83] offset:16896
    ds_write_b128 v8, v[84:87] offset:16928
    ds_write_b128 v8, v[88:91] offset:16960
    ds_write_b128 v8, v[92:95] offset:16992
    ds_write_b128 v8, v[96:99] offset:128
    ds_write_b128 v8, v[100:103] offset:160
    ds_write_b128 v8, v[104:107] offset:192
    ds_write_b128 v8, v[108:111] offset:224
    ds_write_b128 v8, v[112:115] offset:17024
    ds_write_b128 v8, v[116:119] offset:17056
    ds_write_b128 v8, v[120:123] offset:17088
    ds_write_b128 v8, v[124:127] offset:17120
    s_waitcnt lgkmcnt(0)
    s_barrier
    v_lshrrev_b32 v8, 4, v1
    s_lshl_b32 s44, s30, 4
    v_add_u32 v8, s44, v8
    s_mov_b32 s45, 528
    v_mul_lo_u32 v9, v8, s45
    v_and_b32 v10, 15, v1
    v_lshlrev_b32 v11, 5, v10
    v_add_u32 v9, v9, v11
    v_add_u32 v12, 67584, v9
    v_lshlrev_b32 v8, 10, v8
    v_lshlrev_b32 v10, 4, v10
    v_add_u32 v8, v8, v10
    s_lshl_b32 s44, s37, 21
    s_lshl_b32 s45, s34, 17
    s_add_u32 s44, s44, s45
    s_lshl_b32 s45, s36, 8
    s_add_u32 s44, s44, s45
    ds_read_b128 v[64:67], v9 offset:0
    ds_read_b128 v[68:71], v9 offset:16
    ds_read_b128 v[72:75], v12 offset:0
    ds_read_b128 v[76:79], v12 offset:16
    ds_read_b128 v[80:83], v9 offset:2112
    ds_read_b128 v[84:87], v9 offset:2128
    ds_read_b128 v[88:91], v12 offset:2112
    ds_read_b128 v[92:95], v12 offset:2128
    ds_read_b128 v[96:99], v9 offset:4224
    ds_read_b128 v[100:103], v9 offset:4240
    ds_read_b128 v[104:107], v12 offset:4224
    ds_read_b128 v[108:111], v12 offset:4240
    ds_read_b128 v[112:115], v9 offset:6336
    ds_read_b128 v[116:119], v9 offset:6352
    ds_read_b128 v[120:123], v12 offset:6336
    ds_read_b128 v[124:127], v12 offset:6352
    s_waitcnt lgkmcnt(12)
    v_add_f32 v64, v64, v72
    v_add_f32 v65, v65, v73
    v_add_f32 v66, v66, v74
    v_add_f32 v67, v67, v75
    v_add_f32 v68, v68, v76
    v_add_f32 v69, v69, v77
    v_add_f32 v70, v70, v78
    v_add_f32 v71, v71, v79
    v_cvt_pk_bf16_f32 v72, v64, v65
    v_cvt_pk_bf16_f32 v73, v66, v67
    v_cvt_pk_bf16_f32 v74, v68, v69
    v_cvt_pk_bf16_f32 v75, v70, v71
    s_add_u32 s46, s44, 0
    buffer_store_dwordx4 v[72:75], v8, s[20:23], s46 offen sc1
    s_waitcnt lgkmcnt(8)
    v_add_f32 v80, v80, v88
    v_add_f32 v81, v81, v89
    v_add_f32 v82, v82, v90
    v_add_f32 v83, v83, v91
    v_add_f32 v84, v84, v92
    v_add_f32 v85, v85, v93
    v_add_f32 v86, v86, v94
    v_add_f32 v87, v87, v95
    v_cvt_pk_bf16_f32 v88, v80, v81
    v_cvt_pk_bf16_f32 v89, v82, v83
    v_cvt_pk_bf16_f32 v90, v84, v85
    v_cvt_pk_bf16_f32 v91, v86, v87
    s_add_u32 s46, s44, 4096
    buffer_store_dwordx4 v[88:91], v8, s[20:23], s46 offen sc1
    s_waitcnt lgkmcnt(4)
    v_add_f32 v96, v96, v104
    v_add_f32 v97, v97, v105
    v_add_f32 v98, v98, v106
    v_add_f32 v99, v99, v107
    v_add_f32 v100, v100, v108
    v_add_f32 v101, v101, v109
    v_add_f32 v102, v102, v110
    v_add_f32 v103, v103, v111
    v_cvt_pk_bf16_f32 v104, v96, v97
    v_cvt_pk_bf16_f32 v105, v98, v99
    v_cvt_pk_bf16_f32 v106, v100, v101
    v_cvt_pk_bf16_f32 v107, v102, v103
    s_add_u32 s46, s44, 8192
    buffer_store_dwordx4 v[104:107], v8, s[20:23], s46 offen sc1
    s_waitcnt lgkmcnt(0)
    v_add_f32 v112, v112, v120
    v_add_f32 v113, v113, v121
    v_add_f32 v114, v114, v122
    v_add_f32 v115, v115, v123
    v_add_f32 v116, v116, v124
    v_add_f32 v117, v117, v125
    v_add_f32 v118, v118, v126
    v_add_f32 v119, v119, v127
    v_cvt_pk_bf16_f32 v120, v112, v113
    v_cvt_pk_bf16_f32 v121, v114, v115
    v_cvt_pk_bf16_f32 v122, v116, v117
    v_cvt_pk_bf16_f32 v123, v118, v119
    s_add_u32 s46, s44, 12288
    buffer_store_dwordx4 v[120:123], v8, s[20:23], s46 offen sc1
oproj_kernel_end:
    s_endpgm
.globl rgu_kernel
.p2align 8
.type rgu_kernel,@function
rgu_kernel:
    s_cmp_ge_u32 s2, 256
    s_cbranch_scc1 rgu_kernel_end
    s_load_dwordx4 s[4:7], s[0:1], 56
    s_load_dwordx2 s[8:9], s[0:1], 112
    v_and_b32 v1, 63, v0
    v_lshrrev_b32 v5, 6, v0
    s_nop 0
    v_readfirstlane_b32 s30, v5
    s_and_b32 s31, s30, 3
    s_lshr_b32 s32, s30, 2
    s_and_b32 s34, s2, 7
    s_lshr_b32 s33, s2, 3
    s_lshr_b32 s35, s34, 1
    s_mul_i32 s35, s35, 7
    s_and_b32 s34, s34, 1
    s_lshl_b32 s34, s34, 2
    s_and_b32 s36, s33, 3
    s_add_u32 s34, s34, s36
    s_lshr_b32 s33, s33, 2
    s_add_u32 s33, s33, s35
    s_waitcnt lgkmcnt(0)
    s_add_u32 s12, s8, 3145728
    s_addc_u32 s13, s9, 0
    s_mov_b32 s14, 2097152
    s_mov_b32 s15, 0x00020000
    s_mov_b32 s16, s4
    s_mov_b32 s17, s5
    s_mov_b32 s18, 1835008
    s_mov_b32 s19, 0x00020000
    s_mov_b32 s24, s6
    s_mov_b32 s25, s7
    s_mov_b32 s26, 1835008
    s_mov_b32 s27, 0x00020000
    s_add_u32 s20, s8, 9437184
    s_addc_u32 s21, s9, 0
    s_mov_b32 s22, 8388608
    s_mov_b32 s23, 0x00020000
    v_lshlrev_b32 v2, 4, v1
    v_lshrrev_b32 v5, 3, v1
    v_and_b32 v6, 7, v1
    v_lshrrev_b32 v7, 1, v5
    v_and_b32 v7, 1, v7
    s_lshl_b32 s35, s32, 1
    v_or_b32 v7, s35, v7
    v_lshlrev_b32 v7, 1, v7
    v_xor_b32 v6, v6, v7
    v_lshlrev_b32 v6, 4, v6
    s_movk_i32 s35, 3584
    v_mul_lo_u32 v5, v5, s35
    v_add_u32 v3, v5, v6
    s_lshl_b32 s40, s33, 7
    s_mul_i32 s41, s31, 114688
    s_add_u32 s40, s40, s41
    s_lshl_b32 s42, s31, 12
    s_lshl_b32 s41, s32, 14
    s_add_u32 s42, s42, s41
    s_cmp_eq_u32 s32, 0
    s_cselect_b32 s36, s16, s24
    s_cselect_b32 s37, s17, s25
    s_mov_b32 s38, s18
    s_mov_b32 s39, 0x00020000
    v_and_b32 v8, 15, v1
    v_lshrrev_b32 v9, 2, v8
    v_and_b32 v10, 3, v8
    v_lshrrev_b32 v11, 4, v1
    v_and_b32 v11, 1, v11
    v_lshrrev_b32 v8, 5, v1
    v_lshlrev_b32 v8, 3, v8
    v_add_u32 v8, v8, v9
    v_lshlrev_b32 v8, 7, v8
    v_lshlrev_b32 v12, 14, v11
    v_add_u32 v8, v8, v12
    v_lshrrev_b32 v9, 1, v9
    v_lshlrev_b32 v11, 1, v11
    v_or_b32 v9, v9, v11
    v_xor_b32 v9, s31, v9
    v_lshlrev_b32 v9, 5, v9
    v_add_u32 v8, v8, v9
    v_lshlrev_b32 v10, 3, v10
    v_add_u32 v4, v8, v10
    v_add_u32 v5, 0x10000, v4
    v_add_u32 v6, 0x20000, v4
    s_lshl_b32 s43, s34, 18
    s_lshl_b32 s41, s30, 13
    s_add_u32 s43, s43, s41
    s_lshl_b32 s44, s30, 13
    s_lshl_b32 s41, s32, 15
    v_add_u32 v7, s41, v2
    s_lshl_b32 s45, s34, 3
    s_add_u32 s45, s45, s32
    s_mul_i32 s45, s45, 114688
    s_lshl_b32 s41, s33, 12
    s_add_u32 s45, s45, s41
    s_lshl_b32 s41, s31, 10
    s_add_u32 s45, s45, s41
    s_mov_b32 s48, 3222493025
    s_mov_b32 s49, 3184710632
    s_load_dwordx2 s[50:51], s[0:1], 0
    s_load_dwordx2 s[52:53], s[0:1], 104
    s_lshl_b32 s54, s2, 3
    s_add_u32 s54, s54, s30
    s_lshl_b32 s55, s54, 10
    v_add_u32 v8, s55, v2
    v_lshlrev_b32 v9, 5, v1
    s_lshl_b32 s55, s54, 11
    v_add_u32 v10, s55, v9
    s_waitcnt lgkmcnt(0)
    global_load_dwordx4 v[64:67], v8, s[50:51]
    s_add_u32 s56, s8, 34603008
    s_addc_u32 s57, s9, 0
    global_load_dwordx4 v[68:71], v8, s[56:57]
    s_add_u32 s56, s8, 36700160
    s_addc_u32 s57, s9, 0
    global_load_dwordx4 v[72:75], v8, s[56:57]
    s_add_u32 s56, s8, 38797312
    s_addc_u32 s57, s9, 0
    global_load_dwordx4 v[76:79], v8, s[56:57]
    s_add_u32 s56, s8, 40894464
    s_addc_u32 s57, s9, 0
    global_load_dwordx4 v[80:83], v8, s[56:57]
    v_add_u32 v11, 4096, v9
    global_load_dwordx4 v[88:91], v11, s[8:9]
    global_load_dwordx4 v[92:95], v11, s[8:9] offset:16
    global_load_dwordx4 v[96:99], v11, s[8:9] offset:2048
    global_load_dwordx4 v[100:103], v11, s[8:9] offset:2064
    v_add_u32 v11, 8192, v9
    global_load_dwordx4 v[104:107], v11, s[8:9]
    global_load_dwordx4 v[108:111], v11, s[8:9] offset:16
    s_cmp_ge_u32 s2, 224
    s_cbranch_scc1 rgu_kernel_now
    s_add_u32 m0, s42, 131072
    s_add_u32 s46, s40, 0
    buffer_load_dwordx4 v3, s[36:39], s46 offen lds
    s_add_u32 m0, s42, 132096
    s_add_u32 s46, s40, 28672
    buffer_load_dwordx4 v3, s[36:39], s46 offen lds
    s_add_u32 m0, s42, 133120
    s_add_u32 s46, s40, 57344
    buffer_load_dwordx4 v3, s[36:39], s46 offen lds
    s_add_u32 m0, s42, 134144
    s_add_u32 s46, s40, 86016
    buffer_load_dwordx4 v3, s[36:39], s46 offen lds
    s_add_u32 m0, s42, 65536
    s_add_u32 s46, s40, 458752
    buffer_load_dwordx4 v3, s[36:39], s46 offen lds
    s_add_u32 m0, s42, 66560
    s_add_u32 s46, s40, 487424
    buffer_load_dwordx4 v3, s[36:39], s46 offen lds
    s_add_u32 m0, s42, 67584
    s_add_u32 s46, s40, 516096
    buffer_load_dwordx4 v3, s[36:39], s46 offen lds
    s_add_u32 m0, s42, 68608
    s_add_u32 s46, s40, 544768
    buffer_load_dwordx4 v3, s[36:39], s46 offen lds
    s_add_u32 m0, s42, 98304
    s_add_u32 s46, s40, 917504
    buffer_load_dwordx4 v3, s[36:39], s46 offen lds
    s_add_u32 m0, s42, 99328
    s_add_u32 s46, s40, 946176
    buffer_load_dwordx4 v3, s[36:39], s46 offen lds
    s_add_u32 m0, s42, 100352
    s_add_u32 s46, s40, 974848
    buffer_load_dwordx4 v3, s[36:39], s46 offen lds
    s_add_u32 m0, s42, 101376
    s_add_u32 s46, s40, 1003520
    buffer_load_dwordx4 v3, s[36:39], s46 offen lds
    s_waitcnt vmcnt(12)
    s_branch rgu_kernel_now2
rgu_kernel_now:
    s_waitcnt vmcnt(0)
rgu_kernel_now2:
    v_lshlrev_b32 v112, 16, v64
    v_and_b32 v113, 0xffff0000, v64
    v_lshlrev_b32 v114, 16, v65
    v_and_b32 v115, 0xffff0000, v65
    v_lshlrev_b32 v116, 16, v66
    v_and_b32 v117, 0xffff0000, v66
    v_lshlrev_b32 v118, 16, v67
    v_and_b32 v119, 0xffff0000, v67
    v_lshlrev_b32 v120, 16, v68
    v_and_b32 v121, 0xffff0000, v68
    v_lshlrev_b32 v122, 16, v69
    v_and_b32 v123, 0xffff0000, v69
    v_lshlrev_b32 v124, 16, v70
    v_and_b32 v125, 0xffff0000, v70
    v_lshlrev_b32 v126, 16, v71
    v_and_b32 v127, 0xffff0000, v71
    v_lshlrev_b32 v128, 16, v72
    v_and_b32 v129, 0xffff0000, v72
    v_lshlrev_b32 v130, 16, v73
    v_and_b32 v131, 0xffff0000, v73
    v_lshlrev_b32 v132, 16, v74
    v_and_b32 v133, 0xffff0000, v74
    v_lshlrev_b32 v134, 16, v75
    v_and_b32 v135, 0xffff0000, v75
    v_lshlrev_b32 v136, 16, v76
    v_and_b32 v137, 0xffff0000, v76
    v_lshlrev_b32 v138, 16, v77
    v_and_b32 v139, 0xffff0000, v77
    v_lshlrev_b32 v140, 16, v78
    v_and_b32 v141, 0xffff0000, v78
    v_lshlrev_b32 v142, 16, v79
    v_and_b32 v143, 0xffff0000, v79
    v_lshlrev_b32 v144, 16, v80
    v_and_b32 v145, 0xffff0000, v80
    v_lshlrev_b32 v146, 16, v81
    v_and_b32 v147, 0xffff0000, v81
    v_lshlrev_b32 v148, 16, v82
    v_and_b32 v149, 0xffff0000, v82
    v_lshlrev_b32 v150, 16, v83
    v_and_b32 v151, 0xffff0000, v83
    v_add_f32 v120, v120, v128
    v_add_f32 v136, v136, v144
    v_add_f32 v120, v120, v136
    v_fmac_f32 v112, v120, v88
    v_add_f32 v121, v121, v129
    v_add_f32 v137, v137, v145
    v_add_f32 v121, v121, v137
    v_fmac_f32 v113, v121, v89
    v_add_f32 v122, v122, v130
    v_add_f32 v138, v138, v146
    v_add_f32 v122, v122, v138
    v_fmac_f32 v114, v122, v90
    v_add_f32 v123, v123, v131
    v_add_f32 v139, v139, v147
    v_add_f32 v123, v123, v139
    v_fmac_f32 v115, v123, v91
    v_add_f32 v124, v124, v132
    v_add_f32 v140, v140, v148
    v_add_f32 v124, v124, v140
    v_fmac_f32 v116, v124, v92
    v_add_f32 v125, v125, v133
    v_add_f32 v141, v141, v149
    v_add_f32 v125, v125, v141
    v_fmac_f32 v117, v125, v93
    v_add_f32 v126, v126, v134
    v_add_f32 v142, v142, v150
    v_add_f32 v126, v126, v142
    v_fmac_f32 v118, v126, v94
    v_add_f32 v127, v127, v135
    v_add_f32 v143, v143, v151
    v_add_f32 v127, v127, v143
    v_fmac_f32 v119, v127, v95
    s_add_u32 s56, s8, 5242880
    s_addc_u32 s57, s9, 0
    global_store_dwordx4 v10, v[112:115], s[56:57]
    global_store_dwordx4 v10, v[116:119], s[56:57] offset:16
    s_nop 1
    v_mov_b32 v120, v112
    v_mov_b32 v121, v113
    v_mov_b32 v122, v114
    v_mov_b32 v123, v115
    v_mov_b32 v124, v116
    v_mov_b32 v125, v117
    v_mov_b32 v126, v118
    v_mov_b32 v127, v119
    v_add_f32 v128, v120, v121
    v_add_f32 v128, v128, v122
    v_add_f32 v128, v128, v123
    v_add_f32 v128, v128, v124
    v_add_f32 v128, v128, v125
    v_add_f32 v128, v128, v126
    v_add_f32 v128, v128, v127
    s_nop 1
    v_add_f32_dpp v128, v128, v128 quad_perm:[1,0,3,2] row_mask:0xf bank_mask:0xf
    s_nop 1
    v_add_f32_dpp v128, v128, v128 quad_perm:[2,3,0,1] row_mask:0xf bank_mask:0xf
    s_nop 1
    v_add_f32_dpp v128, v128, v128 row_half_mirror row_mask:0xf bank_mask:0xf
    s_nop 1
    v_add_f32_dpp v128, v128, v128 row_mirror row_mask:0xf bank_mask:0xf
    s_nop 1
    v_readlane_b32 s56, v128, 0
    v_readlane_b32 s57, v128, 16
    v_readlane_b32 s58, v128, 32
    v_readlane_b32 s59, v128, 48
    s_nop 1
    v_mov_b32 v128, s56
    v_add_f32 v128, s57, v128
    v_add_f32 v128, s58, v128
    v_add_f32 v128, s59, v128
    v_mul_f32 v128, 0x3b000000, v128
    v_sub_f32 v120, v120, v128
    v_sub_f32 v121, v121, v128
    v_sub_f32 v122, v122, v128
    v_sub_f32 v123, v123, v128
    v_sub_f32 v124, v124, v128
    v_sub_f32 v125, v125, v128
    v_sub_f32 v126, v126, v128
    v_sub_f32 v127, v127, v128
    v_mul_f32 v128, v120, v120
    v_fmac_f32 v128, v121, v121
    v_fmac_f32 v128, v122, v122
    v_fmac_f32 v128, v123, v123
    v_fmac_f32 v128, v124, v124
    v_fmac_f32 v128, v125, v125
    v_fmac_f32 v128, v126, v126
    v_fmac_f32 v128, v127, v127
    s_nop 1
    v_add_f32_dpp v128, v128, v128 quad_perm:[1,0,3,2] row_mask:0xf bank_mask:0xf
    s_nop 1
    v_add_f32_dpp v128, v128, v128 quad_perm:[2,3,0,1] row_mask:0xf bank_mask:0xf
    s_nop 1
    v_add_f32_dpp v128, v128, v128 row_half_mirror row_mask:0xf bank_mask:0xf
    s_nop 1
    v_add_f32_dpp v128, v128, v128 row_mirror row_mask:0xf bank_mask:0xf
    s_nop 1
    v_readlane_b32 s56, v128, 0
    v_readlane_b32 s57, v128, 16
    v_readlane_b32 s58, v128, 32
    v_readlane_b32 s59, v128, 48
    s_nop 1
    v_mov_b32 v128, s56
    v_add_f32 v128, s57, v128
    v_add_f32 v128, s58, v128
    v_add_f32 v128, s59, v128
    v_mov_b32 v129, 0x3727c5ac
    v_fmac_f32 v129, 0x3b000000, v128
    v_rsq_f32 v129, v129
    s_nop 0
    v_mul_f32 v120, v120, v129
    v_mul_f32 v121, v121, v129
    v_mul_f32 v122, v122, v129
    v_mul_f32 v123, v123, v129
    v_mul_f32 v124, v124, v129
    v_mul_f32 v125, v125, v129
    v_mul_f32 v126, v126, v129
    v_mul_f32 v127, v127, v129
    v_add_f32 v104, 1.0, v104
    v_fma_f32 v120, v120, v104, v96
    v_add_f32 v105, 1.0, v105
    v_fma_f32 v121, v121, v105, v97
    v_add_f32 v106, 1.0, v106
    v_fma_f32 v122, v122, v106, v98
    v_add_f32 v107, 1.0, v107
    v_fma_f32 v123, v123, v107, v99
    v_add_f32 v108, 1.0, v108
    v_fma_f32 v124, v124, v108, v100
    v_add_f32 v109, 1.0, v109
    v_fma_f32 v125, v125, v109, v101
    v_add_f32 v110, 1.0, v110
    v_fma_f32 v126, v126, v110, v102
    v_add_f32 v111, 1.0, v111
    v_fma_f32 v127, v127, v111, v103
    v_cvt_pk_bf16_f32 v64, v120, v121
    v_cvt_pk_bf16_f32 v65, v122, v123
    v_cvt_pk_bf16_f32 v66, v124, v125
    v_cvt_pk_bf16_f32 v67, v126, v127
    s_lshl_b32 s55, s30, 10
    v_add_u32 v8, s55, v2
    ds_write_b128 v8, v[64:67]
    s_waitcnt lgkmcnt(0)
    s_barrier
    v_and_b32 v8, 7, v1
    v_lshrrev_b32 v9, 3, v1
    s_lshl_b32 s55, s30, 3
    v_add_u32 v9, s55, v9
    v_lshlrev_b32 v10, 10, v8
    v_lshlrev_b32 v11, 4, v9
    v_add_u32 v10, v10, v11
    ds_read_b128 v[64:67], v10
    v_lshrrev_b32 v10, 1, v9
    v_lshlrev_b32 v10, 10, v10
    v_and_b32 v11, 1, v9
    v_lshlrev_b32 v11, 9, v11
    v_add_u32 v10, v10, v11
    v_lshlrev_b32 v8, 4, v8
    v_add_u32 v10, v10, v8
    s_lshr_b32 s55, s2, 2
    s_lshl_b32 s55, s55, 15
    s_and_b32 s56, s2, 3
    s_lshl_b32 s56, s56, 7
    s_add_u32 s55, s55, s56
    s_add_u32 s55, s55, 3145728
    v_add_u32 v10, s55, v10
    s_waitcnt lgkmcnt(0)
    global_store_dwordx4 v10, v[64:67], s[8:9] sc0 sc1
    s_waitcnt vmcnt(0)
    s_barrier
    s_cmp_eq_u32 s30, 0
    s_cbranch_scc0 rgu_kernel_pub
    s_lshr_b32 s55, s2, 5
    s_lshl_b32 s55, s55, 5
    s_mov_b64 exec, 1
    v_mov_b32 v8, s55
    v_mov_b32 v9, 1
    global_atomic_add v8, v9, s[52:53]
    s_mov_b64 exec, -1
rgu_kernel_pub:
    s_cmp_ge_u32 s2, 224
    s_cbranch_scc1 rgu_kernel_end
    ds_read_b64_tr_b16 v[128:129], v6 offset:0
    ds_read_b64_tr_b16 v[130:131], v6 offset:512
    ds_read_b64_tr_b16 v[132:133], v6 offset:2048
    ds_read_b64_tr_b16 v[134:135], v6 offset:2560
    ds_read_b64_tr_b16 v[136:137], v6 offset:4096
    ds_read_b64_tr_b16 v[138:139], v6 offset:4608
    ds_read_b64_tr_b16 v[140:141], v6 offset:6144
    ds_read_b64_tr_b16 v[142:143], v6 offset:6656
    ds_read_b64_tr_b16 v[144:145], v6 offset:8192
    ds_read_b64_tr_b16 v[146:147], v6 offset:8704
    ds_read_b64_tr_b16 v[148:149], v6 offset:10240
    ds_read_b64_tr_b16 v[150:151], v6 offset:10752
    ds_read_b64_tr_b16 v[152:153], v6 offset:12288
    ds_read_b64_tr_b16 v[154:155], v6 offset:12800
    ds_read_b64_tr_b16 v[156:157], v6 offset:14336
    ds_read_b64_tr_b16 v[158:159], v6 offset:14848
    s_waitcnt lgkmcnt(0)
    s_barrier
    s_add_u32 m0, s42, 131072
    s_add_u32 s46, s40, 1376256
    buffer_load_dwordx4 v3, s[36:39], s46 offen lds
    s_add_u32 m0, s42, 132096
    s_add_u32 s46, s40, 1404928
    buffer_load_dwordx4 v3, s[36:39], s46 offen lds
    s_add_u32 m0, s42, 133120
    s_add_u32 s46, s40, 1433600
    buffer_load_dwordx4 v3, s[36:39], s46 offen lds
    s_add_u32 m0, s42, 134144
    s_add_u32 s46, s40, 1462272
    buffer_load_dwordx4 v3, s[36:39], s46 offen lds
    ds_read_b64_tr_b16 v[160:161], v5 offset:0
    ds_read_b64_tr_b16 v[162:163], v5 offset:512
    ds_read_b64_tr_b16 v[164:165], v5 offset:2048
    ds_read_b64_tr_b16 v[166:167], v5 offset:2560
    ds_read_b64_tr_b16 v[168:169], v5 offset:4096
    ds_read_b64_tr_b16 v[170:171], v5 offset:4608
    ds_read_b64_tr_b16 v[172:173], v5 offset:6144
    ds_read_b64_tr_b16 v[174:175], v5 offset:6656
    ds_read_b64_tr_b16 v[176:177], v5 offset:8192
    ds_read_b64_tr_b16 v[178:179], v5 offset:8704
    ds_read_b64_tr_b16 v[180:181], v5 offset:10240
    ds_read_b64_tr_b16 v[182:183], v5 offset:10752
    ds_read_b64_tr_b16 v[184:185], v5 offset:12288
    ds_read_b64_tr_b16 v[186:187], v5 offset:12800
    ds_read_b64_tr_b16 v[188:189], v5 offset:14336
    ds_read_b64_tr_b16 v[190:191], v5 offset:14848
    ds_read_b64_tr_b16 v[192:193], v5 offset:32768
    ds_read_b64_tr_b16 v[194:195], v5 offset:33280
    ds_read_b64_tr_b16 v[196:197], v5 offset:34816
    ds_read_b64_tr_b16 v[198:199], v5 offset:35328
    ds_read_b64_tr_b16 v[200:201], v5 offset:36864
    ds_read_b64_tr_b16 v[202:203], v5 offset:37376
    ds_read_b64_tr_b16 v[204:205], v5 offset:38912
    ds_read_b64_tr_b16 v[206:207], v5 offset:39424
    ds_read_b64_tr_b16 v[208:209], v5 offset:40960
    ds_read_b64_tr_b16 v[210:211], v5 offset:41472
    ds_read_b64_tr_b16 v[212:213], v5 offset:43008
    ds_read_b64_tr_b16 v[214:215], v5 offset:43520
    ds_read_b64_tr_b16 v[216:217], v5 offset:45056
    ds_read_b64_tr_b16 v[218:219], v5 offset:45568
    ds_read_b64_tr_b16 v[220:221], v5 offset:47104
    ds_read_b64_tr_b16 v[222:223], v5 offset:47616
    s_waitcnt vmcnt(0) lgkmcnt(0)
    s_barrier
    ds_read_b64_tr_b16 v[224:225], v6 offset:0
    ds_read_b64_tr_b16 v[226:227], v6 offset:512
    ds_read_b64_tr_b16 v[228:229], v6 offset:2048
    ds_read_b64_tr_b16 v[230:231], v6 offset:2560
    ds_read_b64_tr_b16 v[232:233], v6 offset:4096
    ds_read_b64_tr_b16 v[234:235], v6 offset:4608
    ds_read_b64_tr_b16 v[236:237], v6 offset:6144
    ds_read_b64_tr_b16 v[238:239], v6 offset:6656
    ds_read_b64_tr_b16 v[240:241], v6 offset:8192
    ds_read_b64_tr_b16 v[242:243], v6 offset:8704
    ds_read_b64_tr_b16 v[244:245], v6 offset:10240
    ds_read_b64_tr_b16 v[246:247], v6 offset:10752
    ds_read_b64_tr_b16 v[248:249], v6 offset:12288
    ds_read_b64_tr_b16 v[250:251], v6 offset:12800
    ds_read_b64_tr_b16 v[252:253], v6 offset:14336
    ds_read_b64_tr_b16 v[254:255], v6 offset:14848
    s_cmp_eq_u32 s30, 0
    s_cbranch_scc0 rgu_kernel_w2
    s_lshl_b32 s55, s34, 5
    v_mov_b32 v8, s55
rgu_kernel_poll:
    global_load_dword v9, v8, s[52:53] sc0 sc1
    s_waitcnt vmcnt(0)
    v_readfirstlane_b32 s56, v9
    s_nop 3
    s_cmp_ge_u32 s56, 32
    s_cbranch_scc1 rgu_kernel_w2
    s_sleep 2
    s_branch rgu_kernel_poll
rgu_kernel_w2:
    s_waitcnt lgkmcnt(0)
    s_barrier
    s_add_u32 m0, s44, 0
    s_add_u32 s46, s43, 0
    buffer_load_dwordx4 v2, s[12:15], s46 offen offset:0 lds
    buffer_load_dwordx4 v2, s[12:15], s46 offen offset:1024 lds
    buffer_load_dwordx4 v2, s[12:15], s46 offen offset:2048 lds
    buffer_load_dwordx4 v2, s[12:15], s46 offen offset:3072 lds
    s_add_u32 m0, s44, 4096
    s_add_u32 s46, s43, 4096
    buffer_load_dwordx4 v2, s[12:15], s46 offen offset:0 lds
    buffer_load_dwordx4 v2, s[12:15], s46 offen offset:1024 lds
    buffer_load_dwordx4 v2, s[12:15], s46 offen offset:2048 lds
    buffer_load_dwordx4 v2, s[12:15], s46 offen offset:3072 lds
    s_add_u32 m0, s44, 65536
    s_add_u32 s46, s43, 65536
    buffer_load_dwordx4 v2, s[12:15], s46 offen offset:0 lds
    buffer_load_dwordx4 v2, s[12:15], s46 offen offset:1024 lds
    buffer_load_dwordx4 v2, s[12:15], s46 offen offset:2048 lds
    buffer_load_dwordx4 v2, s[12:15], s46 offen offset:3072 lds
    s_add_u32 m0, s44, 69632
    s_add_u32 s46, s43, 69632
    buffer_load_dwordx4 v2, s[12:15], s46 offen offset:0 lds
    buffer_load_dwordx4 v2, s[12:15], s46 offen offset:1024 lds
    buffer_load_dwordx4 v2, s[12:15], s46 offen offset:2048 lds
    buffer_load_dwordx4 v2, s[12:15], s46 offen offset:3072 lds
    s_waitcnt vmcnt(8)
    s_barrier
    ds_read_b128 v[64:67], v7 offset:0
    ds_read_b128 v[68:71], v7 offset:1024
    ds_read_b128 v[72:75], v7 offset:2048
    ds_read_b128 v[76:79], v7 offset:3072
    ds_read_b128 v[80:83], v7 offset:4096
    ds_read_b128 v[84:87], v7 offset:5120
    ds_read_b128 v[88:91], v7 offset:6144
    s_waitcnt lgkmcnt(6)
    v_mfma_f32_32x32x16_bf16 v[96:111], v[128:131], v[64:67], 0
    ds_read_b128 v[92:95], v7 offset:7168
    s_waitcnt lgkmcnt(6)
    v_mfma_f32_32x32x16_bf16 v[96:111], v[132:135], v[68:71], v[96:111]
    ds_read_b128 v[64:67], v7 offset:8192
    s_waitcnt lgkmcnt(6)
    v_mfma_f32_32x32x16_bf16 v[96:111], v[136:139], v[72:75], v[96:111]
    ds_read_b128 v[68:71], v7 offset:9216
    s_waitcnt lgkmcnt(6)
    v_mfma_f32_32x32x16_bf16 v[96:111], v[140:143], v[76:79], v[96:111]
    ds_read_b128 v[72:75], v7 offset:10240
    s_waitcnt lgkmcnt(6)
    v_mfma_f32_32x32x16_bf16 v[96:111], v[144:147], v[80:83], v[96:111]
    ds_read_b128 v[76:79], v7 offset:11264
    s_waitcnt lgkmcnt(6)
    v_mfma_f32_32x32x16_bf16 v[96:111], v[148:151], v[84:87], v[96:111]
    ds_read_b128 v[80:83], v7 offset:12288
    s_waitcnt lgkmcnt(6)
    v_mfma_f32_32x32x16_bf16 v[96:111], v[152:155], v[88:91], v[96:111]
    ds_read_b128 v[84:87], v7 offset:13312
    s_waitcnt lgkmcnt(6)
    v_mfma_f32_32x32x16_bf16 v[96:111], v[156:159], v[92:95], v[96:111]
    ds_read_b128 v[88:91], v7 offset:14336
    s_waitcnt lgkmcnt(6)
    v_mfma_f32_32x32x16_bf16 v[96:111], v[160:163], v[64:67], v[96:111]
    ds_read_b128 v[92:95], v7 offset:15360
    s_waitcnt lgkmcnt(6)
    v_mfma_f32_32x32x16_bf16 v[96:111], v[164:167], v[68:71], v[96:111]
    ds_read_b128 v[64:67], v7 offset:16384
    s_waitcnt lgkmcnt(6)
    v_mfma_f32_32x32x16_bf16 v[96:111], v[168:171], v[72:75], v[96:111]
    ds_read_b128 v[68:71], v7 offset:17408
    s_waitcnt lgkmcnt(6)
    v_mfma_f32_32x32x16_bf16 v[96:111], v[172:175], v[76:79], v[96:111]
    ds_read_b128 v[72:75], v7 offset:18432
    s_waitcnt lgkmcnt(6)
    v_mfma_f32_32x32x16_bf16 v[96:111], v[176:179], v[80:83], v[96:111]
    ds_read_b128 v[76:79], v7 offset:19456
    s_waitcnt lgkmcnt(6)
    v_mfma_f32_32x32x16_bf16 v[96:111], v[180:183], v[84:87], v[96:111]
    ds_read_b128 v[80:83], v7 offset:20480
    s_waitcnt lgkmcnt(6)
    v_mfma_f32_32x32x16_bf16 v[96:111], v[184:187], v[88:91], v[96:111]
    ds_read_b128 v[84:87], v7 offset:21504
    s_waitcnt lgkmcnt(6)
    v_mfma_f32_32x32x16_bf16 v[96:111], v[188:191], v[92:95], v[96:111]
    ds_read_b128 v[88:91], v7 offset:22528
    s_waitcnt lgkmcnt(6)
    v_mfma_f32_32x32x16_bf16 v[96:111], v[192:195], v[64:67], v[96:111]
    ds_read_b128 v[92:95], v7 offset:23552
    s_waitcnt lgkmcnt(6)
    v_mfma_f32_32x32x16_bf16 v[96:111], v[196:199], v[68:71], v[96:111]
    ds_read_b128 v[64:67], v7 offset:24576
    s_waitcnt lgkmcnt(6)
    v_mfma_f32_32x32x16_bf16 v[96:111], v[200:203], v[72:75], v[96:111]
    ds_read_b128 v[68:71], v7 offset:25600
    s_waitcnt lgkmcnt(6)
    v_mfma_f32_32x32x16_bf16 v[96:111], v[204:207], v[76:79], v[96:111]
    ds_read_b128 v[72:75], v7 offset:26624
    s_waitcnt lgkmcnt(6)
    v_mfma_f32_32x32x16_bf16 v[96:111], v[208:211], v[80:83], v[96:111]
    ds_read_b128 v[76:79], v7 offset:27648
    s_waitcnt lgkmcnt(6)
    v_mfma_f32_32x32x16_bf16 v[96:111], v[212:215], v[84:87], v[96:111]
    ds_read_b128 v[80:83], v7 offset:28672
    s_waitcnt lgkmcnt(6)
    v_mfma_f32_32x32x16_bf16 v[96:111], v[216:219], v[88:91], v[96:111]
    ds_read_b128 v[84:87], v7 offset:29696
    s_waitcnt lgkmcnt(6)
    v_mfma_f32_32x32x16_bf16 v[96:111], v[220:223], v[92:95], v[96:111]
    ds_read_b128 v[88:91], v7 offset:30720
    s_waitcnt lgkmcnt(6)
    v_mfma_f32_32x32x16_bf16 v[96:111], v[224:227], v[64:67], v[96:111]
    ds_read_b128 v[92:95], v7 offset:31744
    s_waitcnt lgkmcnt(6)
    v_mfma_f32_32x32x16_bf16 v[96:111], v[228:231], v[68:71], v[96:111]
    s_waitcnt lgkmcnt(5)
    v_mfma_f32_32x32x16_bf16 v[96:111], v[232:235], v[72:75], v[96:111]
    s_waitcnt lgkmcnt(4)
    v_mfma_f32_32x32x16_bf16 v[96:111], v[236:239], v[76:79], v[96:111]
    s_waitcnt lgkmcnt(3)
    v_mfma_f32_32x32x16_bf16 v[96:111], v[240:243], v[80:83], v[96:111]
    s_waitcnt lgkmcnt(2)
    v_mfma_f32_32x32x16_bf16 v[96:111], v[244:247], v[84:87], v[96:111]
    s_waitcnt lgkmcnt(1)
    v_mfma_f32_32x32x16_bf16 v[96:111], v[248:251], v[88:91], v[96:111]
    s_waitcnt lgkmcnt(0)
    v_mfma_f32_32x32x16_bf16 v[96:111], v[252:255], v[92:95], v[96:111]
    v_xor_b32 v7, 0x10000, v7
    s_waitcnt vmcnt(0)
    s_barrier
    ds_read_b128 v[64:67], v7 offset:0
    ds_read_b128 v[68:71], v7 offset:1024
    ds_read_b128 v[72:75], v7 offset:2048
    ds_read_b128 v[76:79], v7 offset:3072
    ds_read_b128 v[80:83], v7 offset:4096
    ds_read_b128 v[84:87], v7 offset:5120
    ds_read_b128 v[88:91], v7 offset:6144
    s_waitcnt lgkmcnt(6)
    v_mfma_f32_32x32x16_bf16 v[112:127], v[128:131], v[64:67], 0
    ds_read_b128 v[92:95], v7 offset:7168
    s_waitcnt lgkmcnt(6)
    v_mfma_f32_32x32x16_bf16 v[112:127], v[132:135], v[68:71], v[112:127]
    s_add_u32 m0, s44, 0
    s_add_u32 s46, s43, 131072
    buffer_load_dwordx4 v2, s[12:15], s46 offen offset:0 lds
    ds_read_b128 v[64:67], v7 offset:8192
    s_waitcnt lgkmcnt(6)
    v_mfma_f32_32x32x16_bf16 v[112:127], v[136:139], v[72:75], v[112:127]
    ds_read_b128 v[68:71], v7 offset:9216
    s_waitcnt lgkmcnt(6)
    v_mfma_f32_32x32x16_bf16 v[112:127], v[140:143], v[76:79], v[112:127]
    buffer_load_dwordx4 v2, s[12:15], s46 offen offset:1024 lds
    ds_read_b128 v[72:75], v7 offset:10240
    s_waitcnt lgkmcnt(6)
    v_mfma_f32_32x32x16_bf16 v[112:127], v[144:147], v[80:83], v[112:127]
    ds_read_b128 v[76:79], v7 offset:11264
    s_waitcnt lgkmcnt(6)
    v_mfma_f32_32x32x16_bf16 v[112:127], v[148:151], v[84:87], v[112:127]
    buffer_load_dwordx4 v2, s[12:15], s46 offen offset:2048 lds
    ds_read_b128 v[80:83], v7 offset:12288
    s_waitcnt lgkmcnt(6)
    v_mfma_f32_32x32x16_bf16 v[112:127], v[152:155], v[88:91], v[112:127]
    ds_read_b128 v[84:87], v7 offset:13312
    s_waitcnt lgkmcnt(6)
    v_mfma_f32_32x32x16_bf16 v[112:127], v[156:159], v[92:95], v[112:127]
    buffer_load_dwordx4 v2, s[12:15], s46 offen offset:3072 lds
    ds_read_b128 v[88:91], v7 offset:14336
    s_waitcnt lgkmcnt(6)
    v_mfma_f32_32x32x16_bf16 v[112:127], v[160:163], v[64:67], v[112:127]
    ds_read_b128 v[92:95], v7 offset:15360
    s_waitcnt lgkmcnt(6)
    v_mfma_f32_32x32x16_bf16 v[112:127], v[164:167], v[68:71], v[112:127]
    s_add_u32 m0, s44, 4096
    s_add_u32 s46, s43, 135168
    buffer_load_dwordx4 v2, s[12:15], s46 offen offset:0 lds
    ds_read_b128 v[64:67], v7 offset:16384
    s_waitcnt lgkmcnt(6)
    v_mfma_f32_32x32x16_bf16 v[112:127], v[168:171], v[72:75], v[112:127]
    ds_read_b128 v[68:71], v7 offset:17408
    s_waitcnt lgkmcnt(6)
    v_mfma_f32_32x32x16_bf16 v[112:127], v[172:175], v[76:79], v[112:127]
    buffer_load_dwordx4 v2, s[12:15], s46 offen offset:1024 lds
    ds_read_b128 v[72:75], v7 offset:18432
    s_waitcnt lgkmcnt(6)
    v_mfma_f32_32x32x16_bf16 v[112:127], v[176:179], v[80:83], v[112:127]
    ds_read_b128 v[76:79], v7 offset:19456
    s_waitcnt lgkmcnt(6)
    v_mfma_f32_32x32x16_bf16 v[112:127], v[180:183], v[84:87], v[112:127]
    buffer_load_dwordx4 v2, s[12:15], s46 offen offset:2048 lds
    ds_read_b128 v[80:83], v7 offset:20480
    s_waitcnt lgkmcnt(6)
    v_mfma_f32_32x32x16_bf16 v[112:127], v[184:187], v[88:91], v[112:127]
    ds_read_b128 v[84:87], v7 offset:21504
    s_waitcnt lgkmcnt(6)
    v_mfma_f32_32x32x16_bf16 v[112:127], v[188:191], v[92:95], v[112:127]
    buffer_load_dwordx4 v2, s[12:15], s46 offen offset:3072 lds
    ds_read_b128 v[88:91], v7 offset:22528
    s_waitcnt lgkmcnt(6)
    v_mfma_f32_32x32x16_bf16 v[112:127], v[192:195], v[64:67], v[112:127]
    ds_read_b128 v[92:95], v7 offset:23552
    s_waitcnt lgkmcnt(6)
    v_mfma_f32_32x32x16_bf16 v[112:127], v[196:199], v[68:71], v[112:127]
    ds_read_b128 v[64:67], v7 offset:24576
    s_waitcnt lgkmcnt(6)
    v_mfma_f32_32x32x16_bf16 v[112:127], v[200:203], v[72:75], v[112:127]
    ds_read_b128 v[68:71], v7 offset:25600
    s_waitcnt lgkmcnt(6)
    v_mfma_f32_32x32x16_bf16 v[112:127], v[204:207], v[76:79], v[112:127]
    ds_read_b128 v[72:75], v7 offset:26624
    s_waitcnt lgkmcnt(6)
    v_mfma_f32_32x32x16_bf16 v[112:127], v[208:211], v[80:83], v[112:127]
    ds_read_b128 v[76:79], v7 offset:27648
    s_waitcnt lgkmcnt(6)
    v_mfma_f32_32x32x16_bf16 v[112:127], v[212:215], v[84:87], v[112:127]
    ds_read_b128 v[80:83], v7 offset:28672
    s_waitcnt lgkmcnt(6)
    v_mfma_f32_32x32x16_bf16 v[112:127], v[216:219], v[88:91], v[112:127]
    ds_read_b128 v[84:87], v7 offset:29696
    s_waitcnt lgkmcnt(6)
    v_mfma_f32_32x32x16_bf16 v[112:127], v[220:223], v[92:95], v[112:127]
    ds_read_b128 v[88:91], v7 offset:30720
    s_waitcnt lgkmcnt(6)
    v_mfma_f32_32x32x16_bf16 v[112:127], v[224:227], v[64:67], v[112:127]
    v_mul_f32 v16, v96, v96
    v_mul_f32 v17, v97, v97
    v_mul_f32 v18, v98, v98
    v_mul_f32 v19, v99, v99
    v_mul_f32 v20, v100, v100
    v_mul_f32 v21, v101, v101
    v_mul_f32 v22, v102, v102
    v_mul_f32 v23, v103, v103
    v_mov_b32 v24, s48
    v_fmac_f32 v24, s49, v16
    v_mov_b32 v25, s48
    v_fmac_f32 v25, s49, v17
    v_mov_b32 v26, s48
    v_fmac_f32 v26, s49, v18
    v_mov_b32 v27, s48
    v_fmac_f32 v27, s49, v19
    v_mov_b32 v28, s48
    v_fmac_f32 v28, s49, v20
    v_mov_b32 v29, s48
    v_fmac_f32 v29, s49, v21
    v_mov_b32 v30, s48
    v_fmac_f32 v30, s49, v22
    v_mov_b32 v31, s48
    v_fmac_f32 v31, s49, v23
    v_mul_f32 v16, v96, v24
    v_mul_f32 v17, v97, v25
    v_mul_f32 v18, v98, v26
    v_mul_f32 v19, v99, v27
    v_mul_f32 v20, v100, v28
    v_mul_f32 v21, v101, v29
    v_mul_f32 v22, v102, v30
    v_mul_f32 v23, v103, v31
    v_exp_f32 v16, v16
    v_exp_f32 v17, v17
    v_exp_f32 v18, v18
    v_exp_f32 v19, v19
    v_exp_f32 v20, v20
    v_exp_f32 v21, v21
    v_exp_f32 v22, v22
    v_exp_f32 v23, v23
    s_nop 0
    v_add_f32 v16, 1.0, v16
    v_add_f32 v17, 1.0, v17
    v_add_f32 v18, 1.0, v18
    v_add_f32 v19, 1.0, v19
    v_add_f32 v20, 1.0, v20
    v_add_f32 v21, 1.0, v21
    v_add_f32 v22, 1.0, v22
    v_add_f32 v23, 1.0, v23
    v_rcp_f32 v16, v16
    v_rcp_f32 v17, v17
    v_rcp_f32 v18, v18
    v_rcp_f32 v19, v19
    v_rcp_f32 v20, v20
    v_rcp_f32 v21, v21
    v_rcp_f32 v22, v22
    v_rcp_f32 v23, v23
    v_mul_f32 v24, v96, v104
    v_mul_f32 v25, v97, v105
    v_mul_f32 v26, v98, v106
    v_mul_f32 v27, v99, v107
    v_mul_f32 v28, v100, v108
    v_mul_f32 v29, v101, v109
    v_mul_f32 v30, v102, v110
    v_mul_f32 v31, v103, v111
    v_mul_f32 v16, v16, v24
    v_mul_f32 v17, v17, v25
    v_mul_f32 v18, v18, v26
    v_mul_f32 v19, v19, v27
    v_mul_f32 v20, v20, v28
    v_mul_f32 v21, v21, v29
    v_mul_f32 v22, v22, v30
    v_mul_f32 v23, v23, v31
    v_cvt_pk_bf16_f32 v56, v16, v17
    v_cvt_pk_bf16_f32 v57, v18, v19
    v_cvt_pk_bf16_f32 v58, v20, v21
    v_cvt_pk_bf16_f32 v59, v22, v23
    s_add_u32 s47, s45, 0
    buffer_store_dwordx4 v[56:59], v2, s[20:23], s47 offen sc1
    ds_read_b128 v[92:95], v7 offset:31744
    s_waitcnt lgkmcnt(6)
    v_mfma_f32_32x32x16_bf16 v[112:127], v[228:231], v[68:71], v[112:127]
    s_waitcnt lgkmcnt(5)
    v_mfma_f32_32x32x16_bf16 v[112:127], v[232:235], v[72:75], v[112:127]
    s_waitcnt lgkmcnt(4)
    v_mfma_f32_32x32x16_bf16 v[112:127], v[236:239], v[76:79], v[112:127]
    s_waitcnt lgkmcnt(3)
    v_mfma_f32_32x32x16_bf16 v[112:127], v[240:243], v[80:83], v[112:127]
    s_waitcnt lgkmcnt(2)
    v_mfma_f32_32x32x16_bf16 v[112:127], v[244:247], v[84:87], v[112:127]
    s_waitcnt lgkmcnt(1)
    v_mfma_f32_32x32x16_bf16 v[112:127], v[248:251], v[88:91], v[112:127]
    s_waitcnt lgkmcnt(0)
    v_mfma_f32_32x32x16_bf16 v[112:127], v[252:255], v[92:95], v[112:127]
    v_xor_b32 v7, 0x10000, v7
    s_waitcnt vmcnt(1)
    s_barrier
    ds_read_b128 v[64:67], v7 offset:0
    ds_read_b128 v[68:71], v7 offset:1024
    ds_read_b128 v[72:75], v7 offset:2048
    ds_read_b128 v[76:79], v7 offset:3072
    ds_read_b128 v[80:83], v7 offset:4096
    ds_read_b128 v[84:87], v7 offset:5120
    ds_read_b128 v[88:91], v7 offset:6144
    s_waitcnt lgkmcnt(6)
    v_mfma_f32_32x32x16_bf16 v[96:111], v[128:131], v[64:67], 0
    ds_read_b128 v[92:95], v7 offset:7168
    s_waitcnt lgkmcnt(6)
    v_mfma_f32_32x32x16_bf16 v[96:111], v[132:135], v[68:71], v[96:111]
    s_add_u32 m0, s44, 65536
    s_add_u32 s46, s43, 196608
    buffer_load_dwordx4 v2, s[12:15], s46 offen offset:0 lds
    ds_read_b128 v[64:67], v7 offset:8192
    s_waitcnt lgkmcnt(6)
    v_mfma_f32_32x32x16_bf16 v[96:111], v[136:139], v[72:75], v[96:111]
    ds_read_b128 v[68:71], v7 offset:9216
    s_waitcnt lgkmcnt(6)
    v_mfma_f32_32x32x16_bf16 v[96:111], v[140:143], v[76:79], v[96:111]
    buffer_load_dwordx4 v2, s[12:15], s46 offen offset:1024 lds
    ds_read_b128 v[72:75], v7 offset:10240
    s_waitcnt lgkmcnt(6)
    v_mfma_f32_32x32x16_bf16 v[96:111], v[144:147], v[80:83], v[96:111]
    ds_read_b128 v[76:79], v7 offset:11264
    s_waitcnt lgkmcnt(6)
    v_mfma_f32_32x32x16_bf16 v[96:111], v[148:151], v[84:87], v[96:111]
    buffer_load_dwordx4 v2, s[12:15], s46 offen offset:2048 lds
    ds_read_b128 v[80:83], v7 offset:12288
    s_waitcnt lgkmcnt(6)
    v_mfma_f32_32x32x16_bf16 v[96:111], v[152:155], v[88:91], v[96:111]
    ds_read_b128 v[84:87], v7 offset:13312
    s_waitcnt lgkmcnt(6)
    v_mfma_f32_32x32x16_bf16 v[96:111], v[156:159], v[92:95], v[96:111]
    buffer_load_dwordx4 v2, s[12:15], s46 offen offset:3072 lds
    ds_read_b128 v[88:91], v7 offset:14336
    s_waitcnt lgkmcnt(6)
    v_mfma_f32_32x32x16_bf16 v[96:111], v[160:163], v[64:67], v[96:111]
    ds_read_b128 v[92:95], v7 offset:15360
    s_waitcnt lgkmcnt(6)
    v_mfma_f32_32x32x16_bf16 v[96:111], v[164:167], v[68:71], v[96:111]
    s_add_u32 m0, s44, 69632
    s_add_u32 s46, s43, 200704
    buffer_load_dwordx4 v2, s[12:15], s46 offen offset:0 lds
    ds_read_b128 v[64:67], v7 offset:16384
    s_waitcnt lgkmcnt(6)
    v_mfma_f32_32x32x16_bf16 v[96:111], v[168:171], v[72:75], v[96:111]
    ds_read_b128 v[68:71], v7 offset:17408
    s_waitcnt lgkmcnt(6)
    v_mfma_f32_32x32x16_bf16 v[96:111], v[172:175], v[76:79], v[96:111]
    buffer_load_dwordx4 v2, s[12:15], s46 offen offset:1024 lds
    ds_read_b128 v[72:75], v7 offset:18432
    s_waitcnt lgkmcnt(6)
    v_mfma_f32_32x32x16_bf16 v[96:111], v[176:179], v[80:83], v[96:111]
    ds_read_b128 v[76:79], v7 offset:19456
    s_waitcnt lgkmcnt(6)
    v_mfma_f32_32x32x16_bf16 v[96:111], v[180:183], v[84:87], v[96:111]
    buffer_load_dwordx4 v2, s[12:15], s46 offen offset:2048 lds
    ds_read_b128 v[80:83], v7 offset:20480
    s_waitcnt lgkmcnt(6)
    v_mfma_f32_32x32x16_bf16 v[96:111], v[184:187], v[88:91], v[96:111]
    ds_read_b128 v[84:87], v7 offset:21504
    s_waitcnt lgkmcnt(6)
    v_mfma_f32_32x32x16_bf16 v[96:111], v[188:191], v[92:95], v[96:111]
    buffer_load_dwordx4 v2, s[12:15], s46 offen offset:3072 lds
    ds_read_b128 v[88:91], v7 offset:22528
    s_waitcnt lgkmcnt(6)
    v_mfma_f32_32x32x16_bf16 v[96:111], v[192:195], v[64:67], v[96:111]
    ds_read_b128 v[92:95], v7 offset:23552
    s_waitcnt lgkmcnt(6)
    v_mfma_f32_32x32x16_bf16 v[96:111], v[196:199], v[68:71], v[96:111]
    ds_read_b128 v[64:67], v7 offset:24576
    s_waitcnt lgkmcnt(6)
    v_mfma_f32_32x32x16_bf16 v[96:111], v[200:203], v[72:75], v[96:111]
    ds_read_b128 v[68:71], v7 offset:25600
    s_waitcnt lgkmcnt(6)
    v_mfma_f32_32x32x16_bf16 v[96:111], v[204:207], v[76:79], v[96:111]
    ds_read_b128 v[72:75], v7 offset:26624
    s_waitcnt lgkmcnt(6)
    v_mfma_f32_32x32x16_bf16 v[96:111], v[208:211], v[80:83], v[96:111]
    ds_read_b128 v[76:79], v7 offset:27648
    s_waitcnt lgkmcnt(6)
    v_mfma_f32_32x32x16_bf16 v[96:111], v[212:215], v[84:87], v[96:111]
    ds_read_b128 v[80:83], v7 offset:28672
    s_waitcnt lgkmcnt(6)
    v_mfma_f32_32x32x16_bf16 v[96:111], v[216:219], v[88:91], v[96:111]
    ds_read_b128 v[84:87], v7 offset:29696
    s_waitcnt lgkmcnt(6)
    v_mfma_f32_32x32x16_bf16 v[96:111], v[220:223], v[92:95], v[96:111]
    ds_read_b128 v[88:91], v7 offset:30720
    s_waitcnt lgkmcnt(6)
    v_mfma_f32_32x32x16_bf16 v[96:111], v[224:227], v[64:67], v[96:111]
    v_mul_f32 v16, v112, v112
    v_mul_f32 v17, v113, v113
    v_mul_f32 v18, v114, v114
    v_mul_f32 v19, v115, v115
    v_mul_f32 v20, v116, v116
    v_mul_f32 v21, v117, v117
    v_mul_f32 v22, v118, v118
    v_mul_f32 v23, v119, v119
    v_mov_b32 v24, s48
    v_fmac_f32 v24, s49, v16
    v_mov_b32 v25, s48
    v_fmac_f32 v25, s49, v17
    v_mov_b32 v26, s48
    v_fmac_f32 v26, s49, v18
    v_mov_b32 v27, s48
    v_fmac_f32 v27, s49, v19
    v_mov_b32 v28, s48
    v_fmac_f32 v28, s49, v20
    v_mov_b32 v29, s48
    v_fmac_f32 v29, s49, v21
    v_mov_b32 v30, s48
    v_fmac_f32 v30, s49, v22
    v_mov_b32 v31, s48
    v_fmac_f32 v31, s49, v23
    v_mul_f32 v16, v112, v24
    v_mul_f32 v17, v113, v25
    v_mul_f32 v18, v114, v26
    v_mul_f32 v19, v115, v27
    v_mul_f32 v20, v116, v28
    v_mul_f32 v21, v117, v29
    v_mul_f32 v22, v118, v30
    v_mul_f32 v23, v119, v31
    v_exp_f32 v16, v16
    v_exp_f32 v17, v17
    v_exp_f32 v18, v18
    v_exp_f32 v19, v19
    v_exp_f32 v20, v20
    v_exp_f32 v21, v21
    v_exp_f32 v22, v22
    v_exp_f32 v23, v23
    s_nop 0
    v_add_f32 v16, 1.0, v16
    v_add_f32 v17, 1.0, v17
    v_add_f32 v18, 1.0, v18
    v_add_f32 v19, 1.0, v19
    v_add_f32 v20, 1.0, v20
    v_add_f32 v21, 1.0, v21
    v_add_f32 v22, 1.0, v22
    v_add_f32 v23, 1.0, v23
    v_rcp_f32 v16, v16
    v_rcp_f32 v17, v17
    v_rcp_f32 v18, v18
    v_rcp_f32 v19, v19
    v_rcp_f32 v20, v20
    v_rcp_f32 v21, v21
    v_rcp_f32 v22, v22
    v_rcp_f32 v23, v23
    v_mul_f32 v24, v112, v120
    v_mul_f32 v25, v113, v121
    v_mul_f32 v26, v114, v122
    v_mul_f32 v27, v115, v123
    v_mul_f32 v28, v116, v124
    v_mul_f32 v29, v117, v125
    v_mul_f32 v30, v118, v126
    v_mul_f32 v31, v119, v127
    v_mul_f32 v16, v16, v24
    v_mul_f32 v17, v17, v25
    v_mul_f32 v18, v18, v26
    v_mul_f32 v19, v19, v27
    v_mul_f32 v20, v20, v28
    v_mul_f32 v21, v21, v29
    v_mul_f32 v22, v22, v30
    v_mul_f32 v23, v23, v31
    v_cvt_pk_bf16_f32 v56, v16, v17
    v_cvt_pk_bf16_f32 v57, v18, v19
    v_cvt_pk_bf16_f32 v58, v20, v21
    v_cvt_pk_bf16_f32 v59, v22, v23
    s_add_u32 s47, s45, 229376
    buffer_store_dwordx4 v[56:59], v2, s[20:23], s47 offen sc1
    ds_read_b128 v[92:95], v7 offset:31744
    s_waitcnt lgkmcnt(6)
    v_mfma_f32_32x32x16_bf16 v[96:111], v[228:231], v[68:71], v[96:111]
    s_waitcnt lgkmcnt(5)
    v_mfma_f32_32x32x16_bf16 v[96:111], v[232:235], v[72:75], v[96:111]
    s_waitcnt lgkmcnt(4)
    v_mfma_f32_32x32x16_bf16 v[96:111], v[236:239], v[76:79], v[96:111]
    s_waitcnt lgkmcnt(3)
    v_mfma_f32_32x32x16_bf16 v[96:111], v[240:243], v[80:83], v[96:111]
    s_waitcnt lgkmcnt(2)
    v_mfma_f32_32x32x16_bf16 v[96:111], v[244:247], v[84:87], v[96:111]
    s_waitcnt lgkmcnt(1)
    v_mfma_f32_32x32x16_bf16 v[96:111], v[248:251], v[88:91], v[96:111]
    s_waitcnt lgkmcnt(0)
    v_mfma_f32_32x32x16_bf16 v[96:111], v[252:255], v[92:95], v[96:111]
    v_xor_b32 v7, 0x10000, v7
    s_waitcnt vmcnt(1)
    s_barrier
    ds_read_b128 v[64:67], v7 offset:0
    ds_read_b128 v[68:71], v7 offset:1024
    ds_read_b128 v[72:75], v7 offset:2048
    ds_read_b128 v[76:79], v7 offset:3072
    ds_read_b128 v[80:83], v7 offset:4096
    ds_read_b128 v[84:87], v7 offset:5120
    ds_read_b128 v[88:91], v7 offset:6144
    s_waitcnt lgkmcnt(6)
    v_mfma_f32_32x32x16_bf16 v[112:127], v[128:131], v[64:67], 0
    ds_read_b128 v[92:95], v7 offset:7168
    s_waitcnt lgkmcnt(6)
    v_mfma_f32_32x32x16_bf16 v[112:127], v[132:135], v[68:71], v[112:127]
    ds_read_b128 v[64:67], v7 offset:8192
    s_waitcnt lgkmcnt(6)
    v_mfma_f32_32x32x16_bf16 v[112:127], v[136:139], v[72:75], v[112:127]
    ds_read_b128 v[68:71], v7 offset:9216
    s_waitcnt lgkmcnt(6)
    v_mfma_f32_32x32x16_bf16 v[112:127], v[140:143], v[76:79], v[112:127]
    ds_read_b128 v[72:75], v7 offset:10240
    s_waitcnt lgkmcnt(6)
    v_mfma_f32_32x32x16_bf16 v[112:127], v[144:147], v[80:83], v[112:127]
    ds_read_b128 v[76:79], v7 offset:11264
    s_waitcnt lgkmcnt(6)
    v_mfma_f32_32x32x16_bf16 v[112:127], v[148:151], v[84:87], v[112:127]
    ds_read_b128 v[80:83], v7 offset:12288
    s_waitcnt lgkmcnt(6)
    v_mfma_f32_32x32x16_bf16 v[112:127], v[152:155], v[88:91], v[112:127]
    ds_read_b128 v[84:87], v7 offset:13312
    s_waitcnt lgkmcnt(6)
    v_mfma_f32_32x32x16_bf16 v[112:127], v[156:159], v[92:95], v[112:127]
    ds_read_b128 v[88:91], v7 offset:14336
    s_waitcnt lgkmcnt(6)
    v_mfma_f32_32x32x16_bf16 v[112:127], v[160:163], v[64:67], v[112:127]
    ds_read_b128 v[92:95], v7 offset:15360
    s_waitcnt lgkmcnt(6)
    v_mfma_f32_32x32x16_bf16 v[112:127], v[164:167], v[68:71], v[112:127]
    ds_read_b128 v[64:67], v7 offset:16384
    s_waitcnt lgkmcnt(6)
    v_mfma_f32_32x32x16_bf16 v[112:127], v[168:171], v[72:75], v[112:127]
    ds_read_b128 v[68:71], v7 offset:17408
    s_waitcnt lgkmcnt(6)
    v_mfma_f32_32x32x16_bf16 v[112:127], v[172:175], v[76:79], v[112:127]
    ds_read_b128 v[72:75], v7 offset:18432
    s_waitcnt lgkmcnt(6)
    v_mfma_f32_32x32x16_bf16 v[112:127], v[176:179], v[80:83], v[112:127]
    ds_read_b128 v[76:79], v7 offset:19456
    s_waitcnt lgkmcnt(6)
    v_mfma_f32_32x32x16_bf16 v[112:127], v[180:183], v[84:87], v[112:127]
    ds_read_b128 v[80:83], v7 offset:20480
    s_waitcnt lgkmcnt(6)
    v_mfma_f32_32x32x16_bf16 v[112:127], v[184:187], v[88:91], v[112:127]
    ds_read_b128 v[84:87], v7 offset:21504
    s_waitcnt lgkmcnt(6)
    v_mfma_f32_32x32x16_bf16 v[112:127], v[188:191], v[92:95], v[112:127]
    ds_read_b128 v[88:91], v7 offset:22528
    s_waitcnt lgkmcnt(6)
    v_mfma_f32_32x32x16_bf16 v[112:127], v[192:195], v[64:67], v[112:127]
    ds_read_b128 v[92:95], v7 offset:23552
    s_waitcnt lgkmcnt(6)
    v_mfma_f32_32x32x16_bf16 v[112:127], v[196:199], v[68:71], v[112:127]
    ds_read_b128 v[64:67], v7 offset:24576
    s_waitcnt lgkmcnt(6)
    v_mfma_f32_32x32x16_bf16 v[112:127], v[200:203], v[72:75], v[112:127]
    ds_read_b128 v[68:71], v7 offset:25600
    s_waitcnt lgkmcnt(6)
    v_mfma_f32_32x32x16_bf16 v[112:127], v[204:207], v[76:79], v[112:127]
    ds_read_b128 v[72:75], v7 offset:26624
    s_waitcnt lgkmcnt(6)
    v_mfma_f32_32x32x16_bf16 v[112:127], v[208:211], v[80:83], v[112:127]
    ds_read_b128 v[76:79], v7 offset:27648
    s_waitcnt lgkmcnt(6)
    v_mfma_f32_32x32x16_bf16 v[112:127], v[212:215], v[84:87], v[112:127]
    ds_read_b128 v[80:83], v7 offset:28672
    s_waitcnt lgkmcnt(6)
    v_mfma_f32_32x32x16_bf16 v[112:127], v[216:219], v[88:91], v[112:127]
    ds_read_b128 v[84:87], v7 offset:29696
    s_waitcnt lgkmcnt(6)
    v_mfma_f32_32x32x16_bf16 v[112:127], v[220:223], v[92:95], v[112:127]
    ds_read_b128 v[88:91], v7 offset:30720
    s_waitcnt lgkmcnt(6)
    v_mfma_f32_32x32x16_bf16 v[112:127], v[224:227], v[64:67], v[112:127]
    v_mul_f32 v16, v96, v96
    v_mul_f32 v17, v97, v97
    v_mul_f32 v18, v98, v98
    v_mul_f32 v19, v99, v99
    v_mul_f32 v20, v100, v100
    v_mul_f32 v21, v101, v101
    v_mul_f32 v22, v102, v102
    v_mul_f32 v23, v103, v103
    v_mov_b32 v24, s48
    v_fmac_f32 v24, s49, v16
    v_mov_b32 v25, s48
    v_fmac_f32 v25, s49, v17
    v_mov_b32 v26, s48
    v_fmac_f32 v26, s49, v18
    v_mov_b32 v27, s48
    v_fmac_f32 v27, s49, v19
    v_mov_b32 v28, s48
    v_fmac_f32 v28, s49, v20
    v_mov_b32 v29, s48
    v_fmac_f32 v29, s49, v21
    v_mov_b32 v30, s48
    v_fmac_f32 v30, s49, v22
    v_mov_b32 v31, s48
    v_fmac_f32 v31, s49, v23
    v_mul_f32 v16, v96, v24
    v_mul_f32 v17, v97, v25
    v_mul_f32 v18, v98, v26
    v_mul_f32 v19, v99, v27
    v_mul_f32 v20, v100, v28
    v_mul_f32 v21, v101, v29
    v_mul_f32 v22, v102, v30
    v_mul_f32 v23, v103, v31
    v_exp_f32 v16, v16
    v_exp_f32 v17, v17
    v_exp_f32 v18, v18
    v_exp_f32 v19, v19
    v_exp_f32 v20, v20
    v_exp_f32 v21, v21
    v_exp_f32 v22, v22
    v_exp_f32 v23, v23
    s_nop 0
    v_add_f32 v16, 1.0, v16
    v_add_f32 v17, 1.0, v17
    v_add_f32 v18, 1.0, v18
    v_add_f32 v19, 1.0, v19
    v_add_f32 v20, 1.0, v20
    v_add_f32 v21, 1.0, v21
    v_add_f32 v22, 1.0, v22
    v_add_f32 v23, 1.0, v23
    v_rcp_f32 v16, v16
    v_rcp_f32 v17, v17
    v_rcp_f32 v18, v18
    v_rcp_f32 v19, v19
    v_rcp_f32 v20, v20
    v_rcp_f32 v21, v21
    v_rcp_f32 v22, v22
    v_rcp_f32 v23, v23
    v_mul_f32 v24, v96, v104
    v_mul_f32 v25, v97, v105
    v_mul_f32 v26, v98, v106
    v_mul_f32 v27, v99, v107
    v_mul_f32 v28, v100, v108
    v_mul_f32 v29, v101, v109
    v_mul_f32 v30, v102, v110
    v_mul_f32 v31, v103, v111
    v_mul_f32 v16, v16, v24
    v_mul_f32 v17, v17, v25
    v_mul_f32 v18, v18, v26
    v_mul_f32 v19, v19, v27
    v_mul_f32 v20, v20, v28
    v_mul_f32 v21, v21, v29
    v_mul_f32 v22, v22, v30
    v_mul_f32 v23, v23, v31
    v_cvt_pk_bf16_f32 v56, v16, v17
    v_cvt_pk_bf16_f32 v57, v18, v19
    v_cvt_pk_bf16_f32 v58, v20, v21
    v_cvt_pk_bf16_f32 v59, v22, v23
    s_add_u32 s47, s45, 458752
    buffer_store_dwordx4 v[56:59], v2, s[20:23], s47 offen sc1
    ds_read_b128 v[92:95], v7 offset:31744
    s_waitcnt lgkmcnt(6)
    v_mfma_f32_32x32x16_bf16 v[112:127], v[228:231], v[68:71], v[112:127]
    s_waitcnt lgkmcnt(5)
    v_mfma_f32_32x32x16_bf16 v[112:127], v[232:235], v[72:75], v[112:127]
    s_waitcnt lgkmcnt(4)
    v_mfma_f32_32x32x16_bf16 v[112:127], v[236:239], v[76:79], v[112:127]
    s_waitcnt lgkmcnt(3)
    v_mfma_f32_32x32x16_bf16 v[112:127], v[240:243], v[80:83], v[112:127]
    s_waitcnt lgkmcnt(2)
    v_mfma_f32_32x32x16_bf16 v[112:127], v[244:247], v[84:87], v[112:127]
    s_waitcnt lgkmcnt(1)
    v_mfma_f32_32x32x16_bf16 v[112:127], v[248:251], v[88:91], v[112:127]
    s_waitcnt lgkmcnt(0)
    v_mfma_f32_32x32x16_bf16 v[112:127], v[252:255], v[92:95], v[112:127]
    s_nop 15
    v_mul_f32 v16, v112, v112
    v_mul_f32 v17, v113, v113
    v_mul_f32 v18, v114, v114
    v_mul_f32 v19, v115, v115
    v_mul_f32 v20, v116, v116
    v_mul_f32 v21, v117, v117
    v_mul_f32 v22, v118, v118
    v_mul_f32 v23, v119, v119
    v_mov_b32 v24, s48
    v_fmac_f32 v24, s49, v16
    v_mov_b32 v25, s48
    v_fmac_f32 v25, s49, v17
    v_mov_b32 v26, s48
    v_fmac_f32 v26, s49, v18
    v_mov_b32 v27, s48
    v_fmac_f32 v27, s49, v19
    v_mov_b32 v28, s48
    v_fmac_f32 v28, s49, v20
    v_mov_b32 v29, s48
    v_fmac_f32 v29, s49, v21
    v_mov_b32 v30, s48
    v_fmac_f32 v30, s49, v22
    v_mov_b32 v31, s48
    v_fmac_f32 v31, s49, v23
    v_mul_f32 v16, v112, v24
    v_mul_f32 v17, v113, v25
    v_mul_f32 v18, v114, v26
    v_mul_f32 v19, v115, v27
    v_mul_f32 v20, v116, v28
    v_mul_f32 v21, v117, v29
    v_mul_f32 v22, v118, v30
    v_mul_f32 v23, v119, v31
    v_exp_f32 v16, v16
    v_exp_f32 v17, v17
    v_exp_f32 v18, v18
    v_exp_f32 v19, v19
    v_exp_f32 v20, v20
    v_exp_f32 v21, v21
    v_exp_f32 v22, v22
    v_exp_f32 v23, v23
    s_nop 0
    v_add_f32 v16, 1.0, v16
    v_add_f32 v17, 1.0, v17
    v_add_f32 v18, 1.0, v18
    v_add_f32 v19, 1.0, v19
    v_add_f32 v20, 1.0, v20
    v_add_f32 v21, 1.0, v21
    v_add_f32 v22, 1.0, v22
    v_add_f32 v23, 1.0, v23
    v_rcp_f32 v16, v16
    v_rcp_f32 v17, v17
    v_rcp_f32 v18, v18
    v_rcp_f32 v19, v19
    v_rcp_f32 v20, v20
    v_rcp_f32 v21, v21
    v_rcp_f32 v22, v22
    v_rcp_f32 v23, v23
    v_mul_f32 v24, v112, v120
    v_mul_f32 v25, v113, v121
    v_mul_f32 v26, v114, v122
    v_mul_f32 v27, v115, v123
    v_mul_f32 v28, v116, v124
    v_mul_f32 v29, v117, v125
    v_mul_f32 v30, v118, v126
    v_mul_f32 v31, v119, v127
    v_mul_f32 v16, v16, v24
    v_mul_f32 v17, v17, v25
    v_mul_f32 v18, v18, v26
    v_mul_f32 v19, v19, v27
    v_mul_f32 v20, v20, v28
    v_mul_f32 v21, v21, v29
    v_mul_f32 v22, v22, v30
    v_mul_f32 v23, v23, v31
    v_cvt_pk_bf16_f32 v56, v16, v17
    v_cvt_pk_bf16_f32 v57, v18, v19
    v_cvt_pk_bf16_f32 v58, v20, v21
    v_cvt_pk_bf16_f32 v59, v22, v23
    s_add_u32 s47, s45, 688128
    buffer_store_dwordx4 v[56:59], v2, s[20:23], s47 offen sc1
rgu_kernel_end:
    s_endpgm
.globl down_kernel
.p2align 8
.type down_kernel,@function
down_kernel:
    s_cmp_ge_u32 s2, 256
    s_cbranch_scc1 down_kernel_end
    s_load_dwordx2 s[4:5], s[0:1], 72
    s_load_dwordx2 s[8:9], s[0:1], 112
    s_load_dwordx2 s[6:7], s[0:1], 96
    v_and_b32 v1, 63, v0
    v_lshrrev_b32 v5, 6, v0
    s_nop 0
    v_readfirstlane_b32 s30, v5
    s_and_b32 s34, s2, 7
    s_lshr_b32 s35, s2, 3
    s_lshl_b32 s34, s34, 2
    s_and_b32 s36, s35, 3
    s_add_u32 s34, s34, s36
    s_lshr_b32 s36, s35, 2
    s_waitcnt lgkmcnt(0)
    s_add_u32 s12, s8, 9437184
    s_addc_u32 s13, s9, 0
    s_mov_b32 s14, 8388608
    s_mov_b32 s15, 0x00020000
    s_mov_b32 s16, s4
    s_mov_b32 s17, s5
    s_mov_b32 s18, 1835008
    s_mov_b32 s19, 0x00020000
    v_lshlrev_b32 v2, 4, v1
    s_lshl_b32 s40, s34, 1
    s_mul_i32 s40, s40, 114688
    s_mul_i32 s41, s30, 14336
    s_add_u32 s40, s40, s41
    v_lshrrev_b32 v5, 3, v1
    v_and_b32 v6, 7, v1
    v_lshrrev_b32 v7, 1, v5
    v_and_b32 v7, 1, v7
    v_lshlrev_b32 v7, 2, v7
    v_xor_b32 v6, v6, v7
    v_lshlrev_b32 v6, 4, v6
    v_lshlrev_b32 v5, 10, v5
    v_add_u32 v3, v5, v6
    s_mul_i32 s42, s30, 229376
    s_lshl_b32 s41, s36, 7
    s_add_u32 s42, s42, s41
    s_lshl_b32 s43, s30, 14
    v_and_b32 v8, 15, v1
    v_lshrrev_b32 v9, 2, v8
    v_and_b32 v10, 3, v8
    v_lshrrev_b32 v8, 5, v1
    v_lshlrev_b32 v8, 2, v8
    v_add_u32 v8, v8, v9
    v_lshlrev_b32 v8, 7, v8
    v_lshrrev_b32 v11, 4, v1
    v_and_b32 v11, 1, v11
    v_lshlrev_b32 v11, 5, v11
    v_add_u32 v8, v8, v11
    v_lshlrev_b32 v10, 3, v10
    v_add_u32 v8, v8, v10
    v_add_u32 v8, s43, v8
    v_lshrrev_b32 v9, 1, v9
    v_xor_b32 v10, 0, v9
    v_lshlrev_b32 v10, 6, v10
    v_add_u32 v4, v8, v10
    v_xor_b32 v10, 1, v9
    v_lshlrev_b32 v10, 6, v10
    v_add_u32 v5, v8, v10
    v_lshrrev_b32 v12, 3, v1
    s_lshl_b32 s44, s30, 3
    v_add_u32 v12, s44, v12
    s_lshl_b32 s44, s34, 6
    v_add_u32 v12, s44, v12
    v_and_b32 v13, 7, v1
    v_lshlrev_b32 v14, 5, v13
    v_lshlrev_b32 v15, 11, v12
    v_add_u32 v15, v15, v14
    s_lshl_b32 s44, s36, 8
    v_add_u32 v15, s44, v15
    s_add_u32 s20, s8, 5242880
    s_addc_u32 s21, s9, 0
    global_load_dwordx4 v[16:19], v15, s[20:21]
    global_load_dwordx4 v[20:23], v15, s[20:21] offset:16
    v_add_u32 v14, s44, v14
    v_add_u32 v14, 10240, v14
    global_load_dwordx4 v[24:27], v14, s[8:9]
    global_load_dwordx4 v[28:31], v14, s[8:9] offset:16
    s_add_u32 s46, s40, 0
    buffer_load_dwordx4 v[128:131], v2, s[12:15], s46 offen offset:0
    buffer_load_dwordx4 v[132:135], v2, s[12:15], s46 offen offset:1024
    s_add_u32 s46, s40, 114688
    buffer_load_dwordx4 v[184:187], v2, s[12:15], s46 offen offset:0
    buffer_load_dwordx4 v[188:191], v2, s[12:15], s46 offen offset:1024
    s_add_u32 m0, s43, 0
    s_add_u32 s46, s42, 0
    buffer_load_dwordx4 v3, s[16:19], s46 offen lds
    s_add_u32 m0, s43, 1024
    s_add_u32 s46, s42, 8192
    buffer_load_dwordx4 v3, s[16:19], s46 offen lds
    s_add_u32 m0, s43, 2048
    s_add_u32 s46, s42, 16384
    buffer_load_dwordx4 v3, s[16:19], s46 offen lds
    s_add_u32 m0, s43, 3072
    s_add_u32 s46, s42, 24576
    buffer_load_dwordx4 v3, s[16:19], s46 offen lds
    s_add_u32 s46, s40, 2048
    buffer_load_dwordx4 v[136:139], v2, s[12:15], s46 offen offset:0
    buffer_load_dwordx4 v[140:143], v2, s[12:15], s46 offen offset:1024
    s_add_u32 s46, s40, 116736
    buffer_load_dwordx4 v[192:195], v2, s[12:15], s46 offen offset:0
    buffer_load_dwordx4 v[196:199], v2, s[12:15], s46 offen offset:1024
    s_add_u32 m0, s43, 4096
    s_add_u32 s46, s42, 32768
    buffer_load_dwordx4 v3, s[16:19], s46 offen lds
    s_add_u32 m0, s43, 5120
    s_add_u32 s46, s42, 40960
    buffer_load_dwordx4 v3, s[16:19], s46 offen lds
    s_add_u32 m0, s43, 6144
    s_add_u32 s46, s42, 49152
    buffer_load_dwordx4 v3, s[16:19], s46 offen lds
    s_add_u32 m0, s43, 7168
    s_add_u32 s46, s42, 57344
    buffer_load_dwordx4 v3, s[16:19], s46 offen lds
    s_add_u32 s46, s40, 4096
    buffer_load_dwordx4 v[144:147], v2, s[12:15], s46 offen offset:0
    buffer_load_dwordx4 v[148:151], v2, s[12:15], s46 offen offset:1024
    s_add_u32 s46, s40, 118784
    buffer_load_dwordx4 v[200:203], v2, s[12:15], s46 offen offset:0
    buffer_load_dwordx4 v[204:207], v2, s[12:15], s46 offen offset:1024
    s_add_u32 m0, s43, 8192
    s_add_u32 s46, s42, 65536
    buffer_load_dwordx4 v3, s[16:19], s46 offen lds
    s_add_u32 m0, s43, 9216
    s_add_u32 s46, s42, 73728
    buffer_load_dwordx4 v3, s[16:19], s46 offen lds
    s_add_u32 m0, s43, 10240
    s_add_u32 s46, s42, 81920
    buffer_load_dwordx4 v3, s[16:19], s46 offen lds
    s_add_u32 m0, s43, 11264
    s_add_u32 s46, s42, 90112
    buffer_load_dwordx4 v3, s[16:19], s46 offen lds
    s_add_u32 s46, s40, 6144
    buffer_load_dwordx4 v[152:155], v2, s[12:15], s46 offen offset:0
    buffer_load_dwordx4 v[156:159], v2, s[12:15], s46 offen offset:1024
    s_add_u32 s46, s40, 120832
    buffer_load_dwordx4 v[208:211], v2, s[12:15], s46 offen offset:0
    buffer_load_dwordx4 v[212:215], v2, s[12:15], s46 offen offset:1024
    s_add_u32 m0, s43, 12288
    s_add_u32 s46, s42, 98304
    buffer_load_dwordx4 v3, s[16:19], s46 offen lds
    s_add_u32 m0, s43, 13312
    s_add_u32 s46, s42, 106496
    buffer_load_dwordx4 v3, s[16:19], s46 offen lds
    s_add_u32 m0, s43, 14336
    s_add_u32 s46, s42, 114688
    buffer_load_dwordx4 v3, s[16:19], s46 offen lds
    s_add_u32 m0, s43, 15360
    s_add_u32 s46, s42, 122880
    buffer_load_dwordx4 v3, s[16:19], s46 offen lds
    s_waitcnt vmcnt(24)
    ds_read_b64_tr_b16 v[32:33], v4 offset:0
    ds_read_b64_tr_b16 v[34:35], v4 offset:1024
    ds_read_b64_tr_b16 v[36:37], v5 offset:0
    ds_read_b64_tr_b16 v[38:39], v5 offset:1024
    ds_read_b64_tr_b16 v[40:41], v4 offset:2048
    ds_read_b64_tr_b16 v[42:43], v4 offset:3072
    ds_read_b64_tr_b16 v[44:45], v5 offset:2048
    ds_read_b64_tr_b16 v[46:47], v5 offset:3072
    s_waitcnt lgkmcnt(0)
    s_add_u32 s46, s40, 8192
    buffer_load_dwordx4 v[160:163], v2, s[12:15], s46 offen offset:0
    buffer_load_dwordx4 v[164:167], v2, s[12:15], s46 offen offset:1024
    s_add_u32 s46, s40, 122880
    buffer_load_dwordx4 v[216:219], v2, s[12:15], s46 offen offset:0
    buffer_load_dwordx4 v[220:223], v2, s[12:15], s46 offen offset:1024
    s_add_u32 m0, s43, 0
    s_add_u32 s46, s42, 131072
    buffer_load_dwordx4 v3, s[16:19], s46 offen lds
    s_add_u32 m0, s43, 1024
    s_add_u32 s46, s42, 139264
    buffer_load_dwordx4 v3, s[16:19], s46 offen lds
    s_add_u32 m0, s43, 2048
    s_add_u32 s46, s42, 147456
    buffer_load_dwordx4 v3, s[16:19], s46 offen lds
    s_add_u32 m0, s43, 3072
    s_add_u32 s46, s42, 155648
    buffer_load_dwordx4 v3, s[16:19], s46 offen lds
    v_mfma_f32_32x32x16_bf16 v[64:79], v[32:35], v[128:131], 0
    v_mfma_f32_32x32x16_bf16 v[80:95], v[32:35], v[184:187], 0
    v_mfma_f32_32x32x16_bf16 v[96:111], v[36:39], v[128:131], 0
    v_mfma_f32_32x32x16_bf16 v[112:127], v[36:39], v[184:187], 0
    v_mfma_f32_32x32x16_bf16 v[64:79], v[40:43], v[132:135], v[64:79]
    v_mfma_f32_32x32x16_bf16 v[80:95], v[40:43], v[188:191], v[80:95]
    v_mfma_f32_32x32x16_bf16 v[96:111], v[44:47], v[132:135], v[96:111]
    v_mfma_f32_32x32x16_bf16 v[112:127], v[44:47], v[188:191], v[112:127]
    s_waitcnt vmcnt(24)
    ds_read_b64_tr_b16 v[48:49], v4 offset:4096
    ds_read_b64_tr_b16 v[50:51], v4 offset:5120
    ds_read_b64_tr_b16 v[52:53], v5 offset:4096
    ds_read_b64_tr_b16 v[54:55], v5 offset:5120
    ds_read_b64_tr_b16 v[56:57], v4 offset:6144
    ds_read_b64_tr_b16 v[58:59], v4 offset:7168
    ds_read_b64_tr_b16 v[60:61], v5 offset:6144
    ds_read_b64_tr_b16 v[62:63], v5 offset:7168
    s_waitcnt lgkmcnt(0)
    s_add_u32 s46, s40, 10240
    buffer_load_dwordx4 v[168:171], v2, s[12:15], s46 offen offset:0
    buffer_load_dwordx4 v[172:175], v2, s[12:15], s46 offen offset:1024
    s_add_u32 s46, s40, 124928
    buffer_load_dwordx4 v[224:227], v2, s[12:15], s46 offen offset:0
    buffer_load_dwordx4 v[228:231], v2, s[12:15], s46 offen offset:1024
    s_add_u32 m0, s43, 4096
    s_add_u32 s46, s42, 163840
    buffer_load_dwordx4 v3, s[16:19], s46 offen lds
    s_add_u32 m0, s43, 5120
    s_add_u32 s46, s42, 172032
    buffer_load_dwordx4 v3, s[16:19], s46 offen lds
    s_add_u32 m0, s43, 6144
    s_add_u32 s46, s42, 180224
    buffer_load_dwordx4 v3, s[16:19], s46 offen lds
    s_add_u32 m0, s43, 7168
    s_add_u32 s46, s42, 188416
    buffer_load_dwordx4 v3, s[16:19], s46 offen lds
    v_mfma_f32_32x32x16_bf16 v[64:79], v[48:51], v[136:139], v[64:79]
    v_mfma_f32_32x32x16_bf16 v[80:95], v[48:51], v[192:195], v[80:95]
    v_mfma_f32_32x32x16_bf16 v[96:111], v[52:55], v[136:139], v[96:111]
    v_mfma_f32_32x32x16_bf16 v[112:127], v[52:55], v[192:195], v[112:127]
    v_mfma_f32_32x32x16_bf16 v[64:79], v[56:59], v[140:143], v[64:79]
    v_mfma_f32_32x32x16_bf16 v[80:95], v[56:59], v[196:199], v[80:95]
    v_mfma_f32_32x32x16_bf16 v[96:111], v[60:63], v[140:143], v[96:111]
    v_mfma_f32_32x32x16_bf16 v[112:127], v[60:63], v[196:199], v[112:127]
    s_waitcnt vmcnt(24)
    ds_read_b64_tr_b16 v[32:33], v4 offset:8192
    ds_read_b64_tr_b16 v[34:35], v4 offset:9216
    ds_read_b64_tr_b16 v[36:37], v5 offset:8192
    ds_read_b64_tr_b16 v[38:39], v5 offset:9216
    ds_read_b64_tr_b16 v[40:41], v4 offset:10240
    ds_read_b64_tr_b16 v[42:43], v4 offset:11264
    ds_read_b64_tr_b16 v[44:45], v5 offset:10240
    ds_read_b64_tr_b16 v[46:47], v5 offset:11264
    s_waitcnt lgkmcnt(0)
    s_add_u32 s46, s40, 12288
    buffer_load_dwordx4 v[176:179], v2, s[12:15], s46 offen offset:0
    buffer_load_dwordx4 v[180:183], v2, s[12:15], s46 offen offset:1024
    s_add_u32 s46, s40, 126976
    buffer_load_dwordx4 v[232:235], v2, s[12:15], s46 offen offset:0
    buffer_load_dwordx4 v[236:239], v2, s[12:15], s46 offen offset:1024
    s_add_u32 m0, s43, 8192
    s_add_u32 s46, s42, 196608
    buffer_load_dwordx4 v3, s[16:19], s46 offen lds
    s_add_u32 m0, s43, 9216
    s_add_u32 s46, s42, 204800
    buffer_load_dwordx4 v3, s[16:19], s46 offen lds
    s_add_u32 m0, s43, 10240
    s_add_u32 s46, s42, 212992
    buffer_load_dwordx4 v3, s[16:19], s46 offen lds
    s_add_u32 m0, s43, 11264
    s_add_u32 s46, s42, 221184
    buffer_load_dwordx4 v3, s[16:19], s46 offen lds
    v_mfma_f32_32x32x16_bf16 v[64:79], v[32:35], v[144:147], v[64:79]
    v_mfma_f32_32x32x16_bf16 v[80:95], v[32:35], v[200:203], v[80:95]
    v_mfma_f32_32x32x16_bf16 v[96:111], v[36:39], v[144:147], v[96:111]
    v_mfma_f32_32x32x16_bf16 v[112:127], v[36:39], v[200:203], v[112:127]
    v_mfma_f32_32x32x16_bf16 v[64:79], v[40:43], v[148:151], v[64:79]
    v_mfma_f32_32x32x16_bf16 v[80:95], v[40:43], v[204:207], v[80:95]
    v_mfma_f32_32x32x16_bf16 v[96:111], v[44:47], v[148:151], v[96:111]
    v_mfma_f32_32x32x16_bf16 v[112:127], v[44:47], v[204:207], v[112:127]
    s_waitcnt vmcnt(24)
    ds_read_b64_tr_b16 v[48:49], v4 offset:12288
    ds_read_b64_tr_b16 v[50:51], v4 offset:13312
    ds_read_b64_tr_b16 v[52:53], v5 offset:12288
    ds_read_b64_tr_b16 v[54:55], v5 offset:13312
    ds_read_b64_tr_b16 v[56:57], v4 offset:14336
    ds_read_b64_tr_b16 v[58:59], v4 offset:15360
    ds_read_b64_tr_b16 v[60:61], v5 offset:14336
    ds_read_b64_tr_b16 v[62:63], v5 offset:15360
    s_waitcnt lgkmcnt(0)
    v_mfma_f32_32x32x16_bf16 v[64:79], v[48:51], v[152:155], v[64:79]
    v_mfma_f32_32x32x16_bf16 v[80:95], v[48:51], v[208:211], v[80:95]
    v_mfma_f32_32x32x16_bf16 v[96:111], v[52:55], v[152:155], v[96:111]
    v_mfma_f32_32x32x16_bf16 v[112:127], v[52:55], v[208:211], v[112:127]
    v_mfma_f32_32x32x16_bf16 v[64:79], v[56:59], v[156:159], v[64:79]
    v_mfma_f32_32x32x16_bf16 v[80:95], v[56:59], v[212:215], v[80:95]
    v_mfma_f32_32x32x16_bf16 v[96:111], v[60:63], v[156:159], v[96:111]
    v_mfma_f32_32x32x16_bf16 v[112:127], v[60:63], v[212:215], v[112:127]
    s_waitcnt vmcnt(16)
    ds_read_b64_tr_b16 v[32:33], v4 offset:0
    ds_read_b64_tr_b16 v[34:35], v4 offset:1024
    ds_read_b64_tr_b16 v[36:37], v5 offset:0
    ds_read_b64_tr_b16 v[38:39], v5 offset:1024
    ds_read_b64_tr_b16 v[40:41], v4 offset:2048
    ds_read_b64_tr_b16 v[42:43], v4 offset:3072
    ds_read_b64_tr_b16 v[44:45], v5 offset:2048
    ds_read_b64_tr_b16 v[46:47], v5 offset:3072
    s_waitcnt lgkmcnt(0)
    v_mfma_f32_32x32x16_bf16 v[64:79], v[32:35], v[160:163], v[64:79]
    v_mfma_f32_32x32x16_bf16 v[80:95], v[32:35], v[216:219], v[80:95]
    v_mfma_f32_32x32x16_bf16 v[96:111], v[36:39], v[160:163], v[96:111]
    v_mfma_f32_32x32x16_bf16 v[112:127], v[36:39], v[216:219], v[112:127]
    v_mfma_f32_32x32x16_bf16 v[64:79], v[40:43], v[164:167], v[64:79]
    v_mfma_f32_32x32x16_bf16 v[80:95], v[40:43], v[220:223], v[80:95]
    v_mfma_f32_32x32x16_bf16 v[96:111], v[44:47], v[164:167], v[96:111]
    v_mfma_f32_32x32x16_bf16 v[112:127], v[44:47], v[220:223], v[112:127]
    s_waitcnt vmcnt(8)
    ds_read_b64_tr_b16 v[48:49], v4 offset:4096
    ds_read_b64_tr_b16 v[50:51], v4 offset:5120
    ds_read_b64_tr_b16 v[52:53], v5 offset:4096
    ds_read_b64_tr_b16 v[54:55], v5 offset:5120
    ds_read_b64_tr_b16 v[56:57], v4 offset:6144
    ds_read_b64_tr_b16 v[58:59], v4 offset:7168
    ds_read_b64_tr_b16 v[60:61], v5 offset:6144
    ds_read_b64_tr_b16 v[62:63], v5 offset:7168
    s_waitcnt lgkmcnt(0)
    v_mfma_f32_32x32x16_bf16 v[64:79], v[48:51], v[168:171], v[64:79]
    v_mfma_f32_32x32x16_bf16 v[80:95], v[48:51], v[224:227], v[80:95]
    v_mfma_f32_32x32x16_bf16 v[96:111], v[52:55], v[168:171], v[96:111]
    v_mfma_f32_32x32x16_bf16 v[112:127], v[52:55], v[224:227], v[112:127]
    v_mfma_f32_32x32x16_bf16 v[64:79], v[56:59], v[172:175], v[64:79]
    v_mfma_f32_32x32x16_bf16 v[80:95], v[56:59], v[228:231], v[80:95]
    v_mfma_f32_32x32x16_bf16 v[96:111], v[60:63], v[172:175], v[96:111]
    v_mfma_f32_32x32x16_bf16 v[112:127], v[60:63], v[228:231], v[112:127]
    s_waitcnt vmcnt(0)
    ds_read_b64_tr_b16 v[32:33], v4 offset:8192
    ds_read_b64_tr_b16 v[34:35], v4 offset:9216
    ds_read_b64_tr_b16 v[36:37], v5 offset:8192
    ds_read_b64_tr_b16 v[38:39], v5 offset:9216
    ds_read_b64_tr_b16 v[40:41], v4 offset:10240
    ds_read_b64_tr_b16 v[42:43], v4 offset:11264
    ds_read_b64_tr_b16 v[44:45], v5 offset:10240
    ds_read_b64_tr_b16 v[46:47], v5 offset:11264
    s_waitcnt lgkmcnt(0)
    v_mfma_f32_32x32x16_bf16 v[64:79], v[32:35], v[176:179], v[64:79]
    v_mfma_f32_32x32x16_bf16 v[80:95], v[32:35], v[232:235], v[80:95]
    v_mfma_f32_32x32x16_bf16 v[96:111], v[36:39], v[176:179], v[96:111]
    v_mfma_f32_32x32x16_bf16 v[112:127], v[36:39], v[232:235], v[112:127]
    v_mfma_f32_32x32x16_bf16 v[64:79], v[40:43], v[180:183], v[64:79]
    v_mfma_f32_32x32x16_bf16 v[80:95], v[40:43], v[236:239], v[80:95]
    v_mfma_f32_32x32x16_bf16 v[96:111], v[44:47], v[180:183], v[96:111]
    v_mfma_f32_32x32x16_bf16 v[112:127], v[44:47], v[236:239], v[112:127]
    s_nop 15
    s_barrier
    v_and_b32 v8, 31, v1
    s_mov_b32 s45, 272
    v_mul_lo_u32 v8, v8, s45
    v_lshrrev_b32 v9, 5, v1
    v_lshlrev_b32 v9, 4, v9
    v_add_u32 v8, v8, v9
    s_mul_i32 s44, s30, 17408
    v_add_u32 v8, s44, v8
    ds_write_b128 v8, v[64:67] offset:0
    ds_write_b128 v8, v[68:71] offset:32
    ds_write_b128 v8, v[72:75] offset:64
    ds_write_b128 v8, v[76:79] offset:96
    ds_write_b128 v8, v[80:83] offset:8704
    ds_write_b128 v8, v[84:87] offset:8736
    ds_write_b128 v8, v[88:91] offset:8768
    ds_write_b128 v8, v[92:95] offset:8800
    ds_write_b128 v8, v[96:99] offset:128
    ds_write_b128 v8, v[100:103] offset:160
    ds_write_b128 v8, v[104:107] offset:192
    ds_write_b128 v8, v[108:111] offset:224
    ds_write_b128 v8, v[112:115] offset:8832
    ds_write_b128 v8, v[116:119] offset:8864
    ds_write_b128 v8, v[120:123] offset:8896
    ds_write_b128 v8, v[124:127] offset:8928
    v_lshrrev_b32 v8, 3, v1
    s_lshl_b32 s44, s30, 3
    v_add_u32 v8, s44, v8
    v_and_b32 v10, 7, v1
    v_mul_lo_u32 v9, v8, s45
    v_lshlrev_b32 v11, 5, v10
    v_add_u32 v9, v9, v11
    s_lshl_b32 s44, s34, 6
    v_add_u32 v12, s44, v8
    s_waitcnt lgkmcnt(0)
    s_barrier
    ds_read_b128 v[64:67], v9 offset:0
    ds_read_b128 v[68:71], v9 offset:16
    v_add_u32 v15, 69632, v9
    ds_read_b128 v[72:75], v9 offset:17408
    ds_read_b128 v[76:79], v9 offset:17424
    ds_read_b128 v[80:83], v9 offset:34816
    ds_read_b128 v[84:87], v9 offset:34832
    ds_read_b128 v[88:91], v9 offset:52224
    ds_read_b128 v[92:95], v9 offset:52240
    ds_read_b128 v[96:99], v15 offset:0
    ds_read_b128 v[100:103], v15 offset:16
    ds_read_b128 v[104:107], v15 offset:17408
    ds_read_b128 v[108:111], v15 offset:17424
    ds_read_b128 v[112:115], v15 offset:34816
    ds_read_b128 v[116:119], v15 offset:34832
    ds_read_b128 v[120:123], v15 offset:52224
    ds_read_b128 v[124:127], v15 offset:52240
    s_waitcnt lgkmcnt(0)
    v_add_f32 v64, v64, v72
    v_add_f32 v65, v65, v73
    v_add_f32 v66, v66, v74
    v_add_f32 v67, v67, v75
    v_add_f32 v68, v68, v76
    v_add_f32 v69, v69, v77
    v_add_f32 v70, v70, v78
    v_add_f32 v71, v71, v79
    v_add_f32 v64, v64, v80
    v_add_f32 v65, v65, v81
    v_add_f32 v66, v66, v82
    v_add_f32 v67, v67, v83
    v_add_f32 v68, v68, v84
    v_add_f32 v69, v69, v85
    v_add_f32 v70, v70, v86
    v_add_f32 v71, v71, v87
    v_add_f32 v64, v64, v88
    v_add_f32 v65, v65, v89
    v_add_f32 v66, v66, v90
    v_add_f32 v67, v67, v91
    v_add_f32 v68, v68, v92
    v_add_f32 v69, v69, v93
    v_add_f32 v70, v70, v94
    v_add_f32 v71, v71, v95
    v_add_f32 v64, v64, v96
    v_add_f32 v65, v65, v97
    v_add_f32 v66, v66, v98
    v_add_f32 v67, v67, v99
    v_add_f32 v68, v68, v100
    v_add_f32 v69, v69, v101
    v_add_f32 v70, v70, v102
    v_add_f32 v71, v71, v103
    v_add_f32 v64, v64, v104
    v_add_f32 v65, v65, v105
    v_add_f32 v66, v66, v106
    v_add_f32 v67, v67, v107
    v_add_f32 v68, v68, v108
    v_add_f32 v69, v69, v109
    v_add_f32 v70, v70, v110
    v_add_f32 v71, v71, v111
    v_add_f32 v64, v64, v112
    v_add_f32 v65, v65, v113
    v_add_f32 v66, v66, v114
    v_add_f32 v67, v67, v115
    v_add_f32 v68, v68, v116
    v_add_f32 v69, v69, v117
    v_add_f32 v70, v70, v118
    v_add_f32 v71, v71, v119
    v_add_f32 v64, v64, v120
    v_add_f32 v65, v65, v121
    v_add_f32 v66, v66, v122
    v_add_f32 v67, v67, v123
    v_add_f32 v68, v68, v124
    v_add_f32 v69, v69, v125
    v_add_f32 v70, v70, v126
    v_add_f32 v71, v71, v127
    s_waitcnt vmcnt(0)
    v_fmac_f32 v16, v64, v24
    v_fmac_f32 v17, v65, v25
    v_fmac_f32 v18, v66, v26
    v_fmac_f32 v19, v67, v27
    v_fmac_f32 v20, v68, v28
    v_fmac_f32 v21, v69, v29
    v_fmac_f32 v22, v70, v30
    v_fmac_f32 v23, v71, v31
    v_cvt_pk_bf16_f32 v32, v16, v17
    v_cvt_pk_bf16_f32 v33, v18, v19
    v_cvt_pk_bf16_f32 v34, v20, v21
    v_cvt_pk_bf16_f32 v35, v22, v23
    v_lshlrev_b32 v13, 10, v12
    v_lshlrev_b32 v11, 4, v10
    v_add_u32 v13, v13, v11
    s_lshl_b32 s44, s36, 7
    v_add_u32 v13, s44, v13
    global_store_dwordx4 v13, v[32:35], s[6:7]
down_kernel_end:
    s_endpgm
.section .rodata,"a"
.p2align 6
.amdhsa_kernel kv_kernel
  .amdhsa_next_free_vgpr 256
  .amdhsa_next_free_sgpr 100
  .amdhsa_accum_offset 256
  .amdhsa_group_segment_fixed_size 0
  .amdhsa_kernarg_size 120
  .amdhsa_user_sgpr_count 2
  .amdhsa_user_sgpr_kernarg_segment_ptr 1
  .amdhsa_system_sgpr_workgroup_id_x 1
.end_amdhsa_kernel
.p2align 6
.amdhsa_kernel attn_kernel
  .amdhsa_next_free_vgpr 256
  .amdhsa_next_free_sgpr 102
  .amdhsa_accum_offset 256
  .amdhsa_group_segment_fixed_size 0
  .amdhsa_kernarg_size 120
  .amdhsa_user_sgpr_count 2
  .amdhsa_user_sgpr_kernarg_segment_ptr 1
  .amdhsa_system_sgpr_workgroup_id_x 1
.end_amdhsa_kernel
.p2align 6
.amdhsa_kernel oproj_kernel
  .amdhsa_next_free_vgpr 208
  .amdhsa_next_free_sgpr 102
  .amdhsa_accum_offset 208
  .amdhsa_group_segment_fixed_size 0
  .amdhsa_kernarg_size 120
  .amdhsa_user_sgpr_count 2
  .amdhsa_user_sgpr_kernarg_segment_ptr 1
  .amdhsa_system_sgpr_workgroup_id_x 1
.end_amdhsa_kernel
.p2align 6
.amdhsa_kernel rgu_kernel
  .amdhsa_next_free_vgpr 256
  .amdhsa_next_free_sgpr 102
  .amdhsa_accum_offset 256
  .amdhsa_group_segment_fixed_size 0
  .amdhsa_kernarg_size 120
  .amdhsa_user_sgpr_count 2
  .amdhsa_user_sgpr_kernarg_segment_ptr 1
  .amdhsa_system_sgpr_workgroup_id_x 1
.end_amdhsa_kernel
.p2align 6
.amdhsa_kernel down_kernel
  .amdhsa_next_free_vgpr 256
  .amdhsa_next_free_sgpr 102
  .amdhsa_accum_offset 256
  .amdhsa_group_segment_fixed_size 0
  .amdhsa_kernarg_size 120
  .amdhsa_user_sgpr_count 2
  .amdhsa_user_sgpr_kernarg_segment_ptr 1
  .amdhsa_system_sgpr_workgroup_id_x 1
.end_amdhsa_kernel
.p2align 6
```
